```python
import torch

def _softmax(x, axis=-1):
    return torch.softmax(x, dim=axis)
def _gelu(x):
    return torch.nn.functional.gelu(x, approximate="tanh")
def _silu(x):
    return torch.nn.functional.silu(x)
def _sigmoid(x):
    return torch.sigmoid(x)
def _layernorm(x, axis=-1, eps=1e-5):
    m = x.mean(dim=axis, keepdim=True)
    v = x.var(dim=axis, keepdim=True, unbiased=False)
    return (x - m) / torch.sqrt(v + eps)
def _scatter_add(tgt, idx, src, axis=0):
    return tgt.clone().index_add_(axis, idx, src)
def _segment_sum(src, seg, n):
    out = torch.zeros((n,) + src.shape[1:], dtype=src.dtype)
    return out.index_add_(0, seg, src)
def _pad(x, pw):
    flat = tuple(v for pair in reversed(pw) for v in pair)
    return torch.nn.functional.pad(x, flat)

kernel_name = 'concat_heads__linear_kernel_hedgehog__spectral_fnet__prompt'

def setup_inputs():

    _w = (lambda a: (lambda t: t.to(torch.bfloat16) if t.is_floating_point() else t)(torch.as_tensor(a)))
    def _A_setup():
        B, S, D, H = 1, 2048, 576, 32
        Dh = D // H
        return {
            "x": _w((lambda *s: torch.randn(*s, dtype=torch.bfloat16) * 0.2)(B, S, D)),
            "wqkv": _w((lambda *s: torch.randn(*s, dtype=torch.bfloat16) * 1.6)(D, 3 * D)),
            "w_phi": _w((lambda *s: torch.randn(*s, dtype=torch.bfloat16) * 1.6)(H, Dh, Dh) * (Dh ** -0.5)),
            "wo": _w((lambda *s: torch.randn(*s, dtype=torch.bfloat16) * 0.8)(D, D)),
        }
    _A_in = _A_setup()

    def _B_setup():
        B, S, D = 1, 2048, 576
        ns = torch.arange(S)[:, None] * torch.arange(S)[None, :]
        nd = torch.arange(D)[:, None] * torch.arange(D)[None, :]
        Ws_re = torch.cos(-2.0 * torch.pi * ns / S).to(float)
        Ws_im = torch.sin(-2.0 * torch.pi * ns / S).to(float)
        Wd_re = torch.cos(-2.0 * torch.pi * nd / D).to(float)
        Wd_im = torch.sin(-2.0 * torch.pi * nd / D).to(float)
        return {
            "x": _w((lambda *s: torch.randn(*s, dtype=torch.bfloat16) * 0.05)(B, S, D)),
            "dft_seq_re": _w(Ws_re),
            "dft_seq_im": _w(Ws_im),
            "dft_hid_re": _w(Wd_re),
            "dft_hid_im": _w(Wd_im),
        }
    _B_in = _B_setup()

    return {
        "A_x": _A_in["x"],
        "A_wqkv": _A_in["wqkv"],
        "A_w_phi": _A_in["w_phi"],
        "A_wo": _A_in["wo"],
        "B_x": _B_in["x"],
        "B_dft_seq_re": _B_in["dft_seq_re"],
        "B_dft_seq_im": _B_in["dft_seq_im"],
        "B_dft_hid_re": _B_in["dft_hid_re"],
        "B_dft_hid_im": _B_in["dft_hid_im"],
    }

def reference(A_x, A_wqkv, A_w_phi, A_wo, B_x, B_dft_seq_re, B_dft_seq_im, B_dft_hid_re, B_dft_hid_im):
    def _A_ref(x, wqkv, w_phi, wo):
        B, S, D = x.shape
        H = 32; Dh = D // H
        qkv = (lambda x, *d: x.permute(*d))((x @ wqkv).reshape(B, S, 3, H, Dh), 2, 0, 3, 1, 4)
        q, k, v = qkv[0], qkv[1], qkv[2]
        pq = torch.einsum("bhsd,hdf->bhsf", q, w_phi)
        pk = torch.einsum("bhsd,hdf->bhsf", k, w_phi)
        phi_q = torch.concatenate([_softmax(pq, axis=-1), _softmax(-pq, axis=-1)], axis=-1)
        phi_k = torch.concatenate([_softmax(pk, axis=-1), _softmax(-pk, axis=-1)], axis=-1)
        kv = torch.einsum("bhsf,bhsd->bhfd", phi_k, v)
        z  = torch.einsum("bhsf->bhf", phi_k)
        num = torch.einsum("bhqf,bhfd->bhqd", phi_q, kv)
        den = torch.einsum("bhqf,bhf->bhq", phi_q, z)[..., None] + 1e-6
        o = num / den
        return (lambda x, *d: x.permute(*d))(o, 0, 2, 1, 3).reshape(B, S, D) @ wo

    def _B_ref(x, dft_seq_re, dft_seq_im, dft_hid_re, dft_hid_im):
        a = torch.einsum("bsd,ed->bse", x, dft_hid_re)
        b = torch.einsum("bsd,ed->bse", x, dft_hid_im)
        y = torch.einsum("ts,bse->bte", dft_seq_re, a) - torch.einsum("ts,bse->bte", dft_seq_im, b)
        return y

    a = _A_ref(A_x, A_wqkv, A_w_phi, A_wo)
    b = _B_ref(B_x, B_dft_seq_re, B_dft_seq_im, B_dft_hid_re, B_dft_hid_im)
    return torch.concatenate([a, b], axis=-1)
```

```asm
; @launch grid=(256,1,1) block=(512,1,1) lds=163840
.amdgcn_target "amdgcn-amd-amdhsa--gfx950"
.text
.globl concat_heads__linear_kernel_hedgehog__spectral_fnet__prompt_kernel
.p2align 8
.type concat_heads__linear_kernel_hedgehog__spectral_fnet__prompt_kernel,@function
concat_heads__linear_kernel_hedgehog__spectral_fnet__prompt_kernel:
    s_load_dwordx16 s[16:31], s[0:1], 0
    s_load_dwordx8 s[32:39], s[0:1], 64
    s_cmp_ge_u32 s2, 256
    s_cbranch_scc1 L_end
    v_readfirstlane_b32 s3, v0
    v_and_b32 v1, 63, v0
    s_and_b32 s4, s2, 7
    s_lshr_b32 s5, s2, 3
    s_lshr_b32 s3, s3, 6
    s_cmp_lt_u32 s5, 24
    s_cbranch_scc1 L_A
    s_getpc_b64 s[8:9]
L_pc:
    s_lshl_b32 s10, s5, 3
    s_add_u32 s10, s10, s3
    s_lshl_b32 s10, s10, 10
    s_sub_u32 s10, s10, 196608
    v_lshl_add_u32 v2, v1, 7, s10
    v_min_u32 v2, L_end-L_pc, v2
    s_mov_b64 exec, 0xff
    global_load_dword v255, v2, s[8:9]
    s_mov_b64 exec, -1
    s_branch L_B
L_A:
    s_lshr_b32 s7, s5, 2
    s_and_b32 s6, s5, 3
    s_and_b32 s78, s4, 6
    s_lshl_b32 s78, s78, 1
    s_add_u32 s6, s6, s78
    s_and_b32 s9, s3, 3
    s_cmp_lt_u32 s7, 4
    s_cselect_b32 s10, 0, 1
    s_cselect_b32 s79, 8, 1
    s_cselect_b32 s12, 8, -8
    s_lshl_b32 s8, s7, s10
    s_add_u32 s8, s8, s12
    s_and_b32 s78, s4, 1
    s_lshl_b32 s78, s78, 2
    s_add_u32 s8, s8, s78
    v_and_b32 v18, 15, v1
    v_lshrrev_b32 v19, 4, v1
    s_cmp_ge_u32 s3, 4
    s_cbranch_scc1 L_K
    s_lshr_b32 s78, s7, 1
    s_add_u32 s78, s78, s6
    s_and_b32 s78, s78, 3
    s_lshl_b32 s78, s78, 1
    s_and_b32 s10, s7, 1
    s_add_u32 s78, s78, s10
    s_lshl_b32 s10, s78, 7
    s_mul_i32 s11, s78, 221184
    s_mov_b32 s60, s11
    s_and_b32 s66, s8, 7
    s_mul_i32 s66, s66, 2592
    s_mul_i32 s13, s8, 144
    s_mul_i32 s78, s9, 55296
    s_add_u32 s13, s13, s78
    s_add_u32 s8, s8, s79
    s_mul_i32 s79, s79, 144
    s_add_u32 s61, s13, s79
    s_mul_i32 s15, s9, 2304
    s_movk_i32 s79, -144
    v_and_b32 v20, 7, v1
    v_xor_b32 v20, v20, v19
    v_lshrrev_b32_e64 v21, 3, v1
    v_mul_u32_u24 v21, 1152, v21
    v_lshl_add_u32 v2, v20, 4, v21
    v_xor_b32_e64 v20, 64, v2
    v_add_u32 v3, 8192, v20
    v_add_u32 v4, 16384, v2
    v_add_u32 v5, 24576, v20
    s_lshl_b32 s12, s6, 2
    s_add_u32 s12, s12, s9
    s_mul_i32 s12, s12, 36864
    s_lshl_b32 s14, s9, 12
    s_mov_b32 s42, 2359296
    s_mov_b32 s43, 0x20000
    s_mov_b32 s46, 1990656
    s_mov_b32 s47, 0x20000
    s_waitcnt lgkmcnt(0)
    s_mov_b32 s40, s16
    s_and_b32 s41, s17, 0xffff
    s_mov_b32 s44, s18
    s_and_b32 s45, s19, 0xffff
    s_movk_i32 s78, -144
    s_add_u32 m0, s14, 0
    s_add_u32 s79, s12, s10
    buffer_load_dwordx4 v2, s[40:43], s79 offen lds
    buffer_load_dwordx4 v3, s[40:43], s79 offen offset:1024 lds
    s_add_u32 s10, s10, 128
    s_cmp_eq_u32 s10, 1152
    s_cselect_b32 s10, 0, s10
    buffer_load_dwordx4 v4, s[40:43], s79 offen offset:2048 lds
    buffer_load_dwordx4 v5, s[40:43], s79 offen offset:3072 lds
    s_cmp_ge_u32 s7, 4
    s_cbranch_scc1 L_VQ
    v_add_u32_e64 v20, 0, v1
    v_mul_u32_u24 v20, 7282, v20
    v_lshrrev_b32 v20, 16, v20
    v_and_b32 v21, 8, v20
    v_bfe_u32 v22, v20, 1, 2
    v_and_b32_e64 v23, 1, v20
    v_lshl_add_u32 v22, v23, 2, v22
    v_add_u32_e64 v21, v21, v22
    v_mul_u32_u24 v21, 3456, v21
    v_mad_i32_i24 v21, v20, s78, v21
    v_lshl_add_u32 v6, v1, 4, v21
    v_add_u32_e64 v20, 64, v1
    v_mul_u32_u24 v20, 7282, v20
    v_lshrrev_b32 v20, 16, v20
    v_and_b32 v21, 8, v20
    v_bfe_u32 v22, v20, 1, 2
    v_and_b32_e64 v23, 1, v20
    v_lshl_add_u32 v22, v23, 2, v22
    v_add_u32_e64 v21, v21, v22
    v_mul_u32_u24 v21, 3456, v21
    v_mad_i32_i24 v21, v20, s78, v21
    v_lshl_add_u32 v7, v1, 4, v21
    v_add_u32 v20, 128, v1
    v_mul_u32_u24 v20, 7282, v20
    v_lshrrev_b32 v20, 16, v20
    v_and_b32 v21, 8, v20
    v_bfe_u32 v22, v20, 1, 2
    v_and_b32_e64 v23, 1, v20
    v_lshl_add_u32 v22, v23, 2, v22
    v_add_u32_e64 v21, v21, v22
    v_mul_u32_u24 v21, 3456, v21
    v_mad_i32_i24 v21, v20, s78, v21
    v_lshl_add_u32 v8, v1, 4, v21
    s_add_u32 m0, s15, 32768
    s_add_u32 s79, s13, s11
    buffer_load_dwordx4 v6, s[44:47], s79 offen lds
    buffer_load_dwordx4 v7, s[44:47], s79 offen offset:1024 lds
    s_add_u32 s11, s11, 221184
    s_cmp_eq_u32 s11, 1990656
    s_cselect_b32 s11, 0, s11
    s_mov_b64 exec, 0xffff
    buffer_load_dwordx4 v8, s[44:47], s79 offen offset:2048 lds
    s_mov_b64 exec, -1
    s_mov_b32 s68, s20
    s_and_b32 s69, s21, 0xffff
    s_mov_b32 s70, 20736
    s_mov_b32 s71, 0x20000
    s_mul_i32 s78, s9, 192
    v_add_u32 v20, s78, v1
    v_add_u32 v20, 0, v20
    v_mul_u32_u24 v21, 6554, v20
    v_lshrrev_b32 v21, 16, v21
    v_sub_u32 v20, v20, v21
    v_lshlrev_b32 v253, 2, v20
    v_add_u32 v20, s78, v1
    v_add_u32_e64 v20, 64, v20
    v_mul_u32_u24 v21, 6554, v20
    v_lshrrev_b32 v21, 16, v21
    v_sub_u32 v20, v20, v21
    v_lshlrev_b32 v254, 2, v20
    v_add_u32 v20, s78, v1
    v_add_u32 v20, 128, v20
    v_mul_u32_u24 v21, 6554, v20
    v_lshrrev_b32 v21, 16, v21
    v_sub_u32 v20, v20, v21
    v_lshlrev_b32_e64 v255, 2, v20
    s_mul_i32 s67, s9, 768
    s_add_u32 s67, s67, 159744
    s_add_u32 m0, s67, 0
    s_nop 0
    buffer_load_dword v253, s[68:71], s66 offen lds
    s_add_u32 m0, s67, 256
    s_nop 0
    buffer_load_dword v254, s[68:71], s66 offen lds
    s_add_u32 m0, s67, 512
    s_nop 0
    buffer_load_dword v255, s[68:71], s66 offen lds
    s_add_u32 s66, s66, 2592
    s_mov_b32 s48, s38
    s_and_b32 s49, s39, 0xffff
    s_mov_b32 s50, 10428416
    s_mov_b32 s51, 0x20000
    s_mov_b32 s56, s34
    s_and_b32 s57, s35, 0xffff
    s_mov_b32 s58, 4718592
    s_mov_b32 s59, 0x20000
    v_bfe_u32 v20, v1, 2, 2
    v_lshl_add_u32 v20, v19, 2, v20
    v_mul_u32_u24 v20, 288, v20
    v_add_u32 v20, 76800, v20
    v_and_b32_e64 v21, 3, v1
    v_lshl_add_u32 v9, v21, 3, v20
    v_and_b32_e64 v21, 1, v1
    v_lshl_add_u32 v10, v21, 3, v20
    v_lshrrev_b32 v20, 1, v18
    v_xor_b32 v20, v20, v19
    v_lshlrev_b32_e64 v20, 4, v20
    v_lshl_add_u32 v20, v18, 7, v20
    s_lshl_b32 s78, s9, 12
    v_add_u32 v11, s78, v20
    v_xor_b32_e64 v12, 64, v11
    s_mul_i32 s62, s5, 86
    s_lshr_b32 s62, s62, 8
    s_mul_i32 s63, s62, 3
    s_sub_u32 s63, s5, s63
    s_lshl_b32 s78, s4, 3
    s_add_u32 s62, s62, s78
    s_mul_i32 s64, s5, 43
    s_lshr_b32 s64, s64, 8
    s_mul_i32 s65, s64, 6
    s_sub_u32 s65, s5, s65
    s_lshl_b32 s78, s4, 2
    s_add_u32 s64, s64, s78
    s_lshl_b32 s32, s63, 3
    s_add_u32 s32, s32, s3
    s_mul_i32 s32, s32, 27648
    s_add_u32 s32, s32, 9764864
    v_lshlrev_b32 v124, 4, v1
    s_mul_i32 s33, s9, 1792
    s_add_u32 s33, s33, 4096
    v_min_u32 v20, 13, v1
    v_lshlrev_b32 v125, 7, v20
    v_min_u32 v20, 53, v1
    v_lshlrev_b32 v127, 7, v20
    s_min_u32 s78, s65, 4
    s_cmp_lt_u32 s65, 4
    s_cselect_b32 s72, 3, 2
    s_mul_i32 s65, s65, 10
    s_add_u32 s65, s65, s78
    s_add_u32 s65, s65, s3
    s_cmp_lt_u32 s3, s72
    s_cselect_b32 s19, 1, 0
    s_mul_i32 s16, s64, 98304
    s_lshl_b32 s78, s65, 9
    s_add_u32 s16, s16, s78
    s_add_u32 s16, s16, 1114112
    s_add_u32 s17, s16, 32768
    s_add_u32 s18, s16, 65536
    v_and_b32 v20, 31, v1
    v_lshlrev_b32 v128, 4, v20
    s_lshl_b32 s78, s19, 12
    v_add_u32 v129, s78, v128
    s_mov_b32 s72, 0x39852410
    s_mov_b32 s73, 0xc6
    s_bitcmp1_b32 s64, 0
    s_cselect_b32 s72, 0x26985410, s72
    s_cselect_b32 s73, 0xc3, s73
    s_lshl_b32 s78, s3, 4
    v_add_u32_e64 v20, s78, v18
    v_mul_u32_u24 v21, 1920, v19
    v_lshl_add_u32 v130, v20, 4, v21
    v_mul_u32_u24 v21, 3277, v20
    v_lshrrev_b32 v21, 16, v21
    v_mul_u32_u24 v24, 20, v21
    v_sub_u32 v24, v20, v24
    v_lshrrev_b32 v20, 1, v24
    v_lshlrev_b32_e64 v20, 2, v20
    v_lshrrev_b64 v[22:23], v20, s[72:73]
    v_and_b32 v22, 15, v22
    v_and_b32 v23, 1, v24
    v_lshl_add_u32 v22, v22, 1, v23
    v_mul_u32_u24 v22, 112, v22
    v_cmp_lt_u32 vcc, 2, v21
    v_mul_u32_u24 v23, 12, v21
    v_lshl_add_u32 v22, v19, 2, v22
    v_cndmask_b32 v20, 0, 12, vcc
    v_add3_u32 v22, v22, v23, v20
    v_add_u32 v131, 132096, v22
    v_cmp_gt_u32 vcc, 19, v24
    v_cmp_gt_u32 s[72:73], 6, v21
    s_nop 0
    s_and_b64 s[24:25], vcc, s[72:73]
    s_mov_b32 s26, s24
    s_and_b32 s27, s25, 0xffff
    s_mul_i32 s20, s64, 30720
    s_add_u32 s20, s20, 65536
    s_add_u32 s21, s20, 7680
    s_add_u32 s22, s20, 15360
    s_add_u32 s23, s20, 23040
    v_and_b32 v20, 1, v1
    v_lshlrev_b32 v20, 4, v20
    s_movk_i32 s78, 0x3f80
    v_lshlrev_b32_e64 v20, v20, s78
    v_bfe_u32 v21, v1, 1, 3
    v_cmp_eq_u32 vcc, 0, v21
    s_nop 1
    v_cndmask_b32 v136, 0, v20, vcc
    v_cmp_eq_u32 vcc, 2, v21
    s_nop 1
    v_cndmask_b32 v137, 0, v20, vcc
    v_cmp_eq_u32 vcc, 4, v21
    s_nop 1
    v_cndmask_b32 v138, 0, v20, vcc
    v_mov_b32 v139, 0
    v_and_b32 v20, 31, v1
    v_lshrrev_b32 v21, 5, v1
    v_cmp_eq_u32 vcc, 28, v20
    v_mul_u32_u24 v23, 48, v21
    s_nop 0
    v_cndmask_b32 v22, v20, 24, vcc
    v_mul_u32_u24 v22, 112, v22
    v_add_u32 v22, 132096, v22
    v_add_u32_e64 v132, v22, v23
    v_lshl_add_u32 v133, v21, 10, v128
    v_lshlrev_b32_e64 v21, 15, v21
    v_or_b32 v134, 0x3f80, v21
    v_lshlrev_b32 v135, 16, v134
    s_lshl_b32 s28, s65, 5
    s_add_u32 s28, s28, s64
    s_mul_i32 s28, s28, 1536
    s_add_u32 s28, s28, 4259840
    s_add_u32 s29, s28, 393216
    s_mov_b32 s77, 0
    v_mov_b32 v25, 162880
    v_mov_b32 v26, 1
    v_bfrev_b32 v27, 1
    s_add_u32 m0, s15, 76800
    s_add_u32 s79, s61, s60
    buffer_load_dwordx4 v6, s[44:47], s79 offen lds
    buffer_load_dwordx4 v7, s[44:47], s79 offen offset:1024 lds
    s_add_u32 s60, s60, 221184
    s_cmp_eq_u32 s60, 1990656
    s_cselect_b32 s60, 0, s60
    s_mov_b64 exec, 0xffff
    buffer_load_dwordx4 v8, s[44:47], s79 offen offset:2048 lds
    s_mov_b64 exec, -1
    s_add_u32 m0, s14, 16384
    s_add_u32 s79, s12, s10
    buffer_load_dwordx4 v2, s[40:43], s79 offen lds
    buffer_load_dwordx4 v3, s[40:43], s79 offen offset:1024 lds
    s_add_u32 s10, s10, 128
    s_cmp_eq_u32 s10, 1152
    s_cselect_b32 s10, 0, s10
    buffer_load_dwordx4 v4, s[40:43], s79 offen offset:2048 lds
    buffer_load_dwordx4 v5, s[40:43], s79 offen offset:3072 lds
    s_add_u32 m0, s15, 41984
    s_add_u32 s79, s13, s11
    buffer_load_dwordx4 v6, s[44:47], s79 offen lds
    buffer_load_dwordx4 v7, s[44:47], s79 offen offset:1024 lds
    s_add_u32 s11, s11, 221184
    s_cmp_eq_u32 s11, 1990656
    s_cselect_b32 s11, 0, s11
    s_mov_b64 exec, 0xffff
    buffer_load_dwordx4 v8, s[44:47], s79 offen offset:2048 lds
    s_mov_b64 exec, -1
    s_waitcnt vmcnt(7) lgkmcnt(0)
    s_barrier
    ds_read_b128 v[108:111], v11 offset:0
    ds_read_b128 v[112:115], v11 offset:2048
    ds_read_b128 v[116:119], v12 offset:0
    ds_read_b128 v[120:123], v12 offset:2048
    ds_read_b64_tr_b16 v[68:69], v9 offset:0
    ds_read_b64_tr_b16 v[70:71], v9 offset:144
    ds_read_b64_tr_b16 v[72:73], v9 offset:32
    ds_read_b64_tr_b16 v[74:75], v9 offset:176
    ds_read_b64_tr_b16 v[76:77], v9 offset:64
    ds_read_b64_tr_b16 v[78:79], v9 offset:208
    ds_read_b64_tr_b16 v[80:81], v9 offset:96
    ds_read_b64_tr_b16 v[82:83], v9 offset:240
    ds_read_b64_tr_b16 v[84:85], v10 offset:128
    ds_read_b64_tr_b16 v[86:87], v10 offset:272
    s_add_u32 m0, s15, 86016
    s_add_u32 s79, s61, s60
    buffer_load_dwordx4 v6, s[44:47], s79 offen lds
    buffer_load_dwordx4 v7, s[44:47], s79 offen offset:1024 lds
    s_add_u32 s60, s60, 221184
    s_cmp_eq_u32 s60, 1990656
    s_cselect_b32 s60, 0, s60
    s_mov_b64 exec, 0xffff
    buffer_load_dwordx4 v8, s[44:47], s79 offen offset:2048 lds
    s_mov_b64 exec, -1
    s_add_u32 m0, s14, 51200
    s_add_u32 s79, s12, s10
    buffer_load_dwordx4 v2, s[40:43], s79 offen lds
    buffer_load_dwordx4 v3, s[40:43], s79 offen offset:1024 lds
    s_add_u32 s10, s10, 128
    s_cmp_eq_u32 s10, 1152
    s_cselect_b32 s10, 0, s10
    buffer_load_dwordx4 v4, s[40:43], s79 offen offset:2048 lds
    buffer_load_dwordx4 v5, s[40:43], s79 offen offset:3072 lds
    s_add_u32 m0, s15, 67584
    s_add_u32 s79, s13, s11
    buffer_load_dwordx4 v6, s[44:47], s79 offen lds
    buffer_load_dwordx4 v7, s[44:47], s79 offen offset:1024 lds
    s_add_u32 s11, s11, 221184
    s_cmp_eq_u32 s11, 1990656
    s_cselect_b32 s11, 0, s11
    s_mov_b64 exec, 0xffff
    buffer_load_dwordx4 v8, s[44:47], s79 offen offset:2048 lds
    s_mov_b64 exec, -1
    s_waitcnt vmcnt(10) lgkmcnt(0)
    s_barrier
    ds_read_b128 v[140:143], v11 offset:16384
    ds_read_b128 v[144:147], v11 offset:18432
    ds_read_b128 v[148:151], v12 offset:16384
    ds_read_b128 v[152:155], v12 offset:18432
    s_add_u32 m0, s14, 0
    s_add_u32 s79, s12, s10
    buffer_load_dwordx4 v2, s[40:43], s79 offen lds
    buffer_load_dwordx4 v3, s[40:43], s79 offen offset:1024 lds
    s_add_u32 s10, s10, 128
    s_cmp_eq_u32 s10, 1152
    s_cselect_b32 s10, 0, s10
    buffer_load_dwordx4 v4, s[40:43], s79 offen offset:2048 lds
    buffer_load_dwordx4 v5, s[40:43], s79 offen offset:3072 lds
    v_mfma_f32_16x16x32_bf16 v[28:31], v[68:71], v[108:111], 0
    ds_read_b64_tr_b16 v[88:89], v9 offset:4608
    ds_read_b64_tr_b16 v[90:91], v9 offset:4752
    v_mfma_f32_16x16x32_bf16 v[48:51], v[68:71], v[112:115], 0
    ds_read_b64_tr_b16 v[92:93], v9 offset:4640
    ds_read_b64_tr_b16 v[94:95], v9 offset:4784
    s_add_u32 m0, s15, 32768
    s_add_u32 s79, s13, s11
    buffer_load_dwordx4 v6, s[44:47], s79 offen lds
    v_mfma_f32_16x16x32_bf16 v[32:35], v[72:75], v[108:111], 0
    ds_read_b64_tr_b16 v[96:97], v9 offset:4672
    ds_read_b64_tr_b16 v[98:99], v9 offset:4816
    v_mfma_f32_16x16x32_bf16 v[52:55], v[72:75], v[112:115], 0
    ds_read_b64_tr_b16 v[100:101], v9 offset:4704
    ds_read_b64_tr_b16 v[102:103], v9 offset:4848
    v_mfma_f32_16x16x32_bf16 v[36:39], v[76:79], v[108:111], 0
    ds_read_b64_tr_b16 v[104:105], v10 offset:4736
    ds_read_b64_tr_b16 v[106:107], v10 offset:4880
    buffer_load_dwordx4 v7, s[44:47], s79 offen offset:1024 lds
    s_add_u32 s11, s11, 221184
    s_cmp_eq_u32 s11, 1990656
    s_cselect_b32 s11, 0, s11
    v_mfma_f32_16x16x32_bf16 v[56:59], v[76:79], v[112:115], 0
    v_mfma_f32_16x16x32_bf16 v[40:43], v[80:83], v[108:111], 0
    v_mfma_f32_16x16x32_bf16 v[60:63], v[80:83], v[112:115], 0
    v_mfma_f32_16x16x32_bf16 v[44:47], v[84:87], v[108:111], 0
    s_mov_b64 exec, 0xffff
    buffer_load_dwordx4 v8, s[44:47], s79 offen offset:2048 lds
    s_mov_b64 exec, -1
    v_mfma_f32_16x16x32_bf16 v[64:67], v[84:87], v[112:115], 0
    s_waitcnt vmcnt(7) lgkmcnt(0)
    s_barrier
    ds_read_b128 v[156:159], v11 offset:51200
    ds_read_b128 v[160:163], v11 offset:53248
    ds_read_b128 v[164:167], v12 offset:51200
    ds_read_b128 v[168:171], v12 offset:53248
    s_add_u32 m0, s14, 16384
    s_add_u32 s79, s12, s10
    buffer_load_dwordx4 v2, s[40:43], s79 offen lds
    buffer_load_dwordx4 v3, s[40:43], s79 offen offset:1024 lds
    s_add_u32 s10, s10, 128
    s_cmp_eq_u32 s10, 1152
    s_cselect_b32 s10, 0, s10
    buffer_load_dwordx4 v4, s[40:43], s79 offen offset:2048 lds
    buffer_load_dwordx4 v5, s[40:43], s79 offen offset:3072 lds
    v_mfma_f32_16x16x32_bf16 v[28:31], v[88:91], v[116:119], v[28:31]
    ds_read_b64_tr_b16 v[68:69], v9 offset:9216
    ds_read_b64_tr_b16 v[70:71], v9 offset:9360
    v_mfma_f32_16x16x32_bf16 v[48:51], v[88:91], v[120:123], v[48:51]
    ds_read_b64_tr_b16 v[72:73], v9 offset:9248
    ds_read_b64_tr_b16 v[74:75], v9 offset:9392
    s_add_u32 m0, s15, 41984
    s_add_u32 s79, s13, s11
    buffer_load_dwordx4 v6, s[44:47], s79 offen lds
    v_mfma_f32_16x16x32_bf16 v[32:35], v[92:95], v[116:119], v[32:35]
    ds_read_b64_tr_b16 v[76:77], v9 offset:9280
    ds_read_b64_tr_b16 v[78:79], v9 offset:9424
    v_mfma_f32_16x16x32_bf16 v[52:55], v[92:95], v[120:123], v[52:55]
    ds_read_b64_tr_b16 v[80:81], v9 offset:9312
    ds_read_b64_tr_b16 v[82:83], v9 offset:9456
    v_mfma_f32_16x16x32_bf16 v[36:39], v[96:99], v[116:119], v[36:39]
    s_nop 0
    ds_read_b64_tr_b16 v[84:85], v10 offset:9344
    ds_read_b64_tr_b16 v[86:87], v10 offset:9488
    buffer_load_dwordx4 v7, s[44:47], s79 offen offset:1024 lds
    s_add_u32 s11, s11, 221184
    s_cmp_eq_u32 s11, 1990656
    s_cselect_b32 s11, 0, s11
    v_mfma_f32_16x16x32_bf16 v[56:59], v[96:99], v[120:123], v[56:59]
    v_mfma_f32_16x16x32_bf16 v[40:43], v[100:103], v[116:119], v[40:43]
    v_mfma_f32_16x16x32_bf16 v[60:63], v[100:103], v[120:123], v[60:63]
    v_mfma_f32_16x16x32_bf16 v[44:47], v[104:107], v[116:119], v[44:47]
    s_mov_b64 exec, 0xffff
    buffer_load_dwordx4 v8, s[44:47], s79 offen offset:2048 lds
    s_mov_b64 exec, -1
    v_mfma_f32_16x16x32_bf16 v[64:67], v[104:107], v[120:123], v[64:67]
    s_load_dword s76, s[38:39], 0
    s_waitcnt vmcnt(7) lgkmcnt(0)
    s_barrier
    ds_read_b128 v[172:175], v11 offset:0
    ds_read_b128 v[176:179], v11 offset:2048
    ds_read_b128 v[180:183], v12 offset:0
    ds_read_b128 v[184:187], v12 offset:2048
    s_add_u32 m0, s14, 51200
    s_add_u32 s79, s12, s10
    buffer_load_dwordx4 v2, s[40:43], s79 offen lds
    buffer_load_dwordx4 v3, s[40:43], s79 offen offset:1024 lds
    s_add_u32 s10, s10, 128
    s_cmp_eq_u32 s10, 1152
    s_cselect_b32 s10, 0, s10
    buffer_load_dwordx4 v4, s[40:43], s79 offen offset:2048 lds
    buffer_load_dwordx4 v5, s[40:43], s79 offen offset:3072 lds
    v_mfma_f32_16x16x32_bf16 v[28:31], v[68:71], v[140:143], v[28:31]
    ds_read_b64_tr_b16 v[88:89], v9 offset:13824
    ds_read_b64_tr_b16 v[90:91], v9 offset:13968
    v_mfma_f32_16x16x32_bf16 v[48:51], v[68:71], v[144:147], v[48:51]
    ds_read_b64_tr_b16 v[92:93], v9 offset:13856
    ds_read_b64_tr_b16 v[94:95], v9 offset:14000
    s_add_u32 m0, s15, 67584
    s_add_u32 s79, s13, s11
    buffer_load_dwordx4 v6, s[44:47], s79 offen lds
    v_mfma_f32_16x16x32_bf16 v[32:35], v[72:75], v[140:143], v[32:35]
    ds_read_b64_tr_b16 v[96:97], v9 offset:13888
    ds_read_b64_tr_b16 v[98:99], v9 offset:14032
    v_mfma_f32_16x16x32_bf16 v[52:55], v[72:75], v[144:147], v[52:55]
    ds_read_b64_tr_b16 v[100:101], v9 offset:13920
    ds_read_b64_tr_b16 v[102:103], v9 offset:14064
    v_mfma_f32_16x16x32_bf16 v[36:39], v[76:79], v[140:143], v[36:39]
    ds_read_b64_tr_b16 v[104:105], v10 offset:13952
    ds_read_b64_tr_b16 v[106:107], v10 offset:14096
    buffer_load_dwordx4 v7, s[44:47], s79 offen offset:1024 lds
    s_add_u32 s11, s11, 221184
    s_cmp_eq_u32 s11, 1990656
    s_cselect_b32 s11, 0, s11
    v_mfma_f32_16x16x32_bf16 v[56:59], v[76:79], v[144:147], v[56:59]
    v_mfma_f32_16x16x32_bf16 v[40:43], v[80:83], v[140:143], v[40:43]
    v_mfma_f32_16x16x32_bf16 v[60:63], v[80:83], v[144:147], v[60:63]
    v_mfma_f32_16x16x32_bf16 v[44:47], v[84:87], v[140:143], v[44:47]
    s_mov_b64 exec, 0xffff
    buffer_load_dwordx4 v8, s[44:47], s79 offen offset:2048 lds
    s_mov_b64 exec, -1
    v_mfma_f32_16x16x32_bf16 v[64:67], v[84:87], v[144:147], v[64:67]
    s_mul_i32 s76, s76, 0x9e3779b1
    s_add_u32 s76, s76, 0x7f4a7c15
    s_waitcnt vmcnt(7) lgkmcnt(0)
    s_barrier
    ds_read_b128 v[188:191], v11 offset:16384
    ds_read_b128 v[192:195], v11 offset:18432
    ds_read_b128 v[196:199], v12 offset:16384
    ds_read_b128 v[200:203], v12 offset:18432
    s_add_u32 m0, s14, 0
    s_add_u32 s79, s12, s10
    buffer_load_dwordx4 v2, s[40:43], s79 offen lds
    buffer_load_dwordx4 v3, s[40:43], s79 offen offset:1024 lds
    s_add_u32 s10, s10, 128
    s_cmp_eq_u32 s10, 1152
    s_cselect_b32 s10, 0, s10
    buffer_load_dwordx4 v4, s[40:43], s79 offen offset:2048 lds
    buffer_load_dwordx4 v5, s[40:43], s79 offen offset:3072 lds
    v_mfma_f32_16x16x32_bf16 v[28:31], v[88:91], v[148:151], v[28:31]
    v_mfma_f32_16x16x32_bf16 v[48:51], v[88:91], v[152:155], v[48:51]
    s_add_u32 m0, s15, 32768
    s_add_u32 s79, s13, s11
    buffer_load_dwordx4 v6, s[44:47], s79 offen lds
    v_mfma_f32_16x16x32_bf16 v[32:35], v[92:95], v[148:151], v[32:35]
    v_mfma_f32_16x16x32_bf16 v[52:55], v[92:95], v[152:155], v[52:55]
    v_mfma_f32_16x16x32_bf16 v[36:39], v[96:99], v[148:151], v[36:39]
    buffer_load_dwordx4 v7, s[44:47], s79 offen offset:1024 lds
    s_add_u32 s11, s11, 221184
    s_cmp_eq_u32 s11, 1990656
    s_cselect_b32 s11, 0, s11
    v_mfma_f32_16x16x32_bf16 v[56:59], v[96:99], v[152:155], v[56:59]
    v_mfma_f32_16x16x32_bf16 v[40:43], v[100:103], v[148:151], v[40:43]
    v_mfma_f32_16x16x32_bf16 v[60:63], v[100:103], v[152:155], v[60:63]
    v_mfma_f32_16x16x32_bf16 v[44:47], v[104:107], v[148:151], v[44:47]
    s_mov_b64 exec, 0xffff
    buffer_load_dwordx4 v8, s[44:47], s79 offen offset:2048 lds
    s_mov_b64 exec, -1
    v_mfma_f32_16x16x32_bf16 v[64:67], v[104:107], v[152:155], v[64:67]
    s_waitcnt vmcnt(7) lgkmcnt(0)
    s_barrier
    ds_read_b128 v[204:207], v11 offset:51200
    ds_read_b128 v[208:211], v11 offset:53248
    ds_read_b128 v[212:215], v12 offset:51200
    ds_read_b128 v[216:219], v12 offset:53248
    s_add_u32 m0, s14, 16384
    s_add_u32 s79, s12, s10
    buffer_load_dwordx4 v2, s[40:43], s79 offen lds
    buffer_load_dwordx4 v3, s[40:43], s79 offen offset:1024 lds
    s_add_u32 s10, s10, 128
    s_cmp_eq_u32 s10, 1152
    s_cselect_b32 s10, 0, s10
    buffer_load_dwordx4 v4, s[40:43], s79 offen offset:2048 lds
    buffer_load_dwordx4 v5, s[40:43], s79 offen offset:3072 lds
    s_add_u32 m0, s15, 41984
    s_add_u32 s79, s13, s11
    buffer_load_dwordx4 v6, s[44:47], s79 offen lds
    buffer_load_dwordx4 v7, s[44:47], s79 offen offset:1024 lds
    s_add_u32 s11, s11, 221184
    s_cmp_eq_u32 s11, 1990656
    s_cselect_b32 s11, 0, s11
    s_mov_b64 exec, 0xffff
    buffer_load_dwordx4 v8, s[44:47], s79 offen offset:2048 lds
    s_mov_b64 exec, -1
    s_waitcnt vmcnt(7) lgkmcnt(0)
    s_barrier
    ds_read_b128 v[220:223], v11 offset:0
    ds_read_b128 v[224:227], v11 offset:2048
    ds_read_b128 v[228:231], v12 offset:0
    ds_read_b128 v[232:235], v12 offset:2048
    s_add_u32 m0, s14, 51200
    s_add_u32 s79, s12, s10
    buffer_load_dwordx4 v2, s[40:43], s79 offen lds
    buffer_load_dwordx4 v3, s[40:43], s79 offen offset:1024 lds
    s_add_u32 s10, s10, 128
    s_cmp_eq_u32 s10, 1152
    s_cselect_b32 s10, 0, s10
    buffer_load_dwordx4 v4, s[40:43], s79 offen offset:2048 lds
    buffer_load_dwordx4 v5, s[40:43], s79 offen offset:3072 lds
    s_add_u32 m0, s15, 67584
    s_add_u32 s79, s13, s11
    buffer_load_dwordx4 v6, s[44:47], s79 offen lds
    buffer_load_dwordx4 v7, s[44:47], s79 offen offset:1024 lds
    s_add_u32 s11, s11, 221184
    s_cmp_eq_u32 s11, 1990656
    s_cselect_b32 s11, 0, s11
    s_mov_b64 exec, 0xffff
    buffer_load_dwordx4 v8, s[44:47], s79 offen offset:2048 lds
    s_mov_b64 exec, -1
    s_waitcnt vmcnt(7) lgkmcnt(0)
    s_barrier
    ds_read_b128 v[236:239], v11 offset:16384
    ds_read_b128 v[240:243], v11 offset:18432
    ds_read_b128 v[244:247], v12 offset:16384
    ds_read_b128 v[248:251], v12 offset:18432
    s_add_u32 m0, s15, 95232
    s_add_u32 s79, s61, s60
    buffer_load_dwordx4 v6, s[44:47], s79 offen lds
    buffer_load_dwordx4 v7, s[44:47], s79 offen offset:1024 lds
    s_add_u32 s60, s60, 221184
    s_cmp_eq_u32 s60, 1990656
    s_cselect_b32 s60, 0, s60
    s_mov_b64 exec, 0xffff
    buffer_load_dwordx4 v8, s[44:47], s79 offen offset:2048 lds
    s_mov_b64 exec, -1
    s_add_u32 m0, s15, 104448
    s_add_u32 s79, s61, s60
    buffer_load_dwordx4 v6, s[44:47], s79 offen lds
    buffer_load_dwordx4 v7, s[44:47], s79 offen offset:1024 lds
    s_add_u32 s60, s60, 221184
    s_cmp_eq_u32 s60, 1990656
    s_cselect_b32 s60, 0, s60
    s_mov_b64 exec, 0xffff
    buffer_load_dwordx4 v8, s[44:47], s79 offen offset:2048 lds
    s_mov_b64 exec, -1
    s_waitcnt vmcnt(6) lgkmcnt(0)
    s_barrier
    ds_read_b128 v[108:111], v11 offset:51200
    ds_read_b128 v[112:115], v11 offset:53248
    ds_read_b128 v[116:119], v12 offset:51200
    ds_read_b128 v[120:123], v12 offset:53248
    s_add_u32 m0, s15, 113664
    s_add_u32 s79, s61, s60
    buffer_load_dwordx4 v6, s[44:47], s79 offen lds
    buffer_load_dwordx4 v7, s[44:47], s79 offen offset:1024 lds
    s_add_u32 s60, s60, 221184
    s_cmp_eq_u32 s60, 1990656
    s_cselect_b32 s60, 0, s60
    s_mov_b64 exec, 0xffff
    buffer_load_dwordx4 v8, s[44:47], s79 offen offset:2048 lds
    s_mov_b64 exec, -1
    s_waitcnt vmcnt(6)
    s_mov_b64 exec, 1
    ds_add_u32 v25, v26 offset:0
    s_mov_b64 exec, -1
    ds_read_b32 v24, v25
    s_waitcnt lgkmcnt(0)
    v_readfirstlane_b32 s78, v24
    s_nop 0
    s_cmp_lt_u32 s78, 4
    s_cbranch_scc1 L_Vslow0
L_Vok0:
    ds_read_b64_tr_b16 v[68:69], v9 offset:18432
    ds_read_b64_tr_b16 v[70:71], v9 offset:18576
    ds_read_b64_tr_b16 v[72:73], v9 offset:18464
    ds_read_b64_tr_b16 v[74:75], v9 offset:18608
    ds_read_b64_tr_b16 v[76:77], v9 offset:18496
    ds_read_b64_tr_b16 v[78:79], v9 offset:18640
    ds_read_b64_tr_b16 v[80:81], v9 offset:18528
    ds_read_b64_tr_b16 v[82:83], v9 offset:18672
    ds_read_b64_tr_b16 v[84:85], v10 offset:18560
    ds_read_b64_tr_b16 v[86:87], v10 offset:18704
    s_waitcnt lgkmcnt(8)
    v_mfma_f32_16x16x32_bf16 v[28:31], v[68:71], v[156:159], v[28:31]
    ds_read_b64_tr_b16 v[88:89], v9 offset:23040
    ds_read_b64_tr_b16 v[90:91], v9 offset:23184
    v_mfma_f32_16x16x32_bf16 v[48:51], v[68:71], v[160:163], v[48:51]
    ds_read_b64_tr_b16 v[92:93], v9 offset:23072
    s_waitcnt vmcnt(3)
    s_mov_b64 exec, 1
    ds_add_u32 v25, v26 offset:0
    s_mov_b64 exec, -1
    s_waitcnt lgkmcnt(10)
    v_mfma_f32_16x16x32_bf16 v[32:35], v[72:75], v[156:159], v[32:35]
    ds_read_b64_tr_b16 v[94:95], v9 offset:23216
    v_mfma_f32_16x16x32_bf16 v[52:55], v[72:75], v[160:163], v[52:55]
    ds_read_b64_tr_b16 v[96:97], v9 offset:23104
    s_add_u32 m0, s15, 122880
    s_add_u32 s79, s61, s60
    buffer_load_dwordx4 v6, s[44:47], s79 offen lds
    s_waitcnt lgkmcnt(10)
    v_mfma_f32_16x16x32_bf16 v[36:39], v[76:79], v[156:159], v[36:39]
    ds_read_b64_tr_b16 v[98:99], v9 offset:23248
    v_mfma_f32_16x16x32_bf16 v[56:59], v[76:79], v[160:163], v[56:59]
    ds_read_b64_tr_b16 v[100:101], v9 offset:23136
    s_waitcnt lgkmcnt(10)
    v_mfma_f32_16x16x32_bf16 v[40:43], v[80:83], v[156:159], v[40:43]
    ds_read_b64_tr_b16 v[102:103], v9 offset:23280
    buffer_load_dwordx4 v7, s[44:47], s79 offen offset:1024 lds
    s_add_u32 s60, s60, 221184
    s_cmp_eq_u32 s60, 1990656
    s_cselect_b32 s60, 0, s60
    v_mfma_f32_16x16x32_bf16 v[60:63], v[80:83], v[160:163], v[60:63]
    ds_read_b64_tr_b16 v[104:105], v10 offset:23168
    s_waitcnt lgkmcnt(10)
    v_mfma_f32_16x16x32_bf16 v[44:47], v[84:87], v[156:159], v[44:47]
    ds_read_b64_tr_b16 v[106:107], v10 offset:23312
    s_mov_b64 exec, 0xffff
    buffer_load_dwordx4 v8, s[44:47], s79 offen offset:2048 lds
    s_mov_b64 exec, -1
    v_mfma_f32_16x16x32_bf16 v[64:67], v[84:87], v[160:163], v[64:67]
    ds_read_b32 v24, v25
    s_waitcnt lgkmcnt(10)
    v_mfma_f32_16x16x32_bf16 v[28:31], v[88:91], v[164:167], v[28:31]
    v_mfma_f32_16x16x32_bf16 v[48:51], v[88:91], v[168:171], v[48:51]
    s_waitcnt lgkmcnt(7)
    v_mfma_f32_16x16x32_bf16 v[32:35], v[92:95], v[164:167], v[32:35]
    s_add_u32 m0, s15, 132096
    s_add_u32 s79, s61, s60
    buffer_load_dwordx4 v6, s[44:47], s79 offen lds
    v_mfma_f32_16x16x32_bf16 v[52:55], v[92:95], v[168:171], v[52:55]
    s_waitcnt lgkmcnt(0)
    v_readfirstlane_b32 s78, v24
    s_nop 0
    s_cmp_lt_u32 s78, 8
    s_cbranch_scc1 L_Vslow1
L_Vok1:
    ds_read_b64_tr_b16 v[68:69], v9 offset:27648
    v_mfma_f32_16x16x32_bf16 v[36:39], v[96:99], v[164:167], v[36:39]
    ds_read_b64_tr_b16 v[70:71], v9 offset:27792
    ds_read_b64_tr_b16 v[72:73], v9 offset:27680
    v_mfma_f32_16x16x32_bf16 v[56:59], v[96:99], v[168:171], v[56:59]
    ds_read_b64_tr_b16 v[74:75], v9 offset:27824
    ds_read_b64_tr_b16 v[76:77], v9 offset:27712
    v_mfma_f32_16x16x32_bf16 v[40:43], v[100:103], v[164:167], v[40:43]
    ds_read_b64_tr_b16 v[78:79], v9 offset:27856
    ds_read_b64_tr_b16 v[80:81], v9 offset:27744
    v_mfma_f32_16x16x32_bf16 v[60:63], v[100:103], v[168:171], v[60:63]
    ds_read_b64_tr_b16 v[82:83], v9 offset:27888
    buffer_load_dwordx4 v7, s[44:47], s79 offen offset:1024 lds
    s_add_u32 s60, s60, 221184
    s_cmp_eq_u32 s60, 1990656
    s_cselect_b32 s60, 0, s60
    v_mfma_f32_16x16x32_bf16 v[44:47], v[104:107], v[164:167], v[44:47]
    ds_read_b64_tr_b16 v[84:85], v10 offset:27776
    v_mfma_f32_16x16x32_bf16 v[64:67], v[104:107], v[168:171], v[64:67]
    ds_read_b64_tr_b16 v[86:87], v10 offset:27920
    s_waitcnt lgkmcnt(8)
    v_mfma_f32_16x16x32_bf16 v[28:31], v[68:71], v[172:175], v[28:31]
    ds_read_b64_tr_b16 v[88:89], v9 offset:32256
    ds_read_b64_tr_b16 v[90:91], v9 offset:32400
    v_mfma_f32_16x16x32_bf16 v[48:51], v[68:71], v[176:179], v[48:51]
    ds_read_b64_tr_b16 v[92:93], v9 offset:32288
    s_waitcnt vmcnt(5)
    s_mov_b64 exec, 1
    ds_add_u32 v25, v26 offset:0
    s_mov_b64 exec, -1
    s_waitcnt lgkmcnt(10)
    v_mfma_f32_16x16x32_bf16 v[32:35], v[72:75], v[172:175], v[32:35]
    ds_read_b64_tr_b16 v[94:95], v9 offset:32432
    v_mfma_f32_16x16x32_bf16 v[52:55], v[72:75], v[176:179], v[52:55]
    ds_read_b64_tr_b16 v[96:97], v9 offset:32320
    s_mov_b64 exec, 0xffff
    buffer_load_dwordx4 v8, s[44:47], s79 offen offset:2048 lds
    s_mov_b64 exec, -1
    s_waitcnt lgkmcnt(10)
    v_mfma_f32_16x16x32_bf16 v[36:39], v[76:79], v[172:175], v[36:39]
    ds_read_b64_tr_b16 v[98:99], v9 offset:32464
    v_mfma_f32_16x16x32_bf16 v[56:59], v[76:79], v[176:179], v[56:59]
    ds_read_b64_tr_b16 v[100:101], v9 offset:32352
    s_waitcnt lgkmcnt(10)
    v_mfma_f32_16x16x32_bf16 v[40:43], v[80:83], v[172:175], v[40:43]
    ds_read_b64_tr_b16 v[102:103], v9 offset:32496
    buffer_load_dword v126, v125, s[48:51], s33 offen sc1
    v_mfma_f32_16x16x32_bf16 v[60:63], v[80:83], v[176:179], v[60:63]
    ds_read_b64_tr_b16 v[104:105], v10 offset:32384
    s_waitcnt lgkmcnt(10)
    v_mfma_f32_16x16x32_bf16 v[44:47], v[84:87], v[172:175], v[44:47]
    ds_read_b64_tr_b16 v[106:107], v10 offset:32528
    s_add_u32 m0, s15, 141312
    s_add_u32 s79, s61, s60
    buffer_load_dwordx4 v6, s[44:47], s79 offen lds
    v_mfma_f32_16x16x32_bf16 v[64:67], v[84:87], v[176:179], v[64:67]
    ds_read_b32 v24, v25
    s_waitcnt lgkmcnt(10)
    v_mfma_f32_16x16x32_bf16 v[28:31], v[88:91], v[180:183], v[28:31]
    v_mfma_f32_16x16x32_bf16 v[48:51], v[88:91], v[184:187], v[48:51]
    buffer_load_dwordx4 v7, s[44:47], s79 offen offset:1024 lds
    s_add_u32 s60, s60, 221184
    s_cmp_eq_u32 s60, 1990656
    s_cselect_b32 s60, 0, s60
    s_waitcnt lgkmcnt(7)
    v_mfma_f32_16x16x32_bf16 v[32:35], v[92:95], v[180:183], v[32:35]
    v_mfma_f32_16x16x32_bf16 v[52:55], v[92:95], v[184:187], v[52:55]
    s_waitcnt lgkmcnt(0)
    v_readfirstlane_b32 s78, v24
    s_nop 0
    s_cmp_lt_u32 s78, 12
    s_cbranch_scc1 L_Vslow2
L_Vok2:
    ds_read_b64_tr_b16 v[68:69], v9 offset:36864
    v_mfma_f32_16x16x32_bf16 v[36:39], v[96:99], v[180:183], v[36:39]
    ds_read_b64_tr_b16 v[70:71], v9 offset:37008
    ds_read_b64_tr_b16 v[72:73], v9 offset:36896
    s_mov_b64 exec, 0xffff
    buffer_load_dwordx4 v8, s[44:47], s79 offen offset:2048 lds
    s_mov_b64 exec, -1
    v_mfma_f32_16x16x32_bf16 v[56:59], v[96:99], v[184:187], v[56:59]
    ds_read_b64_tr_b16 v[74:75], v9 offset:37040
    ds_read_b64_tr_b16 v[76:77], v9 offset:36928
    v_mfma_f32_16x16x32_bf16 v[40:43], v[100:103], v[180:183], v[40:43]
    ds_read_b64_tr_b16 v[78:79], v9 offset:37072
    ds_read_b64_tr_b16 v[80:81], v9 offset:36960
    v_mfma_f32_16x16x32_bf16 v[60:63], v[100:103], v[184:187], v[60:63]
    ds_read_b64_tr_b16 v[82:83], v9 offset:37104
    v_mfma_f32_16x16x32_bf16 v[44:47], v[104:107], v[180:183], v[44:47]
    ds_read_b64_tr_b16 v[84:85], v10 offset:36992
    s_add_u32 m0, s15, 150528
    s_add_u32 s79, s61, s60
    buffer_load_dwordx4 v6, s[44:47], s79 offen lds
    v_mfma_f32_16x16x32_bf16 v[64:67], v[104:107], v[184:187], v[64:67]
    ds_read_b64_tr_b16 v[86:87], v10 offset:37136
    s_waitcnt lgkmcnt(8)
    v_mfma_f32_16x16x32_bf16 v[28:31], v[68:71], v[188:191], v[28:31]
    ds_read_b64_tr_b16 v[88:89], v9 offset:41472
    ds_read_b64_tr_b16 v[90:91], v9 offset:41616
    v_mfma_f32_16x16x32_bf16 v[48:51], v[68:71], v[192:195], v[48:51]
    ds_read_b64_tr_b16 v[92:93], v9 offset:41504
    s_waitcnt vmcnt(4)
L_Wchk1:
    v_cmp_ne_u32 vcc, s76, v126
    s_cbranch_vccnz L_Wretry1
L_Wok1:
    s_waitcnt lgkmcnt(9)
    v_mfma_f32_16x16x32_bf16 v[32:35], v[72:75], v[188:191], v[32:35]
    ds_read_b64_tr_b16 v[94:95], v9 offset:41648
    v_mfma_f32_16x16x32_bf16 v[52:55], v[72:75], v[192:195], v[52:55]
    ds_read_b64_tr_b16 v[96:97], v9 offset:41536
    s_mov_b64 exec, 1
    ds_add_u32 v25, v26 offset:0
    s_mov_b64 exec, -1
    s_waitcnt lgkmcnt(10)
    v_mfma_f32_16x16x32_bf16 v[36:39], v[76:79], v[188:191], v[36:39]
    ds_read_b64_tr_b16 v[98:99], v9 offset:41680
    v_mfma_f32_16x16x32_bf16 v[56:59], v[76:79], v[192:195], v[56:59]
    ds_read_b64_tr_b16 v[100:101], v9 offset:41568
    s_waitcnt lgkmcnt(10)
    v_mfma_f32_16x16x32_bf16 v[40:43], v[80:83], v[188:191], v[40:43]
    ds_read_b64_tr_b16 v[102:103], v9 offset:41712
    buffer_load_dwordx4 v7, s[44:47], s79 offen offset:1024 lds
    s_add_u32 s60, s60, 221184
    s_cmp_eq_u32 s60, 1990656
    s_cselect_b32 s60, 0, s60
    v_mfma_f32_16x16x32_bf16 v[60:63], v[80:83], v[192:195], v[60:63]
    ds_read_b64_tr_b16 v[104:105], v10 offset:41600
    s_waitcnt lgkmcnt(10)
    v_mfma_f32_16x16x32_bf16 v[44:47], v[84:87], v[188:191], v[44:47]
    ds_read_b64_tr_b16 v[106:107], v10 offset:41744
    s_mov_b64 exec, 0xffff
    buffer_load_dwordx4 v8, s[44:47], s79 offen offset:2048 lds
    s_mov_b64 exec, -1
    v_mfma_f32_16x16x32_bf16 v[64:67], v[84:87], v[192:195], v[64:67]
    ds_read_b32 v24, v25
    s_waitcnt lgkmcnt(10)
    v_mfma_f32_16x16x32_bf16 v[28:31], v[88:91], v[196:199], v[28:31]
    v_mfma_f32_16x16x32_bf16 v[48:51], v[88:91], v[200:203], v[48:51]
    s_waitcnt lgkmcnt(8)
    v_mfma_f32_16x16x32_bf16 v[32:35], v[92:95], v[196:199], v[32:35]
    v_mfma_f32_16x16x32_bf16 v[52:55], v[92:95], v[200:203], v[52:55]
    s_waitcnt lgkmcnt(0)
    v_readfirstlane_b32 s78, v24
    s_nop 0
    s_cmp_lt_u32 s78, 16
    s_cbranch_scc1 L_Vslow3
L_Vok3:
    ds_read_b64_tr_b16 v[68:69], v9 offset:46080
    v_mfma_f32_16x16x32_bf16 v[36:39], v[96:99], v[196:199], v[36:39]
    ds_read_b64_tr_b16 v[70:71], v9 offset:46224
    ds_read_b64_tr_b16 v[72:73], v9 offset:46112
    v_mfma_f32_16x16x32_bf16 v[56:59], v[96:99], v[200:203], v[56:59]
    ds_read_b64_tr_b16 v[74:75], v9 offset:46256
    ds_read_b64_tr_b16 v[76:77], v9 offset:46144
    v_mfma_f32_16x16x32_bf16 v[40:43], v[100:103], v[196:199], v[40:43]
    ds_read_b64_tr_b16 v[78:79], v9 offset:46288
    ds_read_b64_tr_b16 v[80:81], v9 offset:46176
    v_mfma_f32_16x16x32_bf16 v[60:63], v[100:103], v[200:203], v[60:63]
    ds_read_b64_tr_b16 v[82:83], v9 offset:46320
    v_mfma_f32_16x16x32_bf16 v[44:47], v[104:107], v[196:199], v[44:47]
    ds_read_b64_tr_b16 v[84:85], v10 offset:46208
    v_mfma_f32_16x16x32_bf16 v[64:67], v[104:107], v[200:203], v[64:67]
    ds_read_b64_tr_b16 v[86:87], v10 offset:46352
    s_waitcnt lgkmcnt(8)
    v_mfma_f32_16x16x32_bf16 v[28:31], v[68:71], v[204:207], v[28:31]
    ds_read_b64_tr_b16 v[88:89], v9 offset:50688
    v_mfma_f32_16x16x32_bf16 v[48:51], v[68:71], v[208:211], v[48:51]
    ds_read_b64_tr_b16 v[90:91], v9 offset:50832
    s_waitcnt lgkmcnt(8)
    v_mfma_f32_16x16x32_bf16 v[32:35], v[72:75], v[204:207], v[32:35]
    ds_read_b64_tr_b16 v[92:93], v9 offset:50720
    s_add_u32 s79, s32, 0
    buffer_load_dwordx4 v[140:143], v124, s[48:51], s79 offen sc1
    v_mfma_f32_16x16x32_bf16 v[52:55], v[72:75], v[208:211], v[52:55]
    ds_read_b64_tr_b16 v[94:95], v9 offset:50864
    s_waitcnt lgkmcnt(8)
    v_mfma_f32_16x16x32_bf16 v[36:39], v[76:79], v[204:207], v[36:39]
    ds_read_b64_tr_b16 v[96:97], v9 offset:50752
    v_mfma_f32_16x16x32_bf16 v[56:59], v[76:79], v[208:211], v[56:59]
    ds_read_b64_tr_b16 v[98:99], v9 offset:50896
    s_waitcnt lgkmcnt(8)
    v_mfma_f32_16x16x32_bf16 v[40:43], v[80:83], v[204:207], v[40:43]
    ds_read_b64_tr_b16 v[100:101], v9 offset:50784
    v_mfma_f32_16x16x32_bf16 v[60:63], v[80:83], v[208:211], v[60:63]
    ds_read_b64_tr_b16 v[102:103], v9 offset:50928
    s_add_u32 s79, s32, 1024
    buffer_load_dwordx4 v[144:147], v124, s[48:51], s79 offen sc1
    s_waitcnt lgkmcnt(8)
    v_mfma_f32_16x16x32_bf16 v[44:47], v[84:87], v[204:207], v[44:47]
    ds_read_b64_tr_b16 v[104:105], v10 offset:50816
    v_mfma_f32_16x16x32_bf16 v[64:67], v[84:87], v[208:211], v[64:67]
    ds_read_b64_tr_b16 v[106:107], v10 offset:50960
    s_waitcnt lgkmcnt(8)
    v_mfma_f32_16x16x32_bf16 v[28:31], v[88:91], v[212:215], v[28:31]
    v_add_u32 v9, 55296, v9
    v_add_u32 v10, 55296, v10
    ds_read_b64_tr_b16 v[68:69], v9 offset:0
    v_mfma_f32_16x16x32_bf16 v[48:51], v[88:91], v[216:219], v[48:51]
    ds_read_b64_tr_b16 v[70:71], v9 offset:144
    s_waitcnt vmcnt(2)
    s_mov_b64 exec, 1
    ds_add_u32 v25, v26 offset:0
    s_mov_b64 exec, -1
    s_waitcnt lgkmcnt(9)
    v_mfma_f32_16x16x32_bf16 v[32:35], v[92:95], v[212:215], v[32:35]
    ds_read_b64_tr_b16 v[72:73], v9 offset:32
    v_mfma_f32_16x16x32_bf16 v[52:55], v[92:95], v[216:219], v[52:55]
    ds_read_b64_tr_b16 v[74:75], v9 offset:176
    s_waitcnt lgkmcnt(9)
    v_mfma_f32_16x16x32_bf16 v[36:39], v[96:99], v[212:215], v[36:39]
    ds_read_b64_tr_b16 v[76:77], v9 offset:64
    s_add_u32 s79, s32, 2048
    buffer_load_dwordx4 v[148:151], v124, s[48:51], s79 offen sc1
    v_mfma_f32_16x16x32_bf16 v[56:59], v[96:99], v[216:219], v[56:59]
    ds_read_b64_tr_b16 v[78:79], v9 offset:208
    s_waitcnt lgkmcnt(9)
    v_mfma_f32_16x16x32_bf16 v[40:43], v[100:103], v[212:215], v[40:43]
    ds_read_b64_tr_b16 v[80:81], v9 offset:96
    v_mfma_f32_16x16x32_bf16 v[60:63], v[100:103], v[216:219], v[60:63]
    ds_read_b64_tr_b16 v[82:83], v9 offset:240
    s_waitcnt lgkmcnt(9)
    v_mfma_f32_16x16x32_bf16 v[44:47], v[104:107], v[212:215], v[44:47]
    ds_read_b64_tr_b16 v[84:85], v10 offset:128
    s_add_u32 s79, s32, 3072
    buffer_load_dwordx4 v[152:155], v124, s[48:51], s79 offen sc1
    v_mfma_f32_16x16x32_bf16 v[64:67], v[104:107], v[216:219], v[64:67]
    ds_read_b64_tr_b16 v[86:87], v10 offset:272
    s_waitcnt lgkmcnt(9)
    v_mfma_f32_16x16x32_bf16 v[28:31], v[68:71], v[220:223], v[28:31]
    ds_read_b64_tr_b16 v[88:89], v9 offset:4608
    ds_read_b64_tr_b16 v[90:91], v9 offset:4752
    v_mfma_f32_16x16x32_bf16 v[48:51], v[68:71], v[224:227], v[48:51]
    ds_read_b64_tr_b16 v[92:93], v9 offset:4640
    s_waitcnt lgkmcnt(9)
    v_mfma_f32_16x16x32_bf16 v[32:35], v[72:75], v[220:223], v[32:35]
    ds_read_b64_tr_b16 v[94:95], v9 offset:4784
    s_add_u32 s79, s32, 4096
    buffer_load_dwordx4 v[156:159], v124, s[48:51], s79 offen sc1
    v_mfma_f32_16x16x32_bf16 v[52:55], v[72:75], v[224:227], v[52:55]
    ds_read_b32 v24, v25
    s_waitcnt lgkmcnt(9)
    v_mfma_f32_16x16x32_bf16 v[36:39], v[76:79], v[220:223], v[36:39]
    ds_read_b64_tr_b16 v[96:97], v9 offset:4672
    v_mfma_f32_16x16x32_bf16 v[56:59], v[76:79], v[224:227], v[56:59]
    ds_read_b64_tr_b16 v[98:99], v9 offset:4816
    s_waitcnt lgkmcnt(9)
    v_mfma_f32_16x16x32_bf16 v[40:43], v[80:83], v[220:223], v[40:43]
    ds_read_b64_tr_b16 v[100:101], v9 offset:4704
    v_mfma_f32_16x16x32_bf16 v[60:63], v[80:83], v[224:227], v[60:63]
    ds_read_b64_tr_b16 v[102:103], v9 offset:4848
    s_add_u32 s79, s32, 5120
    buffer_load_dwordx4 v[160:163], v124, s[48:51], s79 offen sc1
    s_waitcnt lgkmcnt(9)
    v_mfma_f32_16x16x32_bf16 v[44:47], v[84:87], v[220:223], v[44:47]
    ds_read_b64_tr_b16 v[104:105], v10 offset:4736
    v_mfma_f32_16x16x32_bf16 v[64:67], v[84:87], v[224:227], v[64:67]
    ds_read_b64_tr_b16 v[106:107], v10 offset:4880
    s_waitcnt lgkmcnt(9)
    v_mfma_f32_16x16x32_bf16 v[28:31], v[88:91], v[228:231], v[28:31]
    s_waitcnt lgkmcnt(6)
    v_readfirstlane_b32 s78, v24
    s_nop 0
    s_cmp_lt_u32 s78, 20
    s_cbranch_scc1 L_Vslow4
L_Vok4:
    ds_read_b64_tr_b16 v[68:69], v9 offset:9216
    v_mfma_f32_16x16x32_bf16 v[48:51], v[88:91], v[232:235], v[48:51]
    ds_read_b64_tr_b16 v[70:71], v9 offset:9360
    v_mfma_f32_16x16x32_bf16 v[32:35], v[92:95], v[228:231], v[32:35]
    ds_read_b64_tr_b16 v[72:73], v9 offset:9248
    s_add_u32 s79, s32, 6144
    buffer_load_dwordx4 v[164:167], v124, s[48:51], s79 offen sc1
    v_mfma_f32_16x16x32_bf16 v[52:55], v[92:95], v[232:235], v[52:55]
    ds_read_b64_tr_b16 v[74:75], v9 offset:9392
    s_waitcnt lgkmcnt(8)
    v_mfma_f32_16x16x32_bf16 v[36:39], v[96:99], v[228:231], v[36:39]
    ds_read_b64_tr_b16 v[76:77], v9 offset:9280
    v_mfma_f32_16x16x32_bf16 v[56:59], v[96:99], v[232:235], v[56:59]
    ds_read_b64_tr_b16 v[78:79], v9 offset:9424
    s_waitcnt lgkmcnt(8)
    v_mfma_f32_16x16x32_bf16 v[40:43], v[100:103], v[228:231], v[40:43]
    ds_read_b64_tr_b16 v[80:81], v9 offset:9312
    v_mfma_f32_16x16x32_bf16 v[60:63], v[100:103], v[232:235], v[60:63]
    ds_read_b64_tr_b16 v[82:83], v9 offset:9456
    s_add_u32 s79, s32, 7168
    buffer_load_dwordx4 v[168:171], v124, s[48:51], s79 offen sc1
    s_waitcnt lgkmcnt(8)
    v_mfma_f32_16x16x32_bf16 v[44:47], v[104:107], v[228:231], v[44:47]
    ds_read_b64_tr_b16 v[84:85], v10 offset:9344
    v_mfma_f32_16x16x32_bf16 v[64:67], v[104:107], v[232:235], v[64:67]
    ds_read_b64_tr_b16 v[86:87], v10 offset:9488
    s_waitcnt lgkmcnt(8)
    v_mfma_f32_16x16x32_bf16 v[28:31], v[68:71], v[236:239], v[28:31]
    ds_read_b64_tr_b16 v[88:89], v9 offset:13824
    ds_read_b64_tr_b16 v[90:91], v9 offset:13968
    v_mfma_f32_16x16x32_bf16 v[48:51], v[68:71], v[240:243], v[48:51]
    ds_read_b64_tr_b16 v[92:93], v9 offset:13856
    s_waitcnt lgkmcnt(9)
    v_mfma_f32_16x16x32_bf16 v[32:35], v[72:75], v[236:239], v[32:35]
    ds_read_b64_tr_b16 v[94:95], v9 offset:14000
    s_add_u32 s79, s32, 8192
    buffer_load_dwordx4 v[172:175], v124, s[48:51], s79 offen sc1
    v_mfma_f32_16x16x32_bf16 v[52:55], v[72:75], v[240:243], v[52:55]
    ds_read_b64_tr_b16 v[96:97], v9 offset:13888
    s_waitcnt lgkmcnt(9)
    v_mfma_f32_16x16x32_bf16 v[36:39], v[76:79], v[236:239], v[36:39]
    ds_read_b64_tr_b16 v[98:99], v9 offset:14032
    v_mfma_f32_16x16x32_bf16 v[56:59], v[76:79], v[240:243], v[56:59]
    ds_read_b64_tr_b16 v[100:101], v9 offset:13920
    s_waitcnt lgkmcnt(9)
    v_mfma_f32_16x16x32_bf16 v[40:43], v[80:83], v[236:239], v[40:43]
    ds_read_b64_tr_b16 v[102:103], v9 offset:14064
    v_mfma_f32_16x16x32_bf16 v[60:63], v[80:83], v[240:243], v[60:63]
    ds_read_b64_tr_b16 v[104:105], v10 offset:13952
    s_add_u32 s79, s32, 9216
    buffer_load_dwordx4 v[176:179], v124, s[48:51], s79 offen sc1
    s_waitcnt lgkmcnt(9)
    v_mfma_f32_16x16x32_bf16 v[44:47], v[84:87], v[236:239], v[44:47]
    ds_read_b64_tr_b16 v[106:107], v10 offset:14096
    v_mfma_f32_16x16x32_bf16 v[64:67], v[84:87], v[240:243], v[64:67]
    ds_read_b32 v24, v25 offset:4
    s_waitcnt lgkmcnt(9)
    v_mfma_f32_16x16x32_bf16 v[28:31], v[88:91], v[244:247], v[28:31]
    ds_read_b64_tr_b16 v[68:69], v9 offset:18432
    v_mfma_f32_16x16x32_bf16 v[48:51], v[88:91], v[248:251], v[48:51]
    ds_read_b64_tr_b16 v[70:71], v9 offset:18576
    s_waitcnt lgkmcnt(9)
    v_mfma_f32_16x16x32_bf16 v[32:35], v[92:95], v[244:247], v[32:35]
    ds_read_b64_tr_b16 v[72:73], v9 offset:18464
    s_add_u32 s79, s32, 10240
    buffer_load_dwordx4 v[180:183], v124, s[48:51], s79 offen sc1
    v_mfma_f32_16x16x32_bf16 v[52:55], v[92:95], v[248:251], v[52:55]
    ds_read_b64_tr_b16 v[74:75], v9 offset:18608
    s_waitcnt lgkmcnt(9)
    v_mfma_f32_16x16x32_bf16 v[36:39], v[96:99], v[244:247], v[36:39]
    ds_read_b64_tr_b16 v[76:77], v9 offset:18496
    v_mfma_f32_16x16x32_bf16 v[56:59], v[96:99], v[248:251], v[56:59]
    ds_read_b64_tr_b16 v[78:79], v9 offset:18640
    s_waitcnt lgkmcnt(9)
    v_mfma_f32_16x16x32_bf16 v[40:43], v[100:103], v[244:247], v[40:43]
    ds_read_b64_tr_b16 v[80:81], v9 offset:18528
    v_mfma_f32_16x16x32_bf16 v[60:63], v[100:103], v[248:251], v[60:63]
    ds_read_b64_tr_b16 v[82:83], v9 offset:18672
    s_add_u32 s79, s32, 11264
    buffer_load_dwordx4 v[184:187], v124, s[48:51], s79 offen sc1
    s_waitcnt lgkmcnt(9)
    v_mfma_f32_16x16x32_bf16 v[44:47], v[104:107], v[244:247], v[44:47]
    ds_read_b64_tr_b16 v[84:85], v10 offset:18560
    v_mfma_f32_16x16x32_bf16 v[64:67], v[104:107], v[248:251], v[64:67]
    ds_read_b64_tr_b16 v[86:87], v10 offset:18704
    s_waitcnt lgkmcnt(8)
    v_mfma_f32_16x16x32_bf16 v[28:31], v[68:71], v[108:111], v[28:31]
    ds_read_b64_tr_b16 v[88:89], v9 offset:23040
    v_mfma_f32_16x16x32_bf16 v[48:51], v[68:71], v[112:115], v[48:51]
    ds_read_b64_tr_b16 v[90:91], v9 offset:23184
    v_readfirstlane_b32 s78, v24
    s_nop 0
    s_cmp_lt_u32 s78, 4
    s_cbranch_scc1 L_Vslow5
L_Vok5:
    s_waitcnt lgkmcnt(8)
    v_mfma_f32_16x16x32_bf16 v[32:35], v[72:75], v[108:111], v[32:35]
    ds_read_b64_tr_b16 v[92:93], v9 offset:23072
    v_mfma_f32_16x16x32_bf16 v[52:55], v[72:75], v[112:115], v[52:55]
    ds_read_b64_tr_b16 v[94:95], v9 offset:23216
    s_waitcnt lgkmcnt(8)
    v_mfma_f32_16x16x32_bf16 v[36:39], v[76:79], v[108:111], v[36:39]
    ds_read_b64_tr_b16 v[96:97], v9 offset:23104
    s_add_u32 s79, s32, 12288
    buffer_load_dwordx4 v[188:191], v124, s[48:51], s79 offen sc1
    v_mfma_f32_16x16x32_bf16 v[56:59], v[76:79], v[112:115], v[56:59]
    ds_read_b64_tr_b16 v[98:99], v9 offset:23248
    s_waitcnt lgkmcnt(8)
    v_mfma_f32_16x16x32_bf16 v[40:43], v[80:83], v[108:111], v[40:43]
    ds_read_b64_tr_b16 v[100:101], v9 offset:23136
    v_mfma_f32_16x16x32_bf16 v[60:63], v[80:83], v[112:115], v[60:63]
    ds_read_b64_tr_b16 v[102:103], v9 offset:23280
    s_waitcnt lgkmcnt(8)
    v_mfma_f32_16x16x32_bf16 v[44:47], v[84:87], v[108:111], v[44:47]
    ds_read_b64_tr_b16 v[104:105], v10 offset:23168
    s_add_u32 s79, s32, 13312
    buffer_load_dwordx4 v[192:195], v124, s[48:51], s79 offen sc1
    v_mfma_f32_16x16x32_bf16 v[64:67], v[84:87], v[112:115], v[64:67]
    ds_read_b64_tr_b16 v[106:107], v10 offset:23312
    s_waitcnt lgkmcnt(8)
    v_mfma_f32_16x16x32_bf16 v[28:31], v[88:91], v[116:119], v[28:31]
    v_mfma_f32_16x16x32_bf16 v[48:51], v[88:91], v[120:123], v[48:51]
    s_mul_i32 s78, s9, 4864
    s_add_u32 s78, s78, 51200
    v_mul_u32_u24 v20, 152, v18
    v_lshl_add_u32 v20, v19, 3, v20
    v_add_u32 v20, s78, v20
    v_cmp_eq_u32 vcc, 2, v19
    v_mov_b32 v21, 0x3f803f80
    s_waitcnt lgkmcnt(6)
    v_mfma_f32_16x16x32_bf16 v[32:35], v[92:95], v[116:119], v[32:35]
    v_mfma_f32_16x16x32_bf16 v[52:55], v[92:95], v[120:123], v[52:55]
    s_waitcnt lgkmcnt(4)
    v_mfma_f32_16x16x32_bf16 v[36:39], v[96:99], v[116:119], v[36:39]
    s_add_u32 s79, s32, 14336
    buffer_load_dwordx4 v[196:199], v124, s[48:51], s79 offen sc1
    v_mfma_f32_16x16x32_bf16 v[56:59], v[96:99], v[120:123], v[56:59]
    s_waitcnt lgkmcnt(2)
    v_mfma_f32_16x16x32_bf16 v[40:43], v[100:103], v[116:119], v[40:43]
    v_mfma_f32_16x16x32_bf16 v[60:63], v[100:103], v[120:123], v[60:63]
    s_waitcnt lgkmcnt(0)
    v_mfma_f32_16x16x32_bf16 v[44:47], v[104:107], v[116:119], v[44:47]
    s_add_u32 s79, s32, 15360
    buffer_load_dwordx4 v[200:203], v124, s[48:51], s79 offen sc1
    v_mfma_f32_16x16x32_bf16 v[64:67], v[104:107], v[120:123], v[64:67]
    v_cvt_pk_bf16_f32 v68, v28, v29
    v_cvt_pk_bf16_f32 v69, v30, v31
    s_nop 0
    ds_write_b64 v20, v[68:69] offset:0
    v_cvt_pk_bf16_f32 v78, v48, v49
    v_cvt_pk_bf16_f32 v79, v50, v51
    ds_write_b64 v20, v[78:79] offset:2432
    v_cvt_pk_bf16_f32 v70, v32, v33
    v_cvt_pk_bf16_f32 v71, v34, v35
    ds_write_b64 v20, v[70:71] offset:32
    v_cvt_pk_bf16_f32 v80, v52, v53
    v_cvt_pk_bf16_f32 v81, v54, v55
    ds_write_b64 v20, v[80:81] offset:2464
    v_cvt_pk_bf16_f32 v72, v36, v37
    v_cvt_pk_bf16_f32 v73, v38, v39
    ds_write_b64 v20, v[72:73] offset:64
    v_cvt_pk_bf16_f32 v82, v56, v57
    v_cvt_pk_bf16_f32 v83, v58, v59
    ds_write_b64 v20, v[82:83] offset:2496
    v_cvt_pk_bf16_f32 v74, v40, v41
    v_cvt_pk_bf16_f32 v75, v42, v43
    ds_write_b64 v20, v[74:75] offset:96
    v_cvt_pk_bf16_f32 v84, v60, v61
    v_cvt_pk_bf16_f32 v85, v62, v63
    ds_write_b64 v20, v[84:85] offset:2528
    v_cvt_pk_bf16_f32 v76, v44, v45
    v_cvt_pk_bf16_f32 v77, v46, v47
    v_cndmask_b32 v76, v76, v21, vcc
    v_cndmask_b32 v77, v77, v21, vcc
    s_mov_b32 exec_hi, 0xffff
    ds_write_b64 v20, v[76:77] offset:128
    v_cvt_pk_bf16_f32 v86, v64, v65
    v_cvt_pk_bf16_f32 v87, v66, v67
    v_cndmask_b32 v86, v86, v21, vcc
    v_cndmask_b32 v87, v87, v21, vcc
    ds_write_b64 v20, v[86:87] offset:2560
    s_mov_b32 exec_hi, -1
    s_waitcnt lgkmcnt(0)
    s_barrier
    buffer_load_dwordx4 v[28:31], v128, s[48:51], s16 offen sc1
    buffer_load_dwordx4 v[32:35], v128, s[48:51], s17 offen sc1
    buffer_load_dwordx4 v[36:39], v128, s[48:51], s18 offen sc1
    s_nop 0
    buffer_load_dwordx4 v[40:43], v129, s[48:51], s16 offen sc1
    buffer_load_dwordx4 v[44:47], v129, s[48:51], s17 offen sc1
    buffer_load_dwordx4 v[48:51], v129, s[48:51], s18 offen sc1
    s_add_u32 s79, s32, 16384
    buffer_load_dwordx4 v[204:207], v124, s[48:51], s79 offen sc1
    s_add_u32 s79, s32, 17408
    buffer_load_dwordx4 v[208:211], v124, s[48:51], s79 offen sc1
    s_add_u32 s79, s32, 18432
    buffer_load_dwordx4 v[212:215], v124, s[48:51], s79 offen sc1
    s_add_u32 s79, s32, 19456
    buffer_load_dwordx4 v[216:219], v124, s[48:51], s79 offen sc1
    s_add_u32 s79, s32, 20480
    buffer_load_dwordx4 v[220:223], v124, s[48:51], s79 offen sc1
    s_add_u32 s79, s32, 21504
    buffer_load_dwordx4 v[224:227], v124, s[48:51], s79 offen sc1
    s_add_u32 s79, s32, 22528
    buffer_load_dwordx4 v[228:231], v124, s[48:51], s79 offen sc1
    s_add_u32 s79, s32, 23552
    buffer_load_dwordx4 v[232:235], v124, s[48:51], s79 offen sc1
    s_add_u32 s79, s32, 24576
    buffer_load_dwordx4 v[236:239], v124, s[48:51], s79 offen sc1
    s_add_u32 s79, s32, 25600
    buffer_load_dwordx4 v[240:243], v124, s[48:51], s79 offen sc1
    s_add_u32 s79, s32, 26624
    buffer_load_dwordx4 v[244:247], v124, s[48:51], s79 offen sc1
    v_lshrrev_b32_e64 v20, 5, v1
    v_mul_u32_u24 v20, 3072, v20
    v_add_u32_e64 v2, v128, v20
    s_mul_i32 s14, s62, 49152
    s_mul_i32 s78, s3, 6144
    s_add_u32 s14, s14, s78
    s_add_u32 s14, s14, 4259840
    s_lshl_b32 s78, s3, 12
    s_add_u32 s78, s78, 76800
    v_lshl_add_u32 v3, v1, 4, s78
    s_lshr_b32 s78, s3, 2
    s_lshl_b32 s78, s78, 11
    s_and_b32 s72, s3, 1
    s_lshl_b32 s72, s72, 10
    s_add_u32 s78, s78, s72
    s_and_b32 s72, s3, 2
    s_lshl_b32 s72, s72, 2
    s_add_u32 s78, s78, s72
    s_add_u32 s78, s78, 109568
    v_lshl_add_u32 v4, v1, 4, s78
    s_lshr_b32 s72, s3, 2
    v_lshlrev_b32 v20, 9, v19
    v_lshl_add_u32 v20, v18, 4, v20
    s_lshl_b32 s78, s72, 14
    s_add_u32 s78, s78, 76800
    v_add_u32 v5, s78, v20
    s_lshl_b32 s78, s72, 11
    s_add_u32 s78, s78, 109568
    v_add_u32 v6, s78, v20
    s_mul_i32 s78, s72, 25088
    s_lshl_b32 s72, s9, 6
    s_add_u32 s78, s78, s72
    v_mul_u32_u24 v20, 784, v18
    v_lshl_add_u32 v20, v19, 4, v20
    v_add_u32 v7, s78, v20
    s_lshl_b32 s78, s62, 3
    s_add_u32 s78, s78, s3
    s_mul_i32 s15, s78, 9216
    s_mul_i32 s78, s63, 384
    s_add_u32 s15, s15, s78
    s_mul_i32 s78, s3, 3136
    v_add_u32_e64 v20, 0, v1
    v_mul_u32_u24 v21, 2731, v20
    v_lshrrev_b32 v21, 16, v21
    v_mul_u32_u24 v22, 24, v21
    v_sub_u32_e64 v20, v20, v22
    v_mul_u32_u24 v22, 784, v21
    v_lshl_add_u32 v22, v20, 5, v22
    v_add_u32_e64 v13, s78, v22
    v_mul_u32_u24 v22, 2304, v21
    v_lshl_add_u32 v15, v20, 4, v22
    v_add_u32_e64 v20, 64, v1
    v_mul_u32_u24 v21, 2731, v20
    v_lshrrev_b32 v21, 16, v21
    v_mul_u32_u24 v22, 24, v21
    v_sub_u32_e64 v20, v20, v22
    v_mul_u32_u24 v22, 784, v21
    v_lshl_add_u32 v22, v20, 5, v22
    v_add_u32_e64 v14, s78, v22
    v_mul_u32_u24 v22, 2304, v21
    v_lshl_add_u32 v16, v20, 4, v22
    s_branch L_TV
L_Vslow0:
L_Vspin0:
    ds_read_b32 v24, v25 offset:0
    s_add_u32 s77, s77, 1
    s_waitcnt lgkmcnt(0)
    v_readfirstlane_b32 s78, v24
    s_cmp_ge_u32 s77, 32768
    s_cbranch_scc1 L_Vok0
    s_cmp_lt_u32 s78, 4
    s_cbranch_scc1 L_Vspin0
    s_branch L_Vok0
L_Vslow1:
L_Vspin1:
    ds_read_b32 v24, v25 offset:0
    s_add_u32 s77, s77, 1
    s_waitcnt lgkmcnt(0)
    v_readfirstlane_b32 s78, v24
    s_cmp_ge_u32 s77, 32768
    s_cbranch_scc1 L_Vok1
    s_cmp_lt_u32 s78, 8
    s_cbranch_scc1 L_Vspin1
    s_branch L_Vok1
L_Vslow2:
L_Vspin2:
    ds_read_b32 v24, v25 offset:0
    s_add_u32 s77, s77, 1
    s_waitcnt lgkmcnt(0)
    v_readfirstlane_b32 s78, v24
    s_cmp_ge_u32 s77, 32768
    s_cbranch_scc1 L_Vok2
    s_cmp_lt_u32 s78, 12
    s_cbranch_scc1 L_Vspin2
    s_branch L_Vok2
L_Vslow3:
L_Vspin3:
    ds_read_b32 v24, v25 offset:0
    s_add_u32 s77, s77, 1
    s_waitcnt lgkmcnt(0)
    v_readfirstlane_b32 s78, v24
    s_cmp_ge_u32 s77, 32768
    s_cbranch_scc1 L_Vok3
    s_cmp_lt_u32 s78, 16
    s_cbranch_scc1 L_Vspin3
    s_branch L_Vok3
L_Vslow4:
L_Vspin4:
    ds_read_b32 v24, v25 offset:0
    s_add_u32 s77, s77, 1
    s_waitcnt lgkmcnt(0)
    v_readfirstlane_b32 s78, v24
    s_cmp_ge_u32 s77, 32768
    s_cbranch_scc1 L_Vok4
    s_cmp_lt_u32 s78, 20
    s_cbranch_scc1 L_Vspin4
    s_branch L_Vok4
L_Vslow5:
L_Vspin5:
    ds_read_b32 v24, v25 offset:4
    s_add_u32 s77, s77, 1
    s_waitcnt lgkmcnt(0)
    v_readfirstlane_b32 s78, v24
    s_cmp_ge_u32 s77, 32768
    s_cbranch_scc1 L_Vok5
    s_cmp_lt_u32 s78, 4
    s_cbranch_scc1 L_Vspin5
    s_branch L_Vok5
L_VQ:
    s_mul_i32 s79, s9, 55296
    s_sub_u32 s13, s13, s79
    s_and_b32 s79, s9, 1
    s_mul_i32 s79, s79, 13824
    s_add_u32 s13, s13, s79
    s_lshr_b32 s79, s9, 1
    s_mul_i32 s79, s79, 110592
    s_add_u32 s13, s13, s79
    s_lshl_b32 s15, s15, 1
    s_movk_i32 s78, -288
    v_add_u32_e64 v20, 0, v1
    v_mul_u32_u24 v20, 3641, v20
    v_lshrrev_b32 v20, 16, v20
    v_and_b32 v21, 12, v20
    v_add_u32_e64 v21, v21, v20
    v_mul_u32_u24 v21, 3456, v21
    v_mad_i32_i24 v21, v20, s78, v21
    v_lshl_add_u32 v232, v1, 4, v21
    v_add_u32_e64 v20, 64, v1
    v_mul_u32_u24 v20, 3641, v20
    v_lshrrev_b32 v20, 16, v20
    v_and_b32 v21, 12, v20
    v_add_u32_e64 v21, v21, v20
    v_mul_u32_u24 v21, 3456, v21
    v_mad_i32_i24 v21, v20, s78, v21
    v_lshl_add_u32 v233, v1, 4, v21
    v_add_u32 v20, 128, v1
    v_mul_u32_u24 v20, 3641, v20
    v_lshrrev_b32 v20, 16, v20
    v_and_b32 v21, 12, v20
    v_add_u32_e64 v21, v21, v20
    v_mul_u32_u24 v21, 3456, v21
    v_mad_i32_i24 v21, v20, s78, v21
    v_lshl_add_u32 v234, v1, 4, v21
    v_add_u32 v20, 192, v1
    v_mul_u32_u24 v20, 3641, v20
    v_lshrrev_b32 v20, 16, v20
    v_and_b32 v21, 12, v20
    v_add_u32_e64 v21, v21, v20
    v_mul_u32_u24 v21, 3456, v21
    v_mad_i32_i24 v21, v20, s78, v21
    v_lshl_add_u32 v235, v1, 4, v21
    v_add_u32 v20, 256, v1
    v_mul_u32_u24 v20, 3641, v20
    v_lshrrev_b32 v20, 16, v20
    v_and_b32 v21, 12, v20
    v_add_u32_e64 v21, v21, v20
    v_mul_u32_u24 v21, 3456, v21
    v_mad_i32_i24 v21, v20, s78, v21
    v_lshl_add_u32 v236, v1, 4, v21
    v_add_u32 v236, 1024, v236
    s_add_u32 m0, s15, 76800
    s_add_u32 s79, s13, s11
    buffer_load_dwordx4 v232, s[44:47], s79 offen lds
    buffer_load_dwordx4 v233, s[44:47], s79 offen offset:1024 lds
    s_add_u32 s11, s11, 221184
    s_cmp_eq_u32 s11, 1990656
    s_cselect_b32 s11, 0, s11
    buffer_load_dwordx4 v234, s[44:47], s79 offen offset:2048 lds
    buffer_load_dwordx4 v235, s[44:47], s79 offen offset:3072 lds
    s_add_u32 m0, m0, 1024
    s_mov_b32 exec_hi, 0
    buffer_load_dwordx4 v236, s[44:47], s79 offen offset:3072 lds
    s_mov_b32 exec_hi, -1
    s_mov_b32 s68, s20
    s_and_b32 s69, s21, 0xffff
    s_mov_b32 s70, 20736
    s_mov_b32 s71, 0x20000
    s_mul_i32 s78, s9, 192
    v_add_u32 v20, s78, v1
    v_add_u32_e64 v20, 0, v20
    v_mul_u32_u24 v21, 6554, v20
    v_lshrrev_b32 v21, 16, v21
    v_sub_u32 v20, v20, v21
    v_lshlrev_b32 v253, 2, v20
    v_add_u32 v20, s78, v1
    v_add_u32_e64 v20, 64, v20
    v_mul_u32_u24 v21, 6554, v20
    v_lshrrev_b32 v21, 16, v21
    v_sub_u32 v20, v20, v21
    v_lshlrev_b32 v254, 2, v20
    v_add_u32 v20, s78, v1
    v_add_u32 v20, 128, v20
    v_mul_u32_u24 v21, 6554, v20
    v_lshrrev_b32 v21, 16, v21
    v_sub_u32 v20, v20, v21
    v_lshlrev_b32_e64 v255, 2, v20
    s_mul_i32 s67, s9, 768
    s_add_u32 s67, s67, 159744
    s_add_u32 m0, s67, 0
    s_nop 0
    buffer_load_dword v253, s[68:71], s66 offen lds
    s_add_u32 m0, s67, 256
    s_nop 0
    buffer_load_dword v254, s[68:71], s66 offen lds
    s_add_u32 m0, s67, 512
    s_nop 0
    buffer_load_dword v255, s[68:71], s66 offen lds
    s_add_u32 s66, s66, 2592
    s_mov_b32 s48, s38
    s_and_b32 s49, s39, 0xffff
    s_mov_b32 s50, 10428416
    s_mov_b32 s51, 0x20000
    s_mov_b32 s56, s34
    s_and_b32 s57, s35, 0xffff
    s_mov_b32 s58, 4718592
    s_mov_b32 s59, 0x20000
    v_bfe_u32 v20, v1, 2, 2
    v_lshl_add_u32 v20, v19, 2, v20
    v_mul_u32_u24 v20, 288, v20
    v_add_u32 v20, 76800, v20
    v_and_b32_e64 v21, 3, v1
    v_lshl_add_u32 v9, v21, 3, v20
    v_and_b32_e64 v21, 1, v1
    v_lshl_add_u32 v10, v21, 3, v20
    v_lshrrev_b32 v20, 1, v18
    v_xor_b32 v20, v20, v19
    v_lshlrev_b32_e64 v20, 4, v20
    v_lshl_add_u32 v20, v18, 7, v20
    s_lshl_b32 s78, s9, 12
    v_add_u32 v11, s78, v20
    v_xor_b32_e64 v12, 64, v11
    s_mul_i32 s62, s5, 86
    s_lshr_b32 s62, s62, 8
    s_mul_i32 s63, s62, 3
    s_sub_u32 s63, s5, s63
    s_lshl_b32 s78, s4, 3
    s_add_u32 s62, s62, s78
    s_mul_i32 s64, s5, 43
    s_lshr_b32 s64, s64, 8
    s_mul_i32 s65, s64, 6
    s_sub_u32 s65, s5, s65
    s_lshl_b32 s78, s4, 2
    s_add_u32 s64, s64, s78
    s_lshl_b32 s32, s63, 3
    s_add_u32 s32, s32, s3
    s_mul_i32 s32, s32, 27648
    s_add_u32 s32, s32, 9764864
    v_lshlrev_b32 v124, 4, v1
    s_mul_i32 s33, s9, 1792
    s_add_u32 s33, s33, 4096
    v_min_u32 v20, 13, v1
    v_lshlrev_b32 v125, 7, v20
    v_min_u32 v20, 53, v1
    v_lshlrev_b32 v127, 7, v20
    s_min_u32 s78, s65, 4
    s_cmp_lt_u32 s65, 4
    s_cselect_b32 s72, 3, 2
    s_mul_i32 s65, s65, 10
    s_add_u32 s65, s65, s78
    s_add_u32 s65, s65, s3
    s_cmp_lt_u32 s3, s72
    s_cselect_b32 s19, 1, 0
    s_mul_i32 s16, s64, 98304
    s_lshl_b32 s78, s65, 9
    s_add_u32 s16, s16, s78
    s_add_u32 s16, s16, 1114112
    s_add_u32 s17, s16, 32768
    s_add_u32 s18, s16, 65536
    v_and_b32 v20, 31, v1
    v_lshlrev_b32 v128, 4, v20
    s_lshl_b32 s78, s19, 12
    v_add_u32 v129, s78, v128
    s_mov_b32 s72, 0x39852410
    s_mov_b32 s73, 0xc6
    s_bitcmp1_b32 s64, 0
    s_cselect_b32 s72, 0x26985410, s72
    s_cselect_b32 s73, 0xc3, s73
    s_lshl_b32 s78, s3, 4
    v_add_u32_e64 v20, s78, v18
    v_mul_u32_u24 v21, 1920, v19
    v_lshl_add_u32 v130, v20, 4, v21
    v_mul_u32_u24 v21, 3277, v20
    v_lshrrev_b32 v21, 16, v21
    v_mul_u32_u24 v24, 20, v21
    v_sub_u32 v24, v20, v24
    v_lshrrev_b32 v20, 1, v24
    v_lshlrev_b32_e64 v20, 2, v20
    v_lshrrev_b64 v[22:23], v20, s[72:73]
    v_and_b32 v22, 15, v22
    v_and_b32 v23, 1, v24
    v_lshl_add_u32 v22, v22, 1, v23
    v_mul_u32_u24 v22, 112, v22
    v_cmp_lt_u32 vcc, 2, v21
    v_mul_u32_u24 v23, 12, v21
    v_lshl_add_u32 v22, v19, 2, v22
    v_cndmask_b32 v20, 0, 12, vcc
    v_add3_u32 v22, v22, v23, v20
    v_add_u32 v131, 132096, v22
    v_cmp_gt_u32 vcc, 19, v24
    v_cmp_gt_u32 s[72:73], 6, v21
    s_nop 0
    s_and_b64 s[24:25], vcc, s[72:73]
    s_mov_b32 s26, s24
    s_and_b32 s27, s25, 0xffff
    s_mul_i32 s20, s64, 30720
    s_add_u32 s20, s20, 65536
    s_add_u32 s21, s20, 7680
    s_add_u32 s22, s20, 15360
    s_add_u32 s23, s20, 23040
    v_and_b32 v20, 1, v1
    v_lshlrev_b32 v20, 4, v20
    s_movk_i32 s78, 0x3f80
    v_lshlrev_b32_e64 v20, v20, s78
    v_bfe_u32 v21, v1, 1, 3
    v_cmp_eq_u32 vcc, 0, v21
    s_nop 1
    v_cndmask_b32 v136, 0, v20, vcc
    v_cmp_eq_u32 vcc, 2, v21
    s_nop 1
    v_cndmask_b32 v137, 0, v20, vcc
    v_cmp_eq_u32 vcc, 4, v21
    s_nop 1
    v_cndmask_b32 v138, 0, v20, vcc
    v_mov_b32 v139, 0
    v_and_b32 v20, 31, v1
    v_lshrrev_b32 v21, 5, v1
    v_cmp_eq_u32 vcc, 28, v20
    v_mul_u32_u24 v23, 48, v21
    s_nop 0
    v_cndmask_b32 v22, v20, 24, vcc
    v_mul_u32_u24 v22, 112, v22
    v_add_u32 v22, 132096, v22
    v_add_u32_e64 v132, v22, v23
    v_lshl_add_u32 v133, v21, 10, v128
    v_lshlrev_b32_e64 v21, 15, v21
    v_or_b32 v134, 0x3f80, v21
    v_lshlrev_b32 v135, 16, v134
    s_lshl_b32 s28, s65, 5
    s_add_u32 s28, s28, s64
    s_mul_i32 s28, s28, 1536
    s_add_u32 s28, s28, 4259840
    s_add_u32 s29, s28, 393216
    s_mov_b32 s77, 0
    v_mov_b32 v25, 162880
    v_mov_b32 v26, 1
    v_bfrev_b32 v27, 1
    s_sub_u32 s67, s67, 126976
    s_add_u32 m0, s67, 0
    s_nop 0
    buffer_load_dword v253, s[68:71], s66 offen lds
    s_add_u32 m0, s67, 256
    s_nop 0
    buffer_load_dword v254, s[68:71], s66 offen lds
    s_add_u32 m0, s67, 512
    s_nop 0
    buffer_load_dword v255, s[68:71], s66 offen lds
    s_add_u32 s66, s66, 2592
    s_add_u32 m0, s14, 16384
    s_add_u32 s79, s12, s10
    buffer_load_dwordx4 v2, s[40:43], s79 offen lds
    buffer_load_dwordx4 v3, s[40:43], s79 offen offset:1024 lds
    s_add_u32 s10, s10, 128
    s_cmp_eq_u32 s10, 1152
    s_cselect_b32 s10, 0, s10
    buffer_load_dwordx4 v4, s[40:43], s79 offen offset:2048 lds
    buffer_load_dwordx4 v5, s[40:43], s79 offen offset:3072 lds
    s_add_u32 m0, s15, 95232
    s_add_u32 s79, s13, s11
    buffer_load_dwordx4 v232, s[44:47], s79 offen lds
    buffer_load_dwordx4 v233, s[44:47], s79 offen offset:1024 lds
    s_add_u32 s11, s11, 221184
    s_cmp_eq_u32 s11, 1990656
    s_cselect_b32 s11, 0, s11
    buffer_load_dwordx4 v234, s[44:47], s79 offen offset:2048 lds
    buffer_load_dwordx4 v235, s[44:47], s79 offen offset:3072 lds
    s_add_u32 m0, m0, 1024
    s_mov_b32 exec_hi, 0
    buffer_load_dwordx4 v236, s[44:47], s79 offen offset:3072 lds
    s_mov_b32 exec_hi, -1
    s_waitcnt vmcnt(9) lgkmcnt(0)
    s_barrier
    s_add_u32 m0, s14, 51200
    s_add_u32 s79, s12, s10
    buffer_load_dwordx4 v2, s[40:43], s79 offen lds
    buffer_load_dwordx4 v3, s[40:43], s79 offen offset:1024 lds
    s_add_u32 s10, s10, 128
    s_cmp_eq_u32 s10, 1152
    s_cselect_b32 s10, 0, s10
    buffer_load_dwordx4 v4, s[40:43], s79 offen offset:2048 lds
    buffer_load_dwordx4 v5, s[40:43], s79 offen offset:3072 lds
    s_add_u32 m0, s15, 113664
    s_add_u32 s79, s13, s11
    buffer_load_dwordx4 v232, s[44:47], s79 offen lds
    buffer_load_dwordx4 v233, s[44:47], s79 offen offset:1024 lds
    s_add_u32 s11, s11, 221184
    s_cmp_eq_u32 s11, 1990656
    s_cselect_b32 s11, 0, s11
    buffer_load_dwordx4 v234, s[44:47], s79 offen offset:2048 lds
    buffer_load_dwordx4 v235, s[44:47], s79 offen offset:3072 lds
    s_add_u32 m0, m0, 1024
    s_mov_b32 exec_hi, 0
    buffer_load_dwordx4 v236, s[44:47], s79 offen offset:3072 lds
    s_mov_b32 exec_hi, -1
    s_waitcnt vmcnt(9) lgkmcnt(0)
    s_barrier
    s_add_u32 m0, s14, 0
    s_add_u32 s79, s12, s10
    buffer_load_dwordx4 v2, s[40:43], s79 offen lds
    buffer_load_dwordx4 v3, s[40:43], s79 offen offset:1024 lds
    s_add_u32 s10, s10, 128
    s_cmp_eq_u32 s10, 1152
    s_cselect_b32 s10, 0, s10
    buffer_load_dwordx4 v4, s[40:43], s79 offen offset:2048 lds
    buffer_load_dwordx4 v5, s[40:43], s79 offen offset:3072 lds
    s_add_u32 m0, s15, 76800
    s_add_u32 s79, s13, s11
    buffer_load_dwordx4 v232, s[44:47], s79 offen lds
    buffer_load_dwordx4 v233, s[44:47], s79 offen offset:1024 lds
    s_add_u32 s11, s11, 221184
    s_cmp_eq_u32 s11, 1990656
    s_cselect_b32 s11, 0, s11
    buffer_load_dwordx4 v234, s[44:47], s79 offen offset:2048 lds
    buffer_load_dwordx4 v235, s[44:47], s79 offen offset:3072 lds
    s_add_u32 m0, m0, 1024
    s_mov_b32 exec_hi, 0
    buffer_load_dwordx4 v236, s[44:47], s79 offen offset:3072 lds
    s_mov_b32 exec_hi, -1
    s_load_dword s76, s[38:39], 0
    s_waitcnt vmcnt(9) lgkmcnt(0)
    s_barrier
    s_add_u32 m0, s14, 16384
    s_add_u32 s79, s12, s10
    buffer_load_dwordx4 v2, s[40:43], s79 offen lds
    buffer_load_dwordx4 v3, s[40:43], s79 offen offset:1024 lds
    s_add_u32 s10, s10, 128
    s_cmp_eq_u32 s10, 1152
    s_cselect_b32 s10, 0, s10
    buffer_load_dwordx4 v4, s[40:43], s79 offen offset:2048 lds
    buffer_load_dwordx4 v5, s[40:43], s79 offen offset:3072 lds
    s_add_u32 m0, s15, 95232
    s_add_u32 s79, s13, s11
    buffer_load_dwordx4 v232, s[44:47], s79 offen lds
    buffer_load_dwordx4 v233, s[44:47], s79 offen offset:1024 lds
    s_add_u32 s11, s11, 221184
    s_cmp_eq_u32 s11, 1990656
    s_cselect_b32 s11, 0, s11
    buffer_load_dwordx4 v234, s[44:47], s79 offen offset:2048 lds
    buffer_load_dwordx4 v235, s[44:47], s79 offen offset:3072 lds
    s_add_u32 m0, m0, 1024
    s_mov_b32 exec_hi, 0
    buffer_load_dwordx4 v236, s[44:47], s79 offen offset:3072 lds
    s_mov_b32 exec_hi, -1
    s_mul_i32 s76, s76, 0x9e3779b1
    s_add_u32 s76, s76, 0x7f4a7c15
    s_waitcnt vmcnt(9) lgkmcnt(0)
    s_barrier
    s_add_u32 m0, s14, 51200
    s_add_u32 s79, s12, s10
    buffer_load_dwordx4 v2, s[40:43], s79 offen lds
    buffer_load_dwordx4 v3, s[40:43], s79 offen offset:1024 lds
    s_add_u32 s10, s10, 128
    s_cmp_eq_u32 s10, 1152
    s_cselect_b32 s10, 0, s10
    buffer_load_dwordx4 v4, s[40:43], s79 offen offset:2048 lds
    buffer_load_dwordx4 v5, s[40:43], s79 offen offset:3072 lds
    s_add_u32 m0, s15, 113664
    s_add_u32 s79, s13, s11
    buffer_load_dwordx4 v232, s[44:47], s79 offen lds
    buffer_load_dwordx4 v233, s[44:47], s79 offen offset:1024 lds
    s_add_u32 s11, s11, 221184
    s_cmp_eq_u32 s11, 1990656
    s_cselect_b32 s11, 0, s11
    buffer_load_dwordx4 v234, s[44:47], s79 offen offset:2048 lds
    buffer_load_dwordx4 v235, s[44:47], s79 offen offset:3072 lds
    s_add_u32 m0, m0, 1024
    s_mov_b32 exec_hi, 0
    buffer_load_dwordx4 v236, s[44:47], s79 offen offset:3072 lds
    s_mov_b32 exec_hi, -1
    s_waitcnt vmcnt(9) lgkmcnt(0)
    s_barrier
    s_add_u32 m0, s14, 0
    s_add_u32 s79, s12, s10
    buffer_load_dwordx4 v2, s[40:43], s79 offen lds
    buffer_load_dwordx4 v3, s[40:43], s79 offen offset:1024 lds
    s_add_u32 s10, s10, 128
    s_cmp_eq_u32 s10, 1152
    s_cselect_b32 s10, 0, s10
    buffer_load_dwordx4 v4, s[40:43], s79 offen offset:2048 lds
    buffer_load_dwordx4 v5, s[40:43], s79 offen offset:3072 lds
    s_add_u32 m0, s15, 76800
    s_add_u32 s79, s13, s11
    buffer_load_dwordx4 v232, s[44:47], s79 offen lds
    buffer_load_dwordx4 v233, s[44:47], s79 offen offset:1024 lds
    s_add_u32 s11, s11, 221184
    s_cmp_eq_u32 s11, 1990656
    s_cselect_b32 s11, 0, s11
    buffer_load_dwordx4 v234, s[44:47], s79 offen offset:2048 lds
    buffer_load_dwordx4 v235, s[44:47], s79 offen offset:3072 lds
    s_add_u32 m0, m0, 1024
    s_mov_b32 exec_hi, 0
    buffer_load_dwordx4 v236, s[44:47], s79 offen offset:3072 lds
    s_mov_b32 exec_hi, -1
    s_waitcnt vmcnt(9) lgkmcnt(0)
    s_barrier
    s_add_u32 m0, s14, 16384
    s_add_u32 s79, s12, s10
    buffer_load_dwordx4 v2, s[40:43], s79 offen lds
    buffer_load_dwordx4 v3, s[40:43], s79 offen offset:1024 lds
    s_add_u32 s10, s10, 128
    s_cmp_eq_u32 s10, 1152
    s_cselect_b32 s10, 0, s10
    buffer_load_dwordx4 v4, s[40:43], s79 offen offset:2048 lds
    buffer_load_dwordx4 v5, s[40:43], s79 offen offset:3072 lds
    s_add_u32 m0, s15, 95232
    s_add_u32 s79, s13, s11
    buffer_load_dwordx4 v232, s[44:47], s79 offen lds
    buffer_load_dwordx4 v233, s[44:47], s79 offen offset:1024 lds
    s_add_u32 s11, s11, 221184
    s_cmp_eq_u32 s11, 1990656
    s_cselect_b32 s11, 0, s11
    buffer_load_dwordx4 v234, s[44:47], s79 offen offset:2048 lds
    buffer_load_dwordx4 v235, s[44:47], s79 offen offset:3072 lds
    s_add_u32 m0, m0, 1024
    s_mov_b32 exec_hi, 0
    buffer_load_dwordx4 v236, s[44:47], s79 offen offset:3072 lds
    s_mov_b32 exec_hi, -1
    s_waitcnt vmcnt(9) lgkmcnt(0)
    s_barrier
    s_add_u32 m0, s14, 51200
    s_add_u32 s79, s12, s10
    buffer_load_dwordx4 v2, s[40:43], s79 offen lds
    buffer_load_dwordx4 v3, s[40:43], s79 offen offset:1024 lds
    s_add_u32 s10, s10, 128
    s_cmp_eq_u32 s10, 1152
    s_cselect_b32 s10, 0, s10
    buffer_load_dwordx4 v4, s[40:43], s79 offen offset:2048 lds
    buffer_load_dwordx4 v5, s[40:43], s79 offen offset:3072 lds
    s_add_u32 m0, s15, 113664
    s_add_u32 s79, s13, s11
    buffer_load_dwordx4 v232, s[44:47], s79 offen lds
    buffer_load_dwordx4 v233, s[44:47], s79 offen offset:1024 lds
    s_add_u32 s11, s11, 221184
    s_cmp_eq_u32 s11, 1990656
    s_cselect_b32 s11, 0, s11
    buffer_load_dwordx4 v234, s[44:47], s79 offen offset:2048 lds
    buffer_load_dwordx4 v235, s[44:47], s79 offen offset:3072 lds
    s_add_u32 m0, m0, 1024
    s_mov_b32 exec_hi, 0
    buffer_load_dwordx4 v236, s[44:47], s79 offen offset:3072 lds
    s_mov_b32 exec_hi, -1
    buffer_load_dword v126, v125, s[48:51], s33 offen sc1
    s_waitcnt vmcnt(10) lgkmcnt(0)
    s_barrier
    s_waitcnt vmcnt(1) lgkmcnt(0)
    s_barrier
    v_lshrrev_b32_e64 v20, 5, v1
    v_mul_u32_u24 v20, 3072, v20
    v_add_u32_e64 v2, v128, v20
    s_mul_i32 s14, s62, 49152
    s_mul_i32 s78, s3, 6144
    s_add_u32 s14, s14, s78
    s_add_u32 s14, s14, 4259840
    s_lshl_b32 s78, s3, 12
    s_add_u32 s78, s78, 76800
    v_lshl_add_u32 v3, v1, 4, s78
    s_lshr_b32 s78, s3, 2
    s_lshl_b32 s78, s78, 11
    s_and_b32 s72, s3, 1
    s_lshl_b32 s72, s72, 10
    s_add_u32 s78, s78, s72
    s_and_b32 s72, s3, 2
    s_lshl_b32 s72, s72, 2
    s_add_u32 s78, s78, s72
    s_add_u32 s78, s78, 109568
    v_lshl_add_u32 v4, v1, 4, s78
    s_lshr_b32 s72, s3, 2
    v_lshlrev_b32 v20, 9, v19
    v_lshl_add_u32 v20, v18, 4, v20
    s_lshl_b32 s78, s72, 14
    s_add_u32 s78, s78, 76800
    v_add_u32 v5, s78, v20
    s_lshl_b32 s78, s72, 11
    s_add_u32 s78, s78, 109568
    v_add_u32 v6, s78, v20
    s_mul_i32 s78, s72, 25088
    s_lshl_b32 s72, s9, 6
    s_add_u32 s78, s78, s72
    v_mul_u32_u24 v20, 784, v18
    v_lshl_add_u32 v20, v19, 4, v20
    v_add_u32 v7, s78, v20
    s_lshl_b32 s78, s62, 3
    s_add_u32 s78, s78, s3
    s_mul_i32 s15, s78, 9216
    s_mul_i32 s78, s63, 384
    s_add_u32 s15, s15, s78
    s_mul_i32 s78, s3, 3136
    v_add_u32_e64 v20, 0, v1
    v_mul_u32_u24 v21, 2731, v20
    v_lshrrev_b32 v21, 16, v21
    v_mul_u32_u24 v22, 24, v21
    v_sub_u32_e64 v20, v20, v22
    v_mul_u32_u24 v22, 784, v21
    v_lshl_add_u32 v22, v20, 5, v22
    v_add_u32_e64 v13, s78, v22
    v_mul_u32_u24 v22, 2304, v21
    v_lshl_add_u32 v15, v20, 4, v22
    v_add_u32_e64 v20, 64, v1
    v_mul_u32_u24 v21, 2731, v20
    v_lshrrev_b32 v21, 16, v21
    v_mul_u32_u24 v22, 24, v21
    v_sub_u32_e64 v20, v20, v22
    v_mul_u32_u24 v22, 784, v21
    v_lshl_add_u32 v22, v20, 5, v22
    v_add_u32_e64 v14, s78, v22
    v_mul_u32_u24 v22, 2304, v21
    v_lshl_add_u32 v16, v20, 4, v22
    s_mov_b32 s77, 0
    s_mov_b32 s74, 1069066811
    v_mov_b32 v101, 0
    v_mov_b32 v113, 0
    v_mov_b32 v115, 0
    s_barrier
    s_waitcnt vmcnt(0)
L_Wchk2:
    v_cmp_ne_u32 vcc, s76, v126
    s_cbranch_vccnz L_Wretry2
L_Wok2:
    s_barrier
    s_add_u32 s79, s32, 0
    buffer_load_dwordx4 v[140:143], v124, s[48:51], s79 offen sc1
    s_add_u32 s79, s32, 1024
    buffer_load_dwordx4 v[144:147], v124, s[48:51], s79 offen sc1
    s_add_u32 s79, s32, 2048
    buffer_load_dwordx4 v[148:151], v124, s[48:51], s79 offen sc1
    s_add_u32 s79, s32, 3072
    buffer_load_dwordx4 v[152:155], v124, s[48:51], s79 offen sc1
    s_add_u32 s79, s32, 4096
    buffer_load_dwordx4 v[156:159], v124, s[48:51], s79 offen sc1
    s_add_u32 s79, s32, 5120
    buffer_load_dwordx4 v[160:163], v124, s[48:51], s79 offen sc1
    s_add_u32 s79, s32, 6144
    buffer_load_dwordx4 v[164:167], v124, s[48:51], s79 offen sc1
    s_add_u32 s79, s32, 7168
    buffer_load_dwordx4 v[168:171], v124, s[48:51], s79 offen sc1
    s_add_u32 s79, s32, 8192
    buffer_load_dwordx4 v[172:175], v124, s[48:51], s79 offen sc1
    s_add_u32 s79, s32, 9216
    buffer_load_dwordx4 v[176:179], v124, s[48:51], s79 offen sc1
    s_add_u32 s79, s32, 10240
    buffer_load_dwordx4 v[180:183], v124, s[48:51], s79 offen sc1
    s_add_u32 s79, s32, 11264
    buffer_load_dwordx4 v[184:187], v124, s[48:51], s79 offen sc1
    s_add_u32 s79, s32, 12288
    buffer_load_dwordx4 v[188:191], v124, s[48:51], s79 offen sc1
    s_add_u32 s79, s32, 13312
    buffer_load_dwordx4 v[192:195], v124, s[48:51], s79 offen sc1
    s_add_u32 s79, s32, 14336
    buffer_load_dwordx4 v[196:199], v124, s[48:51], s79 offen sc1
    s_add_u32 s79, s32, 15360
    buffer_load_dwordx4 v[200:203], v124, s[48:51], s79 offen sc1
    s_add_u32 s79, s32, 16384
    buffer_load_dwordx4 v[204:207], v124, s[48:51], s79 offen sc1
    s_add_u32 s79, s32, 17408
    buffer_load_dwordx4 v[208:211], v124, s[48:51], s79 offen sc1
    s_add_u32 s79, s32, 18432
    buffer_load_dwordx4 v[212:215], v124, s[48:51], s79 offen sc1
    s_add_u32 s79, s32, 19456
    buffer_load_dwordx4 v[216:219], v124, s[48:51], s79 offen sc1
    s_add_u32 s79, s32, 20480
    buffer_load_dwordx4 v[220:223], v124, s[48:51], s79 offen sc1
    s_add_u32 s79, s32, 21504
    buffer_load_dwordx4 v[224:227], v124, s[48:51], s79 offen sc1
    s_add_u32 s79, s32, 22528
    buffer_load_dwordx4 v[228:231], v124, s[48:51], s79 offen sc1
    s_add_u32 s79, s32, 23552
    buffer_load_dwordx4 v[232:235], v124, s[48:51], s79 offen sc1
    s_add_u32 s79, s32, 24576
    buffer_load_dwordx4 v[236:239], v124, s[48:51], s79 offen sc1
    s_add_u32 s79, s32, 25600
    buffer_load_dwordx4 v[240:243], v124, s[48:51], s79 offen sc1
    s_add_u32 s79, s32, 26624
    buffer_load_dwordx4 v[244:247], v124, s[48:51], s79 offen sc1
    buffer_load_dwordx4 v[28:31], v128, s[48:51], s16 offen sc1
    buffer_load_dwordx4 v[32:35], v128, s[48:51], s17 offen sc1
    buffer_load_dwordx4 v[36:39], v128, s[48:51], s18 offen sc1
    buffer_load_dwordx4 v[40:43], v129, s[48:51], s16 offen sc1
    buffer_load_dwordx4 v[44:47], v129, s[48:51], s17 offen sc1
    buffer_load_dwordx4 v[48:51], v129, s[48:51], s18 offen sc1
    s_waitcnt vmcnt(0)
    s_branch L_TQ
L_K:
    s_lshl_b32 s10, s5, 1
    s_add_u32 s10, s10, s9
    s_sub_u32 s10, s10, 1
    s_sub_u32 s11, s10, 15
    s_and_b32 s12, s11, 28
    s_lshr_b32 s13, 0xea954310, s12
    s_and_b32 s13, s13, 15
    s_lshr_b32 s12, s12, 2
    s_lshr_b32 s12, 0x53, s12
    s_and_b32 s12, s12, 1
    s_and_b32 s11, s11, 3
    s_lshl_b32 s11, s11, 1
    s_add_u32 s11, s11, s12
    s_cmp_lt_u32 s10, 15
    s_cselect_b32 s13, s10, s13
    s_cselect_b32 s11, 8, s11
    s_mul_i32 s12, s13, 52
    s_lshr_b32 s12, s12, 8
    s_lshl_b32 s12, s12, 2
    s_add_u32 s13, s13, s12
    s_and_b32 s12, s4, 1
    s_lshl_b32 s12, s12, 2
    s_add_u32 s13, s13, s12
    s_lshl_b32 s13, s13, 7
    s_mul_i32 s11, s11, 221184
    s_add_u32 s13, s13, s11
    s_add_u32 s10, s6, 3
    s_and_b32 s10, s10, 3
    s_lshl_b32 s10, s10, 1
    s_lshr_b32 s11, s7, 1
    s_add_u32 s10, s10, s11
    s_sub_u32 s10, s10, 1
    s_cmp_eq_u32 s11, 0
    s_cselect_b32 s10, 8, s10
    s_lshl_b32 s10, s10, 7
    s_lshl_b32 s11, s6, 1
    s_and_b32 s12, s7, 1
    s_add_u32 s11, s11, s12
    s_mul_i32 s11, s11, 73728
    s_add_u32 s10, s10, s11
    s_cmp_eq_u32 s9, 0
    s_cselect_b32 s13, s10, s13
    s_cselect_b32 s12, 1, 3
    s_mul_i32 s12, s12, 1152
    v_mul_u32_u24 v20, s12, v1
    s_mov_b32 s42, 1990656
    s_cselect_b32 s42, 2359296, s42
    s_mov_b32 s43, 0x20000
    s_waitcnt lgkmcnt(0)
    s_cselect_b32 s40, s16, s18
    s_cselect_b32 s41, s17, s19
    s_and_b32 s41, s41, 0xffff
    s_cmp_eq_u32 s9, 3
    s_cbranch_scc1 L_Knt
    buffer_load_dword v255, v20, s[40:43], s13 offen
L_Knt:
    s_load_dword s76, s[38:39], 0
    s_mov_b32 s48, s38
    s_and_b32 s49, s39, 0xffff
    s_mov_b32 s50, 10428416
    s_mov_b32 s51, 0x20000
    s_mov_b32 s56, s34
    s_and_b32 s57, s35, 0xffff
    s_mov_b32 s58, 4718592
    s_mov_b32 s59, 0x20000
    v_mov_b32 v20, 0
    v_lshlrev_b32_e64 v21, 2, v1
    v_add_u32 v21, 162816, v21
    s_mov_b32 exec_hi, 0
    ds_write_b32 v21, v20
    s_mov_b32 exec_hi, -1
    v_bfe_u32 v20, v1, 2, 2
    v_lshl_add_u32 v20, v19, 2, v20
    v_mul_u32_u24 v20, 288, v20
    v_add_u32 v20, 32768, v20
    v_and_b32_e64 v21, 3, v1
    v_lshl_add_u32 v9, v21, 3, v20
    v_and_b32_e64 v21, 1, v1
    v_lshl_add_u32 v10, v21, 3, v20
    v_lshrrev_b32 v20, 1, v18
    v_xor_b32 v20, v20, v19
    v_lshlrev_b32_e64 v20, 4, v20
    v_lshl_add_u32 v20, v18, 7, v20
    s_lshl_b32 s78, s9, 12
    v_add_u32 v11, s78, v20
    v_xor_b32 v12, 64, v11
    s_cmp_ge_u32 s7, 4
    s_cselect_b32 s78, s9, 0
    s_cmp_ge_u32 s78, 2
    s_cselect_b32 s78, 126976, 0
    v_bfe_u32 v20, v1, 2, 2
    v_lshl_add_u32 v20, v19, 2, v20
    v_and_b32 v21, 3, v1
    v_mul_u32_u24 v21, 18, v21
    v_sub_u32 v21, v20, v21
    v_mul_u32_u24 v20, 40, v20
    v_subrev_u32_e64 v20, s78, v20
    v_mov_b32 v24, 162816
    v_add_u32_e64 v22, 0, v21
    v_add_u32 v23, 159744, v20
    v_cmp_gt_u32 vcc, 18, v22
    s_nop 1
    v_cndmask_b32 v248, v24, v23, vcc
    v_add_u32 v22, 16, v21
    v_add_u32 v23, 160384, v20
    v_cmp_gt_u32 vcc, 18, v22
    s_nop 1
    v_cndmask_b32 v249, v24, v23, vcc
    v_add_u32 v22, 32, v21
    v_add_u32 v23, 161024, v20
    v_cmp_gt_u32 vcc, 18, v22
    s_nop 1
    v_cndmask_b32 v250, v24, v23, vcc
    v_add_u32 v22, 48, v21
    v_add_u32 v23, 161664, v20
    v_cmp_gt_u32 vcc, 18, v22
    s_nop 1
    v_cndmask_b32 v251, v24, v23, vcc
    v_add_u32 v22, 64, v21
    v_add_u32 v23, 162304, v20
    v_cmp_gt_u32 vcc, 18, v22
    s_nop 1
    v_cndmask_b32 v252, v24, v23, vcc
    s_mul_i32 s62, s5, 86
    s_lshr_b32 s62, s62, 8
    s_mul_i32 s63, s62, 3
    s_sub_u32 s63, s5, s63
    s_lshl_b32 s78, s4, 3
    s_add_u32 s62, s62, s78
    s_mul_i32 s64, s5, 43
    s_lshr_b32 s64, s64, 8
    s_mul_i32 s65, s64, 6
    s_sub_u32 s65, s5, s65
    s_lshl_b32 s78, s4, 2
    s_add_u32 s64, s64, s78
    s_lshl_b32 s32, s63, 3
    s_add_u32 s32, s32, s3
    s_mul_i32 s32, s32, 27648
    s_add_u32 s32, s32, 9764864
    v_lshlrev_b32_e64 v124, 4, v1
    s_mul_i32 s33, s9, 1792
    s_add_u32 s33, s33, 4096
    v_min_u32 v20, 13, v1
    v_lshlrev_b32 v125, 7, v20
    v_min_u32 v20, 53, v1
    v_lshlrev_b32 v127, 7, v20
    s_min_u32 s78, s65, 4
    s_cmp_lt_u32 s65, 4
    s_cselect_b32 s72, 3, 2
    s_mul_i32 s65, s65, 10
    s_add_u32 s65, s65, s78
    s_add_u32 s65, s65, s3
    s_cmp_lt_u32 s3, s72
    s_cselect_b32 s19, 1, 0
    s_mul_i32 s16, s64, 98304
    s_lshl_b32 s78, s65, 9
    s_add_u32 s16, s16, s78
    s_add_u32 s16, s16, 1114112
    s_add_u32 s17, s16, 32768
    s_add_u32 s18, s16, 65536
    v_and_b32 v20, 31, v1
    v_lshlrev_b32 v128, 4, v20
    s_lshl_b32 s78, s19, 12
    v_add_u32 v129, s78, v128
    s_mov_b32 s72, 0x39852410
    s_mov_b32 s73, 0xc6
    s_bitcmp1_b32 s64, 0
    s_cselect_b32 s72, 0x26985410, s72
    s_cselect_b32 s73, 0xc3, s73
    s_lshl_b32 s78, s3, 4
    v_add_u32_e64 v20, s78, v18
    v_mul_u32_u24 v21, 1920, v19
    v_lshl_add_u32 v130, v20, 4, v21
    v_mul_u32_u24 v21, 3277, v20
    v_lshrrev_b32 v21, 16, v21
    v_mul_u32_u24 v24, 20, v21
    v_sub_u32 v24, v20, v24
    v_lshrrev_b32 v20, 1, v24
    v_lshlrev_b32_e64 v20, 2, v20
    v_lshrrev_b64 v[22:23], v20, s[72:73]
    v_and_b32 v22, 15, v22
    v_and_b32 v23, 1, v24
    v_lshl_add_u32 v22, v22, 1, v23
    v_mul_u32_u24 v22, 112, v22
    v_cmp_lt_u32 vcc, 2, v21
    v_mul_u32_u24 v23, 12, v21
    v_lshl_add_u32 v22, v19, 2, v22
    v_cndmask_b32 v20, 0, 12, vcc
    v_add3_u32 v22, v22, v23, v20
    v_add_u32 v131, 132096, v22
    v_cmp_gt_u32 vcc, 19, v24
    v_cmp_gt_u32 s[72:73], 6, v21
    s_nop 0
    s_and_b64 s[24:25], vcc, s[72:73]
    s_mov_b32 s26, s24
    s_and_b32 s27, s25, 0xffff
    s_mul_i32 s20, s64, 30720
    s_add_u32 s20, s20, 65536
    s_add_u32 s21, s20, 7680
    s_add_u32 s22, s20, 15360
    s_add_u32 s23, s20, 23040
    v_and_b32 v20, 1, v1
    v_lshlrev_b32 v20, 4, v20
    s_movk_i32 s78, 0x3f80
    v_lshlrev_b32_e64 v20, v20, s78
    v_bfe_u32 v21, v1, 1, 3
    v_cmp_eq_u32 vcc, 0, v21
    s_nop 1
    v_cndmask_b32 v136, 0, v20, vcc
    v_cmp_eq_u32 vcc, 2, v21
    s_nop 1
    v_cndmask_b32 v137, 0, v20, vcc
    v_cmp_eq_u32 vcc, 4, v21
    s_nop 1
    v_cndmask_b32 v138, 0, v20, vcc
    v_mov_b32 v139, 0
    v_and_b32 v20, 31, v1
    v_lshrrev_b32 v21, 5, v1
    v_cmp_eq_u32 vcc, 28, v20
    v_mul_u32_u24 v23, 48, v21
    s_nop 0
    v_cndmask_b32 v22, v20, 24, vcc
    v_mul_u32_u24 v22, 112, v22
    v_add_u32 v22, 132096, v22
    v_add_u32_e64 v132, v22, v23
    v_lshl_add_u32 v133, v21, 10, v128
    v_lshlrev_b32_e64 v21, 15, v21
    v_or_b32 v134, 0x3f80, v21
    v_lshlrev_b32 v135, 16, v134
    s_lshl_b32 s28, s65, 5
    s_add_u32 s28, s28, s64
    s_mul_i32 s28, s28, 1536
    s_add_u32 s28, s28, 4259840
    s_add_u32 s29, s28, 393216
    v_lshrrev_b32 v20, 5, v1
    v_mul_u32_u24 v20, 3072, v20
    v_add_u32_e64 v2, v128, v20
    s_mul_i32 s14, s62, 49152
    s_mul_i32 s78, s3, 6144
    s_add_u32 s14, s14, s78
    s_add_u32 s14, s14, 4259840
    s_lshl_b32 s78, s3, 12
    s_add_u32 s78, s78, 76800
    v_lshl_add_u32 v3, v1, 4, s78
    s_lshr_b32 s78, s3, 2
    s_lshl_b32 s78, s78, 11
    s_and_b32 s72, s3, 1
    s_lshl_b32 s72, s72, 10
    s_add_u32 s78, s78, s72
    s_and_b32 s72, s3, 2
    s_lshl_b32 s72, s72, 2
    s_add_u32 s78, s78, s72
    s_add_u32 s78, s78, 109568
    v_lshl_add_u32 v4, v1, 4, s78
    s_lshr_b32 s72, s3, 2
    v_lshlrev_b32 v20, 9, v19
    v_lshl_add_u32 v20, v18, 4, v20
    s_lshl_b32 s78, s72, 14
    s_add_u32 s78, s78, 76800
    v_add_u32 v5, s78, v20
    s_lshl_b32 s78, s72, 11
    s_add_u32 s78, s78, 109568
    v_add_u32 v6, s78, v20
    s_mul_i32 s78, s72, 25088
    s_lshl_b32 s72, s9, 6
    s_add_u32 s78, s78, s72
    v_mul_u32_u24 v20, 784, v18
    v_lshl_add_u32 v20, v19, 4, v20
    v_add_u32 v7, s78, v20
    s_lshl_b32 s78, s62, 3
    s_add_u32 s78, s78, s3
    s_mul_i32 s15, s78, 9216
    s_mul_i32 s78, s63, 384
    s_add_u32 s15, s15, s78
    s_mul_i32 s78, s3, 3136
    v_add_u32_e64 v20, 0, v1
    v_mul_u32_u24 v21, 2731, v20
    v_lshrrev_b32 v21, 16, v21
    v_mul_u32_u24 v22, 24, v21
    v_sub_u32_e64 v20, v20, v22
    v_mul_u32_u24 v22, 784, v21
    v_lshl_add_u32 v22, v20, 5, v22
    v_add_u32_e64 v13, s78, v22
    v_mul_u32_u24 v22, 2304, v21
    v_lshl_add_u32 v15, v20, 4, v22
    v_add_u32_e64 v20, 64, v1
    v_mul_u32_u24 v21, 2731, v20
    v_lshrrev_b32 v21, 16, v21
    v_mul_u32_u24 v22, 24, v21
    v_sub_u32_e64 v20, v20, v22
    v_mul_u32_u24 v22, 784, v21
    v_lshl_add_u32 v22, v20, 5, v22
    v_add_u32_e64 v14, s78, v22
    v_mul_u32_u24 v22, 2304, v21
    v_lshl_add_u32 v16, v20, 4, v22
    s_mov_b32 s77, 0
    s_cmp_ge_u32 s7, 4
    s_cbranch_scc1 L_KQ
    s_mul_i32 s78, s9, 9472
    v_mul_u32_u24 v20, 296, v18
    v_mul_u32_u24 v21, 72, v19
    v_add3_u32 v240, v20, v21, s78
    v_and_b32 v20, 28, v1
    v_lshrrev_b32_e64 v21, 5, v1
    v_lshl_add_u32 v20, v21, 1, v20
    v_and_b32_e64 v21, 3, v1
    v_mul_u32_u24 v23, 296, v20
    v_lshl_add_u32 v23, v21, 3, v23
    s_mul_i32 s78, s9, 72
    v_add_u32 v241, s78, v23
    s_mul_i32 s78, s9, 9
    s_lshr_b32 s78, s78, 1
    v_mul_u32_u24 v23, 152, v20
    v_add_u32 v23, 51200, v23
    v_add_u32 v22, s78, v21
    v_lshl_add_u32 v242, v22, 3, v23
    s_add_u32 s78, s78, 4
    v_mov_b32 v22, s78
    v_cmp_eq_u32 vcc, 0, v21
    s_nop 1
    v_cndmask_b32 v22, 18, v22, vcc
    v_lshl_add_u32 v243, v22, 3, v23
    s_and_b32 s78, s9, 1
    s_lshl_b32 s78, s78, 1
    v_mul_u32_u24 v23, 640, v19
    v_bfrev_b32 v24, 1
    v_subrev_u32 v20, s78, v18
    v_add_u32 v20, 0, v20
    v_cmp_gt_u32 vcc, 18, v20
    v_lshl_add_u32 v21, v20, 4, v23
    s_nop 0
    v_cndmask_b32 v244, v24, v21, vcc
    v_subrev_u32 v20, s78, v18
    v_add_u32 v20, 16, v20
    v_cmp_gt_u32 vcc, 18, v20
    v_lshl_add_u32 v21, v20, 4, v23
    s_nop 0
    v_cndmask_b32 v245, v24, v21, vcc
    v_cmp_eq_u32 vcc, 4, v18
    v_add_u32 v21, 288, v23
    s_nop 0
    v_cndmask_b32 v245, v245, v21, vcc
    v_cmp_gt_u32 vcc, 3, v19
    s_nop 1
    v_cndmask_b32 v244, v24, v244, vcc
    v_cndmask_b32 v245, v24, v245, vcc
    s_and_b32 s78, s8, 7
    s_lshl_b32 s78, s78, 2
    s_add_u32 s78, s78, s9
    s_lshl_b32 s78, s78, 4
    s_add_u32 s78, s78, s6
    s_mul_i32 s30, s78, 1920
    s_add_u32 s30, s30, 65536
    v_mov_b32 v25, 162880
    v_mov_b32 v26, 1
    s_waitcnt lgkmcnt(0)
    s_mul_i32 s76, s76, 0x9e3779b1
    s_add_u32 s76, s76, 0x7f4a7c15
    s_waitcnt lgkmcnt(0)
    s_barrier
    ds_read_b128 v[108:111], v11 offset:0
    ds_read_b128 v[112:115], v11 offset:2048
    ds_read_b64_tr_b16 v[68:69], v9 offset:0
    ds_read_b64_tr_b16 v[70:71], v9 offset:144
    ds_read_b64_tr_b16 v[72:73], v9 offset:32
    ds_read_b64_tr_b16 v[74:75], v9 offset:176
    ds_read_b64_tr_b16 v[76:77], v9 offset:64
    ds_read_b64_tr_b16 v[78:79], v9 offset:208
    ds_read_b64_tr_b16 v[80:81], v9 offset:96
    ds_read_b64_tr_b16 v[82:83], v9 offset:240
    ds_read_b64_tr_b16 v[84:85], v10 offset:128
    ds_read_b64_tr_b16 v[86:87], v10 offset:272
    s_waitcnt lgkmcnt(8)
    v_mfma_f32_16x16x32_bf16 v[28:31], v[68:71], v[108:111], 0
    ds_read_b128 v[116:119], v12 offset:0
    ds_read_b128 v[120:123], v12 offset:2048
    v_mfma_f32_16x16x32_bf16 v[48:51], v[68:71], v[112:115], 0
    ds_read_b64_tr_b16 v[88:89], v9 offset:4608
    ds_read_b64_tr_b16 v[90:91], v9 offset:4752
    s_waitcnt lgkmcnt(10)
    v_mfma_f32_16x16x32_bf16 v[32:35], v[72:75], v[108:111], 0
    ds_read_b64_tr_b16 v[92:93], v9 offset:4640
    ds_read_b64_tr_b16 v[94:95], v9 offset:4784
    v_mfma_f32_16x16x32_bf16 v[52:55], v[72:75], v[112:115], 0
    ds_read_b64_tr_b16 v[96:97], v9 offset:4672
    ds_read_b64_tr_b16 v[98:99], v9 offset:4816
    s_waitcnt lgkmcnt(12)
    v_mfma_f32_16x16x32_bf16 v[36:39], v[76:79], v[108:111], 0
    ds_read_b64_tr_b16 v[100:101], v9 offset:4704
    v_mfma_f32_16x16x32_bf16 v[56:59], v[76:79], v[112:115], 0
    ds_read_b64_tr_b16 v[102:103], v9 offset:4848
    s_waitcnt lgkmcnt(12)
    v_mfma_f32_16x16x32_bf16 v[40:43], v[80:83], v[108:111], 0
    ds_read_b64_tr_b16 v[104:105], v10 offset:4736
    v_mfma_f32_16x16x32_bf16 v[60:63], v[80:83], v[112:115], 0
    ds_read_b64_tr_b16 v[106:107], v10 offset:4880
    s_waitcnt lgkmcnt(12)
    v_mfma_f32_16x16x32_bf16 v[44:47], v[84:87], v[108:111], 0
    v_mfma_f32_16x16x32_bf16 v[64:67], v[84:87], v[112:115], 0
    ds_read_b64_tr_b16 v[140:141], v248 offset:0
    ds_read_b64_tr_b16 v[142:143], v249 offset:0
    s_nop 0
    ds_read_b64_tr_b16 v[144:145], v250 offset:0
    ds_read_b64_tr_b16 v[146:147], v251 offset:0
    ds_read_b64_tr_b16 v[148:149], v252 offset:0
    ds_read_b64_tr_b16 v[150:151], v248 offset:8
    ds_read_b64_tr_b16 v[152:153], v249 offset:8
    ds_read_b64_tr_b16 v[154:155], v250 offset:8
    ds_read_b64_tr_b16 v[156:157], v251 offset:8
    ds_read_b64_tr_b16 v[158:159], v252 offset:8
    ds_read_b64_tr_b16 v[160:161], v248 offset:16
    ds_read_b64_tr_b16 v[162:163], v249 offset:16
    ds_read_b64_tr_b16 v[164:165], v250 offset:16
    ds_read_b64_tr_b16 v[166:167], v251 offset:16
    ds_read_b64_tr_b16 v[168:169], v252 offset:16
    ds_read_b64_tr_b16 v[170:171], v248 offset:24
    ds_read_b64_tr_b16 v[172:173], v249 offset:24
    ds_read_b64_tr_b16 v[174:175], v250 offset:24
    ds_read_b64_tr_b16 v[176:177], v251 offset:24
    ds_read_b64_tr_b16 v[178:179], v252 offset:24
    ds_read_b64_tr_b16 v[180:181], v248 offset:32
    ds_read_b64_tr_b16 v[182:183], v249 offset:32
    ds_read_b64_tr_b16 v[184:185], v250 offset:32
    ds_read_b64_tr_b16 v[186:187], v251 offset:32
    ds_read_b64_tr_b16 v[188:189], v252 offset:32
    s_waitcnt lgkmcnt(0)
    s_barrier
    v_mfma_f32_16x16x32_bf16 v[28:31], v[88:91], v[116:119], v[28:31]
    ds_read_b128 v[108:111], v11 offset:16384
    ds_read_b128 v[112:115], v11 offset:18432
    v_mfma_f32_16x16x32_bf16 v[48:51], v[88:91], v[120:123], v[48:51]
    ds_read_b64_tr_b16 v[68:69], v9 offset:9216
    ds_read_b64_tr_b16 v[70:71], v9 offset:9360
    v_mfma_f32_16x16x32_bf16 v[32:35], v[92:95], v[116:119], v[32:35]
    ds_read_b64_tr_b16 v[72:73], v9 offset:9248
    v_mfma_f32_16x16x32_bf16 v[52:55], v[92:95], v[120:123], v[52:55]
    ds_read_b64_tr_b16 v[74:75], v9 offset:9392
    v_mfma_f32_16x16x32_bf16 v[36:39], v[96:99], v[116:119], v[36:39]
    ds_read_b64_tr_b16 v[76:77], v9 offset:9280
    v_mfma_f32_16x16x32_bf16 v[56:59], v[96:99], v[120:123], v[56:59]
    ds_read_b64_tr_b16 v[78:79], v9 offset:9424
    v_mfma_f32_16x16x32_bf16 v[40:43], v[100:103], v[116:119], v[40:43]
    ds_read_b64_tr_b16 v[80:81], v9 offset:9312
    v_mfma_f32_16x16x32_bf16 v[60:63], v[100:103], v[120:123], v[60:63]
    ds_read_b64_tr_b16 v[82:83], v9 offset:9456
    v_mfma_f32_16x16x32_bf16 v[44:47], v[104:107], v[116:119], v[44:47]
    ds_read_b64_tr_b16 v[84:85], v10 offset:9344
    v_mfma_f32_16x16x32_bf16 v[64:67], v[104:107], v[120:123], v[64:67]
    ds_read_b64_tr_b16 v[86:87], v10 offset:9488
    s_waitcnt lgkmcnt(8)
    v_mfma_f32_16x16x32_bf16 v[28:31], v[68:71], v[108:111], v[28:31]
    ds_read_b128 v[116:119], v12 offset:16384
    ds_read_b128 v[120:123], v12 offset:18432
    v_mfma_f32_16x16x32_bf16 v[48:51], v[68:71], v[112:115], v[48:51]
    ds_read_b64_tr_b16 v[88:89], v9 offset:13824
    ds_read_b64_tr_b16 v[90:91], v9 offset:13968
    s_waitcnt lgkmcnt(10)
    v_mfma_f32_16x16x32_bf16 v[32:35], v[72:75], v[108:111], v[32:35]
    ds_read_b64_tr_b16 v[92:93], v9 offset:13856
    ds_read_b64_tr_b16 v[94:95], v9 offset:14000
    v_mfma_f32_16x16x32_bf16 v[52:55], v[72:75], v[112:115], v[52:55]
    ds_read_b64_tr_b16 v[96:97], v9 offset:13888
    ds_read_b64_tr_b16 v[98:99], v9 offset:14032
    s_waitcnt lgkmcnt(12)
    v_mfma_f32_16x16x32_bf16 v[36:39], v[76:79], v[108:111], v[36:39]
    ds_read_b64_tr_b16 v[100:101], v9 offset:13920
    v_mfma_f32_16x16x32_bf16 v[56:59], v[76:79], v[112:115], v[56:59]
    ds_read_b64_tr_b16 v[102:103], v9 offset:14064
    s_waitcnt lgkmcnt(12)
    v_mfma_f32_16x16x32_bf16 v[40:43], v[80:83], v[108:111], v[40:43]
    ds_read_b64_tr_b16 v[104:105], v10 offset:13952
    v_mfma_f32_16x16x32_bf16 v[60:63], v[80:83], v[112:115], v[60:63]
    ds_read_b64_tr_b16 v[106:107], v10 offset:14096
    s_waitcnt lgkmcnt(12)
    v_mfma_f32_16x16x32_bf16 v[44:47], v[84:87], v[108:111], v[44:47]
    v_mfma_f32_16x16x32_bf16 v[64:67], v[84:87], v[112:115], v[64:67]
    s_waitcnt lgkmcnt(0)
    s_barrier
    v_mfma_f32_16x16x32_bf16 v[28:31], v[88:91], v[116:119], v[28:31]
    ds_read_b128 v[108:111], v11 offset:51200
    ds_read_b128 v[112:115], v11 offset:53248
    v_mfma_f32_16x16x32_bf16 v[48:51], v[88:91], v[120:123], v[48:51]
    ds_read_b64_tr_b16 v[68:69], v9 offset:34816
    ds_read_b64_tr_b16 v[70:71], v9 offset:34960
    v_mfma_f32_16x16x32_bf16 v[32:35], v[92:95], v[116:119], v[32:35]
    ds_read_b64_tr_b16 v[72:73], v9 offset:34848
    v_mfma_f32_16x16x32_bf16 v[52:55], v[92:95], v[120:123], v[52:55]
    ds_read_b64_tr_b16 v[74:75], v9 offset:34992
    v_mfma_f32_16x16x32_bf16 v[36:39], v[96:99], v[116:119], v[36:39]
    ds_read_b64_tr_b16 v[76:77], v9 offset:34880
    v_mfma_f32_16x16x32_bf16 v[56:59], v[96:99], v[120:123], v[56:59]
    ds_read_b64_tr_b16 v[78:79], v9 offset:35024
    v_mfma_f32_16x16x32_bf16 v[40:43], v[100:103], v[116:119], v[40:43]
    ds_read_b64_tr_b16 v[80:81], v9 offset:34912
    v_mfma_f32_16x16x32_bf16 v[60:63], v[100:103], v[120:123], v[60:63]
    ds_read_b64_tr_b16 v[82:83], v9 offset:35056
    v_mfma_f32_16x16x32_bf16 v[44:47], v[104:107], v[116:119], v[44:47]
    ds_read_b64_tr_b16 v[84:85], v10 offset:34944
    v_mfma_f32_16x16x32_bf16 v[64:67], v[104:107], v[120:123], v[64:67]
    ds_read_b64_tr_b16 v[86:87], v10 offset:35088
    s_waitcnt lgkmcnt(8)
    v_mfma_f32_16x16x32_bf16 v[28:31], v[68:71], v[108:111], v[28:31]
    ds_read_b128 v[116:119], v12 offset:51200
    ds_read_b128 v[120:123], v12 offset:53248
    v_mfma_f32_16x16x32_bf16 v[48:51], v[68:71], v[112:115], v[48:51]
    ds_read_b64_tr_b16 v[88:89], v9 offset:39424
    ds_read_b64_tr_b16 v[90:91], v9 offset:39568
    s_waitcnt lgkmcnt(10)
    v_mfma_f32_16x16x32_bf16 v[32:35], v[72:75], v[108:111], v[32:35]
    ds_read_b64_tr_b16 v[92:93], v9 offset:39456
    ds_read_b64_tr_b16 v[94:95], v9 offset:39600
    v_mfma_f32_16x16x32_bf16 v[52:55], v[72:75], v[112:115], v[52:55]
    ds_read_b64_tr_b16 v[96:97], v9 offset:39488
    ds_read_b64_tr_b16 v[98:99], v9 offset:39632
    s_waitcnt lgkmcnt(12)
    v_mfma_f32_16x16x32_bf16 v[36:39], v[76:79], v[108:111], v[36:39]
    ds_read_b64_tr_b16 v[100:101], v9 offset:39520
    v_mfma_f32_16x16x32_bf16 v[56:59], v[76:79], v[112:115], v[56:59]
    ds_read_b64_tr_b16 v[102:103], v9 offset:39664
    s_waitcnt lgkmcnt(12)
    v_mfma_f32_16x16x32_bf16 v[40:43], v[80:83], v[108:111], v[40:43]
    ds_read_b64_tr_b16 v[104:105], v10 offset:39552
    v_mfma_f32_16x16x32_bf16 v[60:63], v[80:83], v[112:115], v[60:63]
    ds_read_b64_tr_b16 v[106:107], v10 offset:39696
    s_waitcnt lgkmcnt(12)
    v_mfma_f32_16x16x32_bf16 v[44:47], v[84:87], v[108:111], v[44:47]
    v_mfma_f32_16x16x32_bf16 v[64:67], v[84:87], v[112:115], v[64:67]
    s_waitcnt lgkmcnt(0)
    s_barrier
    v_mfma_f32_16x16x32_bf16 v[28:31], v[88:91], v[116:119], v[28:31]
    ds_read_b128 v[108:111], v11 offset:0
    ds_read_b128 v[112:115], v11 offset:2048
    v_mfma_f32_16x16x32_bf16 v[48:51], v[88:91], v[120:123], v[48:51]
    ds_read_b64_tr_b16 v[68:69], v9 offset:0
    ds_read_b64_tr_b16 v[70:71], v9 offset:144
    v_mfma_f32_16x16x32_bf16 v[32:35], v[92:95], v[116:119], v[32:35]
    ds_read_b64_tr_b16 v[72:73], v9 offset:32
    v_mfma_f32_16x16x32_bf16 v[52:55], v[92:95], v[120:123], v[52:55]
    ds_read_b64_tr_b16 v[74:75], v9 offset:176
    v_mfma_f32_16x16x32_bf16 v[36:39], v[96:99], v[116:119], v[36:39]
    ds_read_b64_tr_b16 v[76:77], v9 offset:64
    v_mfma_f32_16x16x32_bf16 v[56:59], v[96:99], v[120:123], v[56:59]
    ds_read_b64_tr_b16 v[78:79], v9 offset:208
    v_mfma_f32_16x16x32_bf16 v[40:43], v[100:103], v[116:119], v[40:43]
    ds_read_b64_tr_b16 v[80:81], v9 offset:96
    v_mfma_f32_16x16x32_bf16 v[60:63], v[100:103], v[120:123], v[60:63]
    ds_read_b64_tr_b16 v[82:83], v9 offset:240
    v_mfma_f32_16x16x32_bf16 v[44:47], v[104:107], v[116:119], v[44:47]
    ds_read_b64_tr_b16 v[84:85], v10 offset:128
    v_mfma_f32_16x16x32_bf16 v[64:67], v[104:107], v[120:123], v[64:67]
    ds_read_b64_tr_b16 v[86:87], v10 offset:272
    s_waitcnt lgkmcnt(8)
    v_mfma_f32_16x16x32_bf16 v[28:31], v[68:71], v[108:111], v[28:31]
    ds_read_b128 v[116:119], v12 offset:0
    ds_read_b128 v[120:123], v12 offset:2048
    v_mfma_f32_16x16x32_bf16 v[48:51], v[68:71], v[112:115], v[48:51]
    ds_read_b64_tr_b16 v[88:89], v9 offset:4608
    ds_read_b64_tr_b16 v[90:91], v9 offset:4752
    s_waitcnt lgkmcnt(10)
    v_mfma_f32_16x16x32_bf16 v[32:35], v[72:75], v[108:111], v[32:35]
    ds_read_b64_tr_b16 v[92:93], v9 offset:4640
    ds_read_b64_tr_b16 v[94:95], v9 offset:4784
    v_mfma_f32_16x16x32_bf16 v[52:55], v[72:75], v[112:115], v[52:55]
    ds_read_b64_tr_b16 v[96:97], v9 offset:4672
    ds_read_b64_tr_b16 v[98:99], v9 offset:4816
    s_waitcnt lgkmcnt(12)
    v_mfma_f32_16x16x32_bf16 v[36:39], v[76:79], v[108:111], v[36:39]
    ds_read_b64_tr_b16 v[100:101], v9 offset:4704
    v_mfma_f32_16x16x32_bf16 v[56:59], v[76:79], v[112:115], v[56:59]
    ds_read_b64_tr_b16 v[102:103], v9 offset:4848
    s_waitcnt lgkmcnt(12)
    v_mfma_f32_16x16x32_bf16 v[40:43], v[80:83], v[108:111], v[40:43]
    ds_read_b64_tr_b16 v[104:105], v10 offset:4736
    v_mfma_f32_16x16x32_bf16 v[60:63], v[80:83], v[112:115], v[60:63]
    ds_read_b64_tr_b16 v[106:107], v10 offset:4880
    s_waitcnt lgkmcnt(12)
    v_mfma_f32_16x16x32_bf16 v[44:47], v[84:87], v[108:111], v[44:47]
    v_mfma_f32_16x16x32_bf16 v[64:67], v[84:87], v[112:115], v[64:67]
    s_waitcnt lgkmcnt(0)
    s_barrier
    v_mfma_f32_16x16x32_bf16 v[28:31], v[88:91], v[116:119], v[28:31]
    ds_read_b128 v[108:111], v11 offset:16384
    ds_read_b128 v[112:115], v11 offset:18432
    v_mfma_f32_16x16x32_bf16 v[48:51], v[88:91], v[120:123], v[48:51]
    ds_read_b64_tr_b16 v[68:69], v9 offset:9216
    ds_read_b64_tr_b16 v[70:71], v9 offset:9360
    v_mfma_f32_16x16x32_bf16 v[32:35], v[92:95], v[116:119], v[32:35]
    ds_read_b64_tr_b16 v[72:73], v9 offset:9248
    v_mfma_f32_16x16x32_bf16 v[52:55], v[92:95], v[120:123], v[52:55]
    ds_read_b64_tr_b16 v[74:75], v9 offset:9392
    v_mfma_f32_16x16x32_bf16 v[36:39], v[96:99], v[116:119], v[36:39]
    ds_read_b64_tr_b16 v[76:77], v9 offset:9280
    v_mfma_f32_16x16x32_bf16 v[56:59], v[96:99], v[120:123], v[56:59]
    ds_read_b64_tr_b16 v[78:79], v9 offset:9424
    v_mfma_f32_16x16x32_bf16 v[40:43], v[100:103], v[116:119], v[40:43]
    ds_read_b64_tr_b16 v[80:81], v9 offset:9312
    v_mfma_f32_16x16x32_bf16 v[60:63], v[100:103], v[120:123], v[60:63]
    ds_read_b64_tr_b16 v[82:83], v9 offset:9456
    v_mfma_f32_16x16x32_bf16 v[44:47], v[104:107], v[116:119], v[44:47]
    ds_read_b64_tr_b16 v[84:85], v10 offset:9344
    v_mfma_f32_16x16x32_bf16 v[64:67], v[104:107], v[120:123], v[64:67]
    ds_read_b64_tr_b16 v[86:87], v10 offset:9488
    s_waitcnt lgkmcnt(8)
    v_mfma_f32_16x16x32_bf16 v[28:31], v[68:71], v[108:111], v[28:31]
    ds_read_b128 v[116:119], v12 offset:16384
    ds_read_b128 v[120:123], v12 offset:18432
    v_mfma_f32_16x16x32_bf16 v[48:51], v[68:71], v[112:115], v[48:51]
    ds_read_b64_tr_b16 v[88:89], v9 offset:13824
    ds_read_b64_tr_b16 v[90:91], v9 offset:13968
    s_waitcnt lgkmcnt(10)
    v_mfma_f32_16x16x32_bf16 v[32:35], v[72:75], v[108:111], v[32:35]
    ds_read_b64_tr_b16 v[92:93], v9 offset:13856
    ds_read_b64_tr_b16 v[94:95], v9 offset:14000
    v_mfma_f32_16x16x32_bf16 v[52:55], v[72:75], v[112:115], v[52:55]
    ds_read_b64_tr_b16 v[96:97], v9 offset:13888
    ds_read_b64_tr_b16 v[98:99], v9 offset:14032
    s_waitcnt lgkmcnt(12)
    v_mfma_f32_16x16x32_bf16 v[36:39], v[76:79], v[108:111], v[36:39]
    ds_read_b64_tr_b16 v[100:101], v9 offset:13920
    v_mfma_f32_16x16x32_bf16 v[56:59], v[76:79], v[112:115], v[56:59]
    ds_read_b64_tr_b16 v[102:103], v9 offset:14064
    s_waitcnt lgkmcnt(12)
    v_mfma_f32_16x16x32_bf16 v[40:43], v[80:83], v[108:111], v[40:43]
    ds_read_b64_tr_b16 v[104:105], v10 offset:13952
    v_mfma_f32_16x16x32_bf16 v[60:63], v[80:83], v[112:115], v[60:63]
    ds_read_b64_tr_b16 v[106:107], v10 offset:14096
    s_waitcnt lgkmcnt(12)
    v_mfma_f32_16x16x32_bf16 v[44:47], v[84:87], v[108:111], v[44:47]
    v_mfma_f32_16x16x32_bf16 v[64:67], v[84:87], v[112:115], v[64:67]
    s_waitcnt lgkmcnt(0)
    s_barrier
    v_mfma_f32_16x16x32_bf16 v[28:31], v[88:91], v[116:119], v[28:31]
    ds_read_b128 v[108:111], v11 offset:51200
    ds_read_b128 v[112:115], v11 offset:53248
    v_mfma_f32_16x16x32_bf16 v[48:51], v[88:91], v[120:123], v[48:51]
    ds_read_b64_tr_b16 v[68:69], v9 offset:34816
    ds_read_b64_tr_b16 v[70:71], v9 offset:34960
    v_mfma_f32_16x16x32_bf16 v[32:35], v[92:95], v[116:119], v[32:35]
    ds_read_b64_tr_b16 v[72:73], v9 offset:34848
    v_mfma_f32_16x16x32_bf16 v[52:55], v[92:95], v[120:123], v[52:55]
    ds_read_b64_tr_b16 v[74:75], v9 offset:34992
    v_mfma_f32_16x16x32_bf16 v[36:39], v[96:99], v[116:119], v[36:39]
    ds_read_b64_tr_b16 v[76:77], v9 offset:34880
    v_mfma_f32_16x16x32_bf16 v[56:59], v[96:99], v[120:123], v[56:59]
    ds_read_b64_tr_b16 v[78:79], v9 offset:35024
    v_mfma_f32_16x16x32_bf16 v[40:43], v[100:103], v[116:119], v[40:43]
    ds_read_b64_tr_b16 v[80:81], v9 offset:34912
    v_mfma_f32_16x16x32_bf16 v[60:63], v[100:103], v[120:123], v[60:63]
    ds_read_b64_tr_b16 v[82:83], v9 offset:35056
    v_mfma_f32_16x16x32_bf16 v[44:47], v[104:107], v[116:119], v[44:47]
    ds_read_b64_tr_b16 v[84:85], v10 offset:34944
    v_mfma_f32_16x16x32_bf16 v[64:67], v[104:107], v[120:123], v[64:67]
    ds_read_b64_tr_b16 v[86:87], v10 offset:35088
    s_waitcnt lgkmcnt(8)
    v_mfma_f32_16x16x32_bf16 v[28:31], v[68:71], v[108:111], v[28:31]
    ds_read_b128 v[116:119], v12 offset:51200
    ds_read_b128 v[120:123], v12 offset:53248
    v_mfma_f32_16x16x32_bf16 v[48:51], v[68:71], v[112:115], v[48:51]
    ds_read_b64_tr_b16 v[88:89], v9 offset:39424
    ds_read_b64_tr_b16 v[90:91], v9 offset:39568
    s_waitcnt lgkmcnt(10)
    v_mfma_f32_16x16x32_bf16 v[32:35], v[72:75], v[108:111], v[32:35]
    ds_read_b64_tr_b16 v[92:93], v9 offset:39456
    ds_read_b64_tr_b16 v[94:95], v9 offset:39600
    v_mfma_f32_16x16x32_bf16 v[52:55], v[72:75], v[112:115], v[52:55]
    ds_read_b64_tr_b16 v[96:97], v9 offset:39488
    ds_read_b64_tr_b16 v[98:99], v9 offset:39632
    s_waitcnt lgkmcnt(12)
    v_mfma_f32_16x16x32_bf16 v[36:39], v[76:79], v[108:111], v[36:39]
    ds_read_b64_tr_b16 v[100:101], v9 offset:39520
    v_mfma_f32_16x16x32_bf16 v[56:59], v[76:79], v[112:115], v[56:59]
    ds_read_b64_tr_b16 v[102:103], v9 offset:39664
    s_waitcnt lgkmcnt(12)
    v_mfma_f32_16x16x32_bf16 v[40:43], v[80:83], v[108:111], v[40:43]
    ds_read_b64_tr_b16 v[104:105], v10 offset:39552
    v_mfma_f32_16x16x32_bf16 v[60:63], v[80:83], v[112:115], v[60:63]
    ds_read_b64_tr_b16 v[106:107], v10 offset:39696
    s_waitcnt lgkmcnt(12)
    v_mfma_f32_16x16x32_bf16 v[44:47], v[84:87], v[108:111], v[44:47]
    v_mfma_f32_16x16x32_bf16 v[64:67], v[84:87], v[112:115], v[64:67]
    s_waitcnt lgkmcnt(0)
    s_barrier
    v_mfma_f32_16x16x32_bf16 v[28:31], v[88:91], v[116:119], v[28:31]
    ds_read_b128 v[108:111], v11 offset:0
    ds_read_b128 v[112:115], v11 offset:2048
    v_mfma_f32_16x16x32_bf16 v[48:51], v[88:91], v[120:123], v[48:51]
    ds_read_b64_tr_b16 v[68:69], v9 offset:0
    ds_read_b64_tr_b16 v[70:71], v9 offset:144
    v_mfma_f32_16x16x32_bf16 v[32:35], v[92:95], v[116:119], v[32:35]
    ds_read_b64_tr_b16 v[72:73], v9 offset:32
    v_mfma_f32_16x16x32_bf16 v[52:55], v[92:95], v[120:123], v[52:55]
    ds_read_b64_tr_b16 v[74:75], v9 offset:176
    v_mfma_f32_16x16x32_bf16 v[36:39], v[96:99], v[116:119], v[36:39]
    ds_read_b64_tr_b16 v[76:77], v9 offset:64
    v_mfma_f32_16x16x32_bf16 v[56:59], v[96:99], v[120:123], v[56:59]
    ds_read_b64_tr_b16 v[78:79], v9 offset:208
    v_mfma_f32_16x16x32_bf16 v[40:43], v[100:103], v[116:119], v[40:43]
    ds_read_b64_tr_b16 v[80:81], v9 offset:96
    v_mfma_f32_16x16x32_bf16 v[60:63], v[100:103], v[120:123], v[60:63]
    ds_read_b64_tr_b16 v[82:83], v9 offset:240
    v_mfma_f32_16x16x32_bf16 v[44:47], v[104:107], v[116:119], v[44:47]
    ds_read_b64_tr_b16 v[84:85], v10 offset:128
    v_mfma_f32_16x16x32_bf16 v[64:67], v[104:107], v[120:123], v[64:67]
    ds_read_b64_tr_b16 v[86:87], v10 offset:272
    s_waitcnt lgkmcnt(8)
    v_mfma_f32_16x16x32_bf16 v[28:31], v[68:71], v[108:111], v[28:31]
    ds_read_b128 v[116:119], v12 offset:0
    ds_read_b128 v[120:123], v12 offset:2048
    v_mfma_f32_16x16x32_bf16 v[48:51], v[68:71], v[112:115], v[48:51]
    ds_read_b64_tr_b16 v[88:89], v9 offset:4608
    ds_read_b64_tr_b16 v[90:91], v9 offset:4752
    s_waitcnt lgkmcnt(10)
    v_mfma_f32_16x16x32_bf16 v[32:35], v[72:75], v[108:111], v[32:35]
    ds_read_b64_tr_b16 v[92:93], v9 offset:4640
    ds_read_b64_tr_b16 v[94:95], v9 offset:4784
    v_mfma_f32_16x16x32_bf16 v[52:55], v[72:75], v[112:115], v[52:55]
    ds_read_b64_tr_b16 v[96:97], v9 offset:4672
    ds_read_b64_tr_b16 v[98:99], v9 offset:4816
    s_waitcnt lgkmcnt(12)
    v_mfma_f32_16x16x32_bf16 v[36:39], v[76:79], v[108:111], v[36:39]
    ds_read_b64_tr_b16 v[100:101], v9 offset:4704
    v_mfma_f32_16x16x32_bf16 v[56:59], v[76:79], v[112:115], v[56:59]
    ds_read_b64_tr_b16 v[102:103], v9 offset:4848
    s_waitcnt lgkmcnt(12)
    v_mfma_f32_16x16x32_bf16 v[40:43], v[80:83], v[108:111], v[40:43]
    ds_read_b64_tr_b16 v[104:105], v10 offset:4736
    v_mfma_f32_16x16x32_bf16 v[60:63], v[80:83], v[112:115], v[60:63]
    ds_read_b64_tr_b16 v[106:107], v10 offset:4880
    s_waitcnt lgkmcnt(12)
    v_mfma_f32_16x16x32_bf16 v[44:47], v[84:87], v[108:111], v[44:47]
    v_mfma_f32_16x16x32_bf16 v[64:67], v[84:87], v[112:115], v[64:67]
    s_waitcnt lgkmcnt(0)
    s_barrier
    v_mfma_f32_16x16x32_bf16 v[28:31], v[88:91], v[116:119], v[28:31]
    ds_read_b128 v[108:111], v11 offset:16384
    ds_read_b128 v[112:115], v11 offset:18432
    v_mfma_f32_16x16x32_bf16 v[48:51], v[88:91], v[120:123], v[48:51]
    ds_read_b64_tr_b16 v[68:69], v9 offset:9216
    ds_read_b64_tr_b16 v[70:71], v9 offset:9360
    v_mfma_f32_16x16x32_bf16 v[32:35], v[92:95], v[116:119], v[32:35]
    ds_read_b64_tr_b16 v[72:73], v9 offset:9248
    v_mfma_f32_16x16x32_bf16 v[52:55], v[92:95], v[120:123], v[52:55]
    ds_read_b64_tr_b16 v[74:75], v9 offset:9392
    v_mfma_f32_16x16x32_bf16 v[36:39], v[96:99], v[116:119], v[36:39]
    ds_read_b64_tr_b16 v[76:77], v9 offset:9280
    v_mfma_f32_16x16x32_bf16 v[56:59], v[96:99], v[120:123], v[56:59]
    ds_read_b64_tr_b16 v[78:79], v9 offset:9424
    v_mfma_f32_16x16x32_bf16 v[40:43], v[100:103], v[116:119], v[40:43]
    ds_read_b64_tr_b16 v[80:81], v9 offset:9312
    v_mfma_f32_16x16x32_bf16 v[60:63], v[100:103], v[120:123], v[60:63]
    ds_read_b64_tr_b16 v[82:83], v9 offset:9456
    v_mfma_f32_16x16x32_bf16 v[44:47], v[104:107], v[116:119], v[44:47]
    ds_read_b64_tr_b16 v[84:85], v10 offset:9344
    v_mfma_f32_16x16x32_bf16 v[64:67], v[104:107], v[120:123], v[64:67]
    ds_read_b64_tr_b16 v[86:87], v10 offset:9488
    s_waitcnt lgkmcnt(8)
    v_mfma_f32_16x16x32_bf16 v[28:31], v[68:71], v[108:111], v[28:31]
    ds_read_b128 v[116:119], v12 offset:16384
    ds_read_b128 v[120:123], v12 offset:18432
    v_mfma_f32_16x16x32_bf16 v[48:51], v[68:71], v[112:115], v[48:51]
    ds_read_b64_tr_b16 v[88:89], v9 offset:13824
    ds_read_b64_tr_b16 v[90:91], v9 offset:13968
    s_waitcnt lgkmcnt(10)
    v_mfma_f32_16x16x32_bf16 v[32:35], v[72:75], v[108:111], v[32:35]
    ds_read_b64_tr_b16 v[92:93], v9 offset:13856
    ds_read_b64_tr_b16 v[94:95], v9 offset:14000
    v_mfma_f32_16x16x32_bf16 v[52:55], v[72:75], v[112:115], v[52:55]
    ds_read_b64_tr_b16 v[96:97], v9 offset:13888
    ds_read_b64_tr_b16 v[98:99], v9 offset:14032
    s_waitcnt lgkmcnt(12)
    v_mfma_f32_16x16x32_bf16 v[36:39], v[76:79], v[108:111], v[36:39]
    ds_read_b64_tr_b16 v[100:101], v9 offset:13920
    v_mfma_f32_16x16x32_bf16 v[56:59], v[76:79], v[112:115], v[56:59]
    ds_read_b64_tr_b16 v[102:103], v9 offset:14064
    s_waitcnt lgkmcnt(12)
    v_mfma_f32_16x16x32_bf16 v[40:43], v[80:83], v[108:111], v[40:43]
    ds_read_b64_tr_b16 v[104:105], v10 offset:13952
    v_mfma_f32_16x16x32_bf16 v[60:63], v[80:83], v[112:115], v[60:63]
    ds_read_b64_tr_b16 v[106:107], v10 offset:14096
    s_waitcnt lgkmcnt(12)
    v_mfma_f32_16x16x32_bf16 v[44:47], v[84:87], v[108:111], v[44:47]
    v_mfma_f32_16x16x32_bf16 v[64:67], v[84:87], v[112:115], v[64:67]
    s_waitcnt lgkmcnt(0)
    s_barrier
    v_mfma_f32_16x16x32_bf16 v[28:31], v[88:91], v[116:119], v[28:31]
    ds_read_b128 v[108:111], v11 offset:51200
    ds_read_b128 v[112:115], v11 offset:53248
    v_mfma_f32_16x16x32_bf16 v[48:51], v[88:91], v[120:123], v[48:51]
    ds_read_b64_tr_b16 v[68:69], v9 offset:34816
    ds_read_b64_tr_b16 v[70:71], v9 offset:34960
    v_mfma_f32_16x16x32_bf16 v[32:35], v[92:95], v[116:119], v[32:35]
    ds_read_b64_tr_b16 v[72:73], v9 offset:34848
    v_mfma_f32_16x16x32_bf16 v[52:55], v[92:95], v[120:123], v[52:55]
    ds_read_b64_tr_b16 v[74:75], v9 offset:34992
    v_mfma_f32_16x16x32_bf16 v[36:39], v[96:99], v[116:119], v[36:39]
    ds_read_b64_tr_b16 v[76:77], v9 offset:34880
    v_mfma_f32_16x16x32_bf16 v[56:59], v[96:99], v[120:123], v[56:59]
    ds_read_b64_tr_b16 v[78:79], v9 offset:35024
    v_mfma_f32_16x16x32_bf16 v[40:43], v[100:103], v[116:119], v[40:43]
    ds_read_b64_tr_b16 v[80:81], v9 offset:34912
    v_mfma_f32_16x16x32_bf16 v[60:63], v[100:103], v[120:123], v[60:63]
    ds_read_b64_tr_b16 v[82:83], v9 offset:35056
    v_mfma_f32_16x16x32_bf16 v[44:47], v[104:107], v[116:119], v[44:47]
    ds_read_b64_tr_b16 v[84:85], v10 offset:34944
    v_mfma_f32_16x16x32_bf16 v[64:67], v[104:107], v[120:123], v[64:67]
    ds_read_b64_tr_b16 v[86:87], v10 offset:35088
    s_waitcnt lgkmcnt(8)
    v_mfma_f32_16x16x32_bf16 v[28:31], v[68:71], v[108:111], v[28:31]
    ds_read_b128 v[116:119], v12 offset:51200
    ds_read_b128 v[120:123], v12 offset:53248
    v_mfma_f32_16x16x32_bf16 v[48:51], v[68:71], v[112:115], v[48:51]
    ds_read_b64_tr_b16 v[88:89], v9 offset:39424
    ds_read_b64_tr_b16 v[90:91], v9 offset:39568
    s_waitcnt lgkmcnt(10)
    v_mfma_f32_16x16x32_bf16 v[32:35], v[72:75], v[108:111], v[32:35]
    ds_read_b64_tr_b16 v[92:93], v9 offset:39456
    ds_read_b64_tr_b16 v[94:95], v9 offset:39600
    v_mfma_f32_16x16x32_bf16 v[52:55], v[72:75], v[112:115], v[52:55]
    ds_read_b64_tr_b16 v[96:97], v9 offset:39488
    ds_read_b64_tr_b16 v[98:99], v9 offset:39632
    s_waitcnt lgkmcnt(12)
    v_mfma_f32_16x16x32_bf16 v[36:39], v[76:79], v[108:111], v[36:39]
    ds_read_b64_tr_b16 v[100:101], v9 offset:39520
    v_mfma_f32_16x16x32_bf16 v[56:59], v[76:79], v[112:115], v[56:59]
    ds_read_b64_tr_b16 v[102:103], v9 offset:39664
    s_waitcnt lgkmcnt(12)
    v_mfma_f32_16x16x32_bf16 v[40:43], v[80:83], v[108:111], v[40:43]
    ds_read_b64_tr_b16 v[104:105], v10 offset:39552
    v_mfma_f32_16x16x32_bf16 v[60:63], v[80:83], v[112:115], v[60:63]
    ds_read_b64_tr_b16 v[106:107], v10 offset:39696
    s_waitcnt lgkmcnt(12)
    v_mfma_f32_16x16x32_bf16 v[44:47], v[84:87], v[108:111], v[44:47]
    v_mfma_f32_16x16x32_bf16 v[64:67], v[84:87], v[112:115], v[64:67]
    s_setprio 2
    s_waitcnt lgkmcnt(8)
    v_mfma_f32_16x16x32_bf16 v[28:31], v[88:91], v[116:119], v[28:31]
    v_mfma_f32_16x16x32_bf16 v[48:51], v[88:91], v[120:123], v[48:51]
    s_waitcnt lgkmcnt(6)
    v_mfma_f32_16x16x32_bf16 v[32:35], v[92:95], v[116:119], v[32:35]
    v_mfma_f32_16x16x32_bf16 v[52:55], v[92:95], v[120:123], v[52:55]
    s_waitcnt lgkmcnt(4)
    v_mfma_f32_16x16x32_bf16 v[36:39], v[96:99], v[116:119], v[36:39]
    v_mfma_f32_16x16x32_bf16 v[56:59], v[96:99], v[120:123], v[56:59]
    s_waitcnt lgkmcnt(2)
    v_mfma_f32_16x16x32_bf16 v[40:43], v[100:103], v[116:119], v[40:43]
    v_mfma_f32_16x16x32_bf16 v[60:63], v[100:103], v[120:123], v[60:63]
    s_waitcnt lgkmcnt(0)
    v_mfma_f32_16x16x32_bf16 v[44:47], v[104:107], v[116:119], v[44:47]
    v_mfma_f32_16x16x32_bf16 v[64:67], v[104:107], v[120:123], v[64:67]
    s_mov_b64 exec, 1
    ds_add_u32 v25, v26 offset:4
    s_mov_b64 exec, -1
    v_cvt_pk_bf16_f32 v68, v28, v29
    v_cvt_pk_bf16_f32 v69, v30, v31
    v_cvt_pk_bf16_f32 v70, v32, v33
    v_cvt_pk_bf16_f32 v71, v34, v35
    v_cvt_pk_bf16_f32 v72, v36, v37
    v_cvt_pk_bf16_f32 v73, v38, v39
    v_cvt_pk_bf16_f32 v74, v40, v41
    v_cvt_pk_bf16_f32 v75, v42, v43
    v_cvt_pk_bf16_f32 v76, v44, v45
    v_cvt_pk_bf16_f32 v77, v46, v47
    s_nop 1
    v_mfma_f32_16x16x16_bf16 v[190:193], v[148:149], v[76:77], 0
    v_cvt_pk_bf16_f32 v78, v48, v49
    v_mfma_f32_16x16x16_bf16 v[194:197], v[158:159], v[76:77], 0
    v_cvt_pk_bf16_f32 v79, v50, v51
    v_mfma_f32_16x16x16_bf16 v[198:201], v[168:169], v[76:77], 0
    v_cvt_pk_bf16_f32 v80, v52, v53
    v_mfma_f32_16x16x16_bf16 v[202:205], v[178:179], v[76:77], 0
    v_cvt_pk_bf16_f32 v81, v54, v55
    v_mfma_f32_16x16x16_bf16 v[206:209], v[188:189], v[76:77], 0
    v_cvt_pk_bf16_f32 v82, v56, v57
    v_mfma_f32_16x16x32_bf16 v[190:193], v[140:143], v[68:71], v[190:193]
    v_cvt_pk_bf16_f32 v83, v58, v59
    v_mfma_f32_16x16x32_bf16 v[194:197], v[150:153], v[68:71], v[194:197]
    v_cvt_pk_bf16_f32 v84, v60, v61
    v_mfma_f32_16x16x32_bf16 v[198:201], v[160:163], v[68:71], v[198:201]
    v_cvt_pk_bf16_f32 v85, v62, v63
    v_mfma_f32_16x16x32_bf16 v[202:205], v[170:173], v[68:71], v[202:205]
    v_cvt_pk_bf16_f32 v86, v64, v65
    v_mfma_f32_16x16x32_bf16 v[206:209], v[180:183], v[68:71], v[206:209]
    v_cvt_pk_bf16_f32 v87, v66, v67
    v_mfma_f32_16x16x32_bf16 v[190:193], v[144:147], v[72:75], v[190:193]
    v_mfma_f32_16x16x32_bf16 v[194:197], v[154:157], v[72:75], v[194:197]
    v_mfma_f32_16x16x32_bf16 v[198:201], v[164:167], v[72:75], v[198:201]
    v_mfma_f32_16x16x32_bf16 v[202:205], v[174:177], v[72:75], v[202:205]
    v_mfma_f32_16x16x32_bf16 v[206:209], v[184:187], v[72:75], v[206:209]
    s_mov_b32 s78, 1069066811
    v_mfma_f32_16x16x16_bf16 v[210:213], v[148:149], v[86:87], 0
    v_mfma_f32_16x16x16_bf16 v[214:217], v[158:159], v[86:87], 0
    v_mfma_f32_16x16x16_bf16 v[218:221], v[168:169], v[86:87], 0
    v_mfma_f32_16x16x16_bf16 v[222:225], v[178:179], v[86:87], 0
    v_mfma_f32_16x16x16_bf16 v[226:229], v[188:189], v[86:87], 0
    v_max3_f32 v58, v190, v191, v192
    v_min3_f32 v60, v190, v191, v192
    v_max3_f32 v58, v58, v193, v194
    v_min3_f32 v60, v60, v193, v194
    v_mfma_f32_16x16x32_bf16 v[210:213], v[140:143], v[78:81], v[210:213]
    v_max3_f32 v58, v58, v195, v196
    v_min3_f32 v60, v60, v195, v196
    v_max3_f32 v58, v58, v197, v198
    v_min3_f32 v60, v60, v197, v198
    v_mfma_f32_16x16x32_bf16 v[214:217], v[150:153], v[78:81], v[214:217]
    v_max3_f32 v58, v58, v199, v200
    v_min3_f32 v60, v60, v199, v200
    v_max3_f32 v58, v58, v201, v202
    v_min3_f32 v60, v60, v201, v202
    v_mfma_f32_16x16x32_bf16 v[218:221], v[160:163], v[78:81], v[218:221]
    v_max3_f32 v58, v58, v203, v204
    v_min3_f32 v60, v60, v203, v204
    v_max3_f32 v58, v58, v205, v206
    v_min3_f32 v60, v60, v205, v206
    v_mfma_f32_16x16x32_bf16 v[222:225], v[170:173], v[78:81], v[222:225]
    v_max_f32 v58, v58, v207
    v_min_f32 v60, v60, v207
    v_mul_f32 v58, s78, v58
    v_mul_f32_e64 v60, s78, v60
    v_mfma_f32_16x16x32_bf16 v[226:229], v[180:183], v[78:81], v[226:229]
    v_fma_f32 v40, v190, s78, -v58
    v_fma_f32 v190, -v190, s78, v60
    v_fma_f32 v41, v191, s78, -v58
    v_fma_f32 v191, -v191, s78, v60
    v_mfma_f32_16x16x32_bf16 v[210:213], v[144:147], v[82:85], v[210:213]
    v_fma_f32 v42, v192, s78, -v58
    v_fma_f32 v192, -v192, s78, v60
    v_fma_f32 v43, v193, s78, -v58
    v_fma_f32 v193, -v193, s78, v60
    v_mfma_f32_16x16x32_bf16 v[214:217], v[154:157], v[82:85], v[214:217]
    v_fma_f32 v44, v194, s78, -v58
    v_fma_f32 v194, -v194, s78, v60
    v_fma_f32 v45, v195, s78, -v58
    v_fma_f32 v195, -v195, s78, v60
    v_mfma_f32_16x16x32_bf16 v[218:221], v[164:167], v[82:85], v[218:221]
    v_fma_f32 v46, v196, s78, -v58
    v_fma_f32 v196, -v196, s78, v60
    v_fma_f32 v47, v197, s78, -v58
    v_fma_f32 v197, -v197, s78, v60
    v_mfma_f32_16x16x32_bf16 v[222:225], v[174:177], v[82:85], v[222:225]
    v_fma_f32 v48, v198, s78, -v58
    v_fma_f32 v198, -v198, s78, v60
    v_fma_f32 v49, v199, s78, -v58
    v_fma_f32 v199, -v199, s78, v60
    v_mfma_f32_16x16x32_bf16 v[226:229], v[184:187], v[82:85], v[226:229]
    v_fma_f32 v50, v200, s78, -v58
    v_fma_f32 v200, -v200, s78, v60
    v_fma_f32 v51, v201, s78, -v58
    v_fma_f32 v201, -v201, s78, v60
    v_fma_f32 v52, v202, s78, -v58
    v_fma_f32 v202, -v202, s78, v60
    v_fma_f32 v53, v203, s78, -v58
    v_fma_f32 v203, -v203, s78, v60
    v_fma_f32 v54, v204, s78, -v58
    v_fma_f32 v204, -v204, s78, v60
    v_fma_f32 v55, v205, s78, -v58
    v_fma_f32 v205, -v205, s78, v60
    v_fma_f32 v56, v206, s78, -v58
    v_fma_f32 v206, -v206, s78, v60
    v_fma_f32 v57, v207, s78, -v58
    v_fma_f32 v207, -v207, s78, v60
    s_setprio 0
    v_exp_f32 v40, v40
    v_exp_f32 v190, v190
    v_exp_f32 v41, v41
    v_exp_f32 v191, v191
    v_exp_f32 v42, v42
    v_exp_f32 v192, v192
    v_add_f32 v62, v40, v41
    v_add_f32 v64, v190, v191
    v_exp_f32 v43, v43
    v_exp_f32 v193, v193
    v_add_f32 v62, v62, v42
    v_add_f32 v64, v64, v192
    v_exp_f32 v44, v44
    v_exp_f32 v194, v194
    v_add_f32 v62, v62, v43
    v_add_f32 v64, v64, v193
    v_exp_f32 v45, v45
    v_exp_f32 v195, v195
    v_add_f32 v62, v62, v44
    v_add_f32 v64, v64, v194
    v_exp_f32 v46, v46
    v_exp_f32 v196, v196
    v_add_f32 v62, v62, v45
    v_add_f32 v64, v64, v195
    v_exp_f32 v47, v47
    v_exp_f32 v197, v197
    v_add_f32 v62, v62, v46
    v_add_f32 v64, v64, v196
    v_exp_f32 v48, v48
    v_exp_f32 v198, v198
    v_add_f32 v62, v62, v47
    v_add_f32 v64, v64, v197
    v_exp_f32 v49, v49
    v_exp_f32 v199, v199
    v_add_f32 v62, v62, v48
    v_add_f32 v64, v64, v198
    v_exp_f32 v50, v50
    v_exp_f32 v200, v200
    v_add_f32 v62, v62, v49
    v_add_f32 v64, v64, v199
    v_exp_f32 v51, v51
    v_exp_f32 v201, v201
    v_add_f32 v62, v62, v50
    v_add_f32 v64, v64, v200
    v_exp_f32 v52, v52
    v_exp_f32 v202, v202
    v_add_f32 v62, v62, v51
    v_add_f32 v64, v64, v201
    v_exp_f32 v53, v53
    v_exp_f32 v203, v203
    v_add_f32 v62, v62, v52
    v_add_f32 v64, v64, v202
    v_exp_f32 v54, v54
    v_exp_f32 v204, v204
    v_add_f32 v62, v62, v53
    v_add_f32 v64, v64, v203
    v_exp_f32 v55, v55
    v_exp_f32 v205, v205
    v_add_f32 v62, v62, v54
    v_add_f32 v64, v64, v204
    v_exp_f32 v56, v56
    v_exp_f32 v206, v206
    v_add_f32 v62, v62, v55
    v_add_f32 v64, v64, v205
    v_exp_f32 v57, v57
    v_exp_f32 v207, v207
    v_add_f32 v62, v62, v56
    v_add_f32 v64, v64, v206
    v_add_f32 v62, v62, v57
    v_add_f32 v64, v64, v207
    v_rcp_f32 v58, v62
    v_rcp_f32 v60, v64
    s_setprio 2
    v_mul_f32 v40, v58, v40
    v_mul_f32 v41, v58, v41
    v_cvt_pk_bf16_f32 v88, v40, v41
    v_mul_f32 v42, v58, v42
    v_mul_f32 v43, v58, v43
    v_cvt_pk_bf16_f32 v89, v42, v43
    ds_write_b64 v240, v[88:89] offset:0
    v_mul_f32 v44, v58, v44
    v_mul_f32 v45, v58, v45
    v_cvt_pk_bf16_f32 v90, v44, v45
    v_mul_f32 v46, v58, v46
    v_mul_f32 v47, v58, v47
    v_cvt_pk_bf16_f32 v91, v46, v47
    ds_write_b64 v240, v[90:91] offset:24
    v_mul_f32 v48, v58, v48
    v_mul_f32 v49, v58, v49
    v_cvt_pk_bf16_f32 v92, v48, v49
    v_mul_f32 v50, v58, v50
    v_mul_f32 v51, v58, v51
    v_cvt_pk_bf16_f32 v93, v50, v51
    ds_write_b64 v240, v[92:93] offset:48
    v_mul_f32 v52, v58, v52
    v_mul_f32 v53, v58, v53
    v_cvt_pk_bf16_f32 v94, v52, v53
    v_mul_f32 v54, v58, v54
    v_mul_f32 v55, v58, v55
    v_cvt_pk_bf16_f32 v95, v54, v55
    ds_write_b64 v240, v[94:95] offset:8
    v_mul_f32 v56, v58, v56
    v_mul_f32 v57, v58, v57
    v_cvt_pk_bf16_f32 v96, v56, v57
    v_mul_f32 v190, v60, v190
    v_mul_f32 v191, v60, v191
    v_cvt_pk_bf16_f32 v97, v190, v191
    ds_write_b64 v240, v[96:97] offset:32
    v_mul_f32 v192, v60, v192
    v_mul_f32 v193, v60, v193
    v_cvt_pk_bf16_f32 v98, v192, v193
    v_mul_f32 v194, v60, v194
    v_mul_f32 v195, v60, v195
    v_cvt_pk_bf16_f32 v99, v194, v195
    ds_write_b64 v240, v[98:99] offset:56
    v_mul_f32 v196, v60, v196
    v_mul_f32 v197, v60, v197
    v_cvt_pk_bf16_f32 v100, v196, v197
    v_mul_f32 v198, v60, v198
    v_mul_f32 v199, v60, v199
    v_cvt_pk_bf16_f32 v101, v198, v199
    ds_write_b64 v240, v[100:101] offset:16
    v_mul_f32 v200, v60, v200
    v_mul_f32 v201, v60, v201
    v_cvt_pk_bf16_f32 v102, v200, v201
    v_mul_f32 v202, v60, v202
    v_mul_f32 v203, v60, v203
    v_cvt_pk_bf16_f32 v103, v202, v203
    ds_write_b64 v240, v[102:103] offset:40
    v_mul_f32 v204, v60, v204
    v_mul_f32 v205, v60, v205
    v_cvt_pk_bf16_f32 v104, v204, v205
    v_mul_f32 v206, v60, v206
    v_mul_f32 v207, v60, v207
    v_cvt_pk_bf16_f32 v105, v206, v207
    ds_write_b64 v240, v[104:105] offset:64
    v_max3_f32 v58, v210, v211, v212
    v_min3_f32 v60, v210, v211, v212
    v_max3_f32 v58, v58, v213, v214
    v_min3_f32 v60, v60, v213, v214
    v_max3_f32 v58, v58, v215, v216
    v_min3_f32 v60, v60, v215, v216
    v_max3_f32 v58, v58, v217, v218
    v_min3_f32 v60, v60, v217, v218
    v_max3_f32 v58, v58, v219, v220
    v_min3_f32 v60, v60, v219, v220
    v_max3_f32 v58, v58, v221, v222
    v_min3_f32 v60, v60, v221, v222
    v_max3_f32 v58, v58, v223, v224
    v_min3_f32 v60, v60, v223, v224
    v_max3_f32 v58, v58, v225, v226
    v_min3_f32 v60, v60, v225, v226
    v_max_f32 v58, v58, v227
    v_min_f32 v60, v60, v227
    v_mul_f32 v58, s78, v58
    v_mul_f32 v60, s78, v60
    v_fma_f32 v40, v210, s78, -v58
    v_fma_f32 v210, -v210, s78, v60
    v_fma_f32 v41, v211, s78, -v58
    v_fma_f32 v211, -v211, s78, v60
    v_fma_f32 v42, v212, s78, -v58
    v_fma_f32 v212, -v212, s78, v60
    v_fma_f32 v43, v213, s78, -v58
    v_fma_f32 v213, -v213, s78, v60
    v_fma_f32 v44, v214, s78, -v58
    v_fma_f32 v214, -v214, s78, v60
    v_fma_f32 v45, v215, s78, -v58
    v_fma_f32 v215, -v215, s78, v60
    v_fma_f32 v46, v216, s78, -v58
    v_fma_f32 v216, -v216, s78, v60
    v_fma_f32 v47, v217, s78, -v58
    v_fma_f32 v217, -v217, s78, v60
    v_fma_f32 v48, v218, s78, -v58
    v_fma_f32 v218, -v218, s78, v60
    v_fma_f32 v49, v219, s78, -v58
    v_fma_f32 v219, -v219, s78, v60
    v_fma_f32 v50, v220, s78, -v58
    v_fma_f32 v220, -v220, s78, v60
    v_fma_f32 v51, v221, s78, -v58
    v_fma_f32 v221, -v221, s78, v60
    v_fma_f32 v52, v222, s78, -v58
    v_fma_f32 v222, -v222, s78, v60
    v_fma_f32 v53, v223, s78, -v58
    v_fma_f32 v223, -v223, s78, v60
    v_fma_f32 v54, v224, s78, -v58
    v_fma_f32 v224, -v224, s78, v60
    v_fma_f32 v55, v225, s78, -v58
    v_fma_f32 v225, -v225, s78, v60
    v_fma_f32 v56, v226, s78, -v58
    v_fma_f32 v226, -v226, s78, v60
    v_fma_f32 v57, v227, s78, -v58
    v_fma_f32 v227, -v227, s78, v60
    s_setprio 0
    v_exp_f32 v40, v40
    v_exp_f32 v210, v210
    v_exp_f32 v41, v41
    v_exp_f32 v211, v211
    v_exp_f32 v42, v42
    v_exp_f32 v212, v212
    v_add_f32 v62, v40, v41
    v_add_f32 v64, v210, v211
    v_exp_f32 v43, v43
    v_exp_f32 v213, v213
    v_add_f32 v62, v62, v42
    v_add_f32 v64, v64, v212
    v_exp_f32 v44, v44
    v_exp_f32 v214, v214
    v_add_f32 v62, v62, v43
    v_add_f32 v64, v64, v213
    v_exp_f32 v45, v45
    v_exp_f32 v215, v215
    v_add_f32 v62, v62, v44
    v_add_f32 v64, v64, v214
    v_exp_f32 v46, v46
    v_exp_f32 v216, v216
    v_add_f32 v62, v62, v45
    v_add_f32 v64, v64, v215
    v_exp_f32 v47, v47
    v_exp_f32 v217, v217
    v_add_f32 v62, v62, v46
    v_add_f32 v64, v64, v216
    v_exp_f32 v48, v48
    v_exp_f32 v218, v218
    v_add_f32 v62, v62, v47
    v_add_f32 v64, v64, v217
    v_exp_f32 v49, v49
    v_exp_f32 v219, v219
    v_add_f32 v62, v62, v48
    v_add_f32 v64, v64, v218
    v_exp_f32 v50, v50
    v_exp_f32 v220, v220
    v_add_f32 v62, v62, v49
    v_add_f32 v64, v64, v219
    v_exp_f32 v51, v51
    v_exp_f32 v221, v221
    v_add_f32 v62, v62, v50
    v_add_f32 v64, v64, v220
    v_exp_f32 v52, v52
    v_exp_f32 v222, v222
    v_add_f32 v62, v62, v51
    v_add_f32 v64, v64, v221
    v_exp_f32 v53, v53
    v_exp_f32 v223, v223
    v_add_f32 v62, v62, v52
    v_add_f32 v64, v64, v222
    v_exp_f32 v54, v54
    v_exp_f32 v224, v224
    v_add_f32 v62, v62, v53
    v_add_f32 v64, v64, v223
    v_exp_f32 v55, v55
    v_exp_f32 v225, v225
    v_add_f32 v62, v62, v54
    v_add_f32 v64, v64, v224
    v_exp_f32 v56, v56
    v_exp_f32 v226, v226
    v_add_f32 v62, v62, v55
    v_add_f32 v64, v64, v225
    v_exp_f32 v57, v57
    v_exp_f32 v227, v227
    v_add_f32 v62, v62, v56
    v_add_f32 v64, v64, v226
    v_add_f32 v62, v62, v57
    v_add_f32 v64, v64, v227
    v_rcp_f32 v58, v62
    v_rcp_f32 v60, v64
    s_setprio 2
    v_mul_f32 v40, v58, v40
    v_mul_f32 v41, v58, v41
    v_cvt_pk_bf16_f32 v106, v40, v41
    v_mul_f32 v42, v58, v42
    v_mul_f32 v43, v58, v43
    v_cvt_pk_bf16_f32 v107, v42, v43
    ds_write_b64 v240, v[106:107] offset:4736
    v_mul_f32 v44, v58, v44
    v_mul_f32 v45, v58, v45
    v_cvt_pk_bf16_f32 v108, v44, v45
    v_mul_f32 v46, v58, v46
    v_mul_f32 v47, v58, v47
    v_cvt_pk_bf16_f32 v109, v46, v47
    ds_write_b64 v240, v[108:109] offset:4760
    v_mul_f32 v48, v58, v48
    v_mul_f32 v49, v58, v49
    v_cvt_pk_bf16_f32 v110, v48, v49
    v_mul_f32 v50, v58, v50
    v_mul_f32 v51, v58, v51
    v_cvt_pk_bf16_f32 v111, v50, v51
    ds_write_b64 v240, v[110:111] offset:4784
    v_mul_f32 v52, v58, v52
    v_mul_f32 v53, v58, v53
    v_cvt_pk_bf16_f32 v112, v52, v53
    v_mul_f32 v54, v58, v54
    v_mul_f32 v55, v58, v55
    v_cvt_pk_bf16_f32 v113, v54, v55
    ds_write_b64 v240, v[112:113] offset:4744
    v_mul_f32 v56, v58, v56
    v_mul_f32 v57, v58, v57
    v_cvt_pk_bf16_f32 v114, v56, v57
    v_mul_f32 v210, v60, v210
    v_mul_f32 v211, v60, v211
    v_cvt_pk_bf16_f32 v115, v210, v211
    ds_write_b64 v240, v[114:115] offset:4768
    v_mul_f32 v212, v60, v212
    v_mul_f32 v213, v60, v213
    v_cvt_pk_bf16_f32 v116, v212, v213
    v_mul_f32 v214, v60, v214
    v_mul_f32 v215, v60, v215
    v_cvt_pk_bf16_f32 v117, v214, v215
    ds_write_b64 v240, v[116:117] offset:4792
    v_mul_f32 v216, v60, v216
    v_mul_f32 v217, v60, v217
    v_cvt_pk_bf16_f32 v118, v216, v217
    v_mul_f32 v218, v60, v218
    v_mul_f32 v219, v60, v219
    v_cvt_pk_bf16_f32 v119, v218, v219
    ds_write_b64 v240, v[118:119] offset:4752
    v_mul_f32 v220, v60, v220
    v_mul_f32 v221, v60, v221
    v_cvt_pk_bf16_f32 v120, v220, v221
    v_mul_f32 v222, v60, v222
    v_mul_f32 v223, v60, v223
    v_cvt_pk_bf16_f32 v121, v222, v223
    ds_write_b64 v240, v[120:121] offset:4776
    v_mul_f32 v224, v60, v224
    v_mul_f32 v225, v60, v225
    v_cvt_pk_bf16_f32 v122, v224, v225
    v_mul_f32 v226, v60, v226
    v_mul_f32 v227, v60, v227
    v_cvt_pk_bf16_f32 v123, v226, v227
    ds_write_b64 v240, v[122:123] offset:4800
    s_waitcnt lgkmcnt(0)
    s_barrier
    ds_read_b64_tr_b16 v[164:165], v242 offset:0
    ds_read_b64_tr_b16 v[166:167], v242 offset:152
    ds_read_b64_tr_b16 v[168:169], v243 offset:0
    ds_read_b64_tr_b16 v[170:171], v243 offset:152
    ds_read_b64_tr_b16 v[152:153], v241 offset:0
    ds_read_b64_tr_b16 v[154:155], v241 offset:296
    ds_read_b64_tr_b16 v[156:157], v241 offset:24
    ds_read_b64_tr_b16 v[158:159], v241 offset:320
    ds_read_b64_tr_b16 v[160:161], v241 offset:48
    ds_read_b64_tr_b16 v[162:163], v241 offset:344
    ds_read_b64_tr_b16 v[184:185], v242 offset:4864
    ds_read_b64_tr_b16 v[186:187], v242 offset:5016
    ds_read_b64_tr_b16 v[188:189], v243 offset:4864
    ds_read_b64_tr_b16 v[190:191], v243 offset:5016
    buffer_load_dwordx4 v[28:31], v128, s[48:51], s16 offen sc1
    buffer_load_dwordx4 v[32:35], v128, s[48:51], s17 offen sc1
    buffer_load_dwordx4 v[36:39], v128, s[48:51], s18 offen sc1
    v_mov_b32 v71, s76
    v_mov_b32 v75, s76
    v_mov_b32 v79, s76
    v_mov_b32 v83, s76
    s_waitcnt lgkmcnt(8)
    v_mfma_f32_16x16x32_bf16 v[40:43], v[152:155], v[164:167], 0
    ds_read_b64_tr_b16 v[172:173], v241 offset:9472
    ds_read_b64_tr_b16 v[174:175], v241 offset:9768
    v_mfma_f32_16x16x32_bf16 v[52:55], v[152:155], v[168:171], 0
    ds_read_b64_tr_b16 v[176:177], v241 offset:9496
    ds_read_b64_tr_b16 v[178:179], v241 offset:9792
    s_waitcnt lgkmcnt(10)
    v_mfma_f32_16x16x32_bf16 v[44:47], v[156:159], v[164:167], 0
    ds_read_b64_tr_b16 v[180:181], v241 offset:9520
    ds_read_b64_tr_b16 v[182:183], v241 offset:9816
    v_mfma_f32_16x16x32_bf16 v[56:59], v[156:159], v[168:171], 0
    ds_read_b64_tr_b16 v[204:205], v242 offset:9728
    ds_read_b64_tr_b16 v[206:207], v242 offset:9880
    s_waitcnt lgkmcnt(12)
    v_mfma_f32_16x16x32_bf16 v[48:51], v[160:163], v[164:167], 0
    ds_read_b64_tr_b16 v[208:209], v243 offset:9728
    ds_read_b64_tr_b16 v[210:211], v243 offset:9880
    v_mfma_f32_16x16x32_bf16 v[60:63], v[160:163], v[168:171], 0
    ds_read_b64_tr_b16 v[192:193], v241 offset:18944
    ds_read_b64_tr_b16 v[194:195], v241 offset:19240
    s_waitcnt lgkmcnt(10)
    v_mfma_f32_16x16x32_bf16 v[40:43], v[172:175], v[184:187], v[40:43]
    ds_read_b64_tr_b16 v[196:197], v241 offset:18968
    ds_read_b64_tr_b16 v[198:199], v241 offset:19264
    v_mfma_f32_16x16x32_bf16 v[52:55], v[172:175], v[188:191], v[52:55]
    ds_read_b64_tr_b16 v[200:201], v241 offset:18992
    ds_read_b64_tr_b16 v[202:203], v241 offset:19288
    s_waitcnt lgkmcnt(12)
    v_mfma_f32_16x16x32_bf16 v[44:47], v[176:179], v[184:187], v[44:47]
    ds_read_b64_tr_b16 v[224:225], v242 offset:14592
    ds_read_b64_tr_b16 v[226:227], v242 offset:14744
    v_mfma_f32_16x16x32_bf16 v[56:59], v[176:179], v[188:191], v[56:59]
    ds_read_b64_tr_b16 v[228:229], v243 offset:14592
    ds_read_b64_tr_b16 v[230:231], v243 offset:14744
    s_waitcnt lgkmcnt(14)
    v_mfma_f32_16x16x32_bf16 v[48:51], v[180:183], v[184:187], v[48:51]
    ds_read_b64_tr_b16 v[212:213], v241 offset:28416
    ds_read_b64_tr_b16 v[214:215], v241 offset:28712
    v_mfma_f32_16x16x32_bf16 v[60:63], v[180:183], v[188:191], v[60:63]
    ds_read_b64_tr_b16 v[216:217], v241 offset:28440
    ds_read_b64_tr_b16 v[218:219], v241 offset:28736
    s_waitcnt lgkmcnt(12)
    v_mfma_f32_16x16x32_bf16 v[40:43], v[192:195], v[204:207], v[40:43]
    ds_read_b64_tr_b16 v[220:221], v241 offset:28464
    ds_read_b64_tr_b16 v[222:223], v241 offset:28760
    v_mfma_f32_16x16x32_bf16 v[52:55], v[192:195], v[208:211], v[52:55]
    s_waitcnt lgkmcnt(12)
    v_mfma_f32_16x16x32_bf16 v[44:47], v[196:199], v[204:207], v[44:47]
    v_mfma_f32_16x16x32_bf16 v[56:59], v[196:199], v[208:211], v[56:59]
    s_waitcnt lgkmcnt(10)
    v_mfma_f32_16x16x32_bf16 v[48:51], v[200:203], v[204:207], v[48:51]
    v_mfma_f32_16x16x32_bf16 v[60:63], v[200:203], v[208:211], v[60:63]
    s_waitcnt lgkmcnt(4)
    v_mfma_f32_16x16x32_bf16 v[40:43], v[212:215], v[224:227], v[40:43]
    v_mfma_f32_16x16x32_bf16 v[52:55], v[212:215], v[228:231], v[52:55]
    s_waitcnt lgkmcnt(2)
    v_mfma_f32_16x16x32_bf16 v[44:47], v[216:219], v[224:227], v[44:47]
    v_mfma_f32_16x16x32_bf16 v[56:59], v[216:219], v[228:231], v[56:59]
    s_waitcnt lgkmcnt(0)
    v_mfma_f32_16x16x32_bf16 v[48:51], v[220:223], v[224:227], v[48:51]
    v_mfma_f32_16x16x32_bf16 v[60:63], v[220:223], v[228:231], v[60:63]
    s_nop 0
    v_cvt_pk_bf16_f32 v68, v40, v41
    v_cvt_pk_bf16_f32 v69, v42, v43
    s_nop 0
    v_cvt_pk_bf16_f32 v70, v44, v45
    buffer_store_dwordx4 v[68:71], v244, s[48:51], s30 offen offset:0 sc1
    v_cvt_pk_bf16_f32 v76, v52, v53
    v_cvt_pk_bf16_f32 v77, v54, v55
    v_cvt_pk_bf16_f32 v78, v56, v57
    buffer_store_dwordx4 v[76:79], v245, s[48:51], s30 offen offset:0 sc1
    v_cvt_pk_bf16_f32 v72, v46, v47
    v_cvt_pk_bf16_f32 v73, v48, v49
    v_cvt_pk_bf16_f32 v74, v50, v51
    buffer_store_dwordx4 v[72:75], v244, s[48:51], s30 offen offset:320 sc1
    v_cvt_pk_bf16_f32 v80, v58, v59
    v_cvt_pk_bf16_f32 v81, v60, v61
    v_cvt_pk_bf16_f32 v82, v62, v63
    buffer_store_dwordx4 v[80:83], v245, s[48:51], s30 offen offset:320 sc1
    s_setprio 0
    s_branch L_TK
L_KQ:
    s_lshr_b32 s10, s9, 1
    s_mul_i32 s78, s10, 144
    s_add_u32 s78, s78, 44032
    v_add_u32 v9, s78, v9
    v_add_u32 v10, s78, v10
    s_and_b32 s11, s9, 1
    s_lshl_b32 s78, s11, 13
    s_lshl_b32 s79, s9, 12
    s_sub_u32 s78, s78, s79
    v_add_u32 v11, s78, v11
    v_add_u32 v12, s78, v12
    s_add_u32 s78, s8, s10
    s_mul_i32 s10, s78, 393216
    s_lshl_b32 s78, s6, 1
    s_add_u32 s78, s78, s11
    s_lshl_b32 s78, s78, 10
    s_add_u32 s10, s10, s78
    s_add_u32 s10, s10, 1114112
    s_add_u32 s11, s10, 32768
    s_add_u32 s12, s10, 65536
    v_mul_u32_u24 v20, 98304, v19
    v_lshl_add_u32 v27, v18, 4, v20
    s_waitcnt lgkmcnt(0)
    s_mul_i32 s76, s76, 0x9e3779b1
    s_add_u32 s76, s76, 0x7f4a7c15
    s_waitcnt lgkmcnt(0)
    s_barrier
    ds_read_b64_tr_b16 v[190:191], v9 offset:0
    s_nop 0
    ds_read_b64_tr_b16 v[192:193], v9 offset:4608
    ds_read_b128 v[108:111], v11 offset:0
    ds_read_b128 v[112:115], v11 offset:2048
    ds_read_b128 v[116:119], v11 offset:4096
    ds_read_b128 v[120:123], v11 offset:6144
    ds_read_b64_tr_b16 v[194:195], v9 offset:32
    ds_read_b64_tr_b16 v[196:197], v9 offset:4640
    ds_read_b64_tr_b16 v[198:199], v9 offset:64
    ds_read_b64_tr_b16 v[200:201], v9 offset:4672
    ds_read_b64_tr_b16 v[202:203], v9 offset:96
    ds_read_b64_tr_b16 v[204:205], v9 offset:4704
    ds_read_b64_tr_b16 v[206:207], v10 offset:128
    ds_read_b64_tr_b16 v[208:209], v10 offset:4736
    s_waitcnt lgkmcnt(8)
    v_mfma_f32_16x16x32_bf16 v[28:31], v[190:193], v[108:111], 0
    ds_read_b64_tr_b16 v[210:211], v9 offset:9216
    v_mfma_f32_16x16x32_bf16 v[48:51], v[190:193], v[112:115], 0
    ds_read_b64_tr_b16 v[212:213], v9 offset:13824
    v_mfma_f32_16x16x32_bf16 v[68:71], v[190:193], v[116:119], 0
    ds_read_b128 v[230:233], v12 offset:0
    v_mfma_f32_16x16x32_bf16 v[88:91], v[190:193], v[120:123], 0
    ds_read_b128 v[234:237], v12 offset:2048
    s_waitcnt lgkmcnt(10)
    v_mfma_f32_16x16x32_bf16 v[32:35], v[194:197], v[108:111], 0
    ds_read_b128 v[238:241], v12 offset:4096
    v_mfma_f32_16x16x32_bf16 v[52:55], v[194:197], v[112:115], 0
    ds_read_b128 v[242:245], v12 offset:6144
    v_mfma_f32_16x16x32_bf16 v[72:75], v[194:197], v[116:119], 0
    ds_read_b64_tr_b16 v[214:215], v9 offset:9248
    v_mfma_f32_16x16x32_bf16 v[92:95], v[194:197], v[120:123], 0
    ds_read_b64_tr_b16 v[216:217], v9 offset:13856
    s_waitcnt lgkmcnt(12)
    v_mfma_f32_16x16x32_bf16 v[36:39], v[198:201], v[108:111], 0
    ds_read_b64_tr_b16 v[218:219], v9 offset:9280
    v_mfma_f32_16x16x32_bf16 v[56:59], v[198:201], v[112:115], 0
    ds_read_b64_tr_b16 v[220:221], v9 offset:13888
    v_mfma_f32_16x16x32_bf16 v[76:79], v[198:201], v[116:119], 0
    ds_read_b64_tr_b16 v[222:223], v9 offset:9312
    v_mfma_f32_16x16x32_bf16 v[96:99], v[198:201], v[120:123], 0
    ds_read_b64_tr_b16 v[224:225], v9 offset:13920
    s_waitcnt lgkmcnt(14)
    v_mfma_f32_16x16x32_bf16 v[40:43], v[202:205], v[108:111], 0
    ds_read_b64_tr_b16 v[226:227], v10 offset:9344
    v_mfma_f32_16x16x32_bf16 v[60:63], v[202:205], v[112:115], 0
    ds_read_b64_tr_b16 v[228:229], v10 offset:13952
    v_mfma_f32_16x16x32_bf16 v[80:83], v[202:205], v[116:119], 0
    v_mfma_f32_16x16x32_bf16 v[100:103], v[202:205], v[120:123], 0
    s_waitcnt lgkmcnt(14)
    v_mfma_f32_16x16x32_bf16 v[44:47], v[206:209], v[108:111], 0
    v_mfma_f32_16x16x32_bf16 v[64:67], v[206:209], v[112:115], 0
    v_mfma_f32_16x16x32_bf16 v[84:87], v[206:209], v[116:119], 0
    v_mfma_f32_16x16x32_bf16 v[104:107], v[206:209], v[120:123], 0
    ds_read_b64_tr_b16 v[140:141], v248 offset:0
    ds_read_b64_tr_b16 v[142:143], v249 offset:0
    s_nop 0
    ds_read_b64_tr_b16 v[144:145], v250 offset:0
    ds_read_b64_tr_b16 v[146:147], v251 offset:0
    ds_read_b64_tr_b16 v[148:149], v252 offset:0
    ds_read_b64_tr_b16 v[150:151], v248 offset:8
    ds_read_b64_tr_b16 v[152:153], v249 offset:8
    ds_read_b64_tr_b16 v[154:155], v250 offset:8
    ds_read_b64_tr_b16 v[156:157], v251 offset:8
    ds_read_b64_tr_b16 v[158:159], v252 offset:8
    ds_read_b64_tr_b16 v[160:161], v248 offset:16
    ds_read_b64_tr_b16 v[162:163], v249 offset:16
    ds_read_b64_tr_b16 v[164:165], v250 offset:16
    ds_read_b64_tr_b16 v[166:167], v251 offset:16
    ds_read_b64_tr_b16 v[168:169], v252 offset:16
    ds_read_b64_tr_b16 v[170:171], v248 offset:24
    ds_read_b64_tr_b16 v[172:173], v249 offset:24
    ds_read_b64_tr_b16 v[174:175], v250 offset:24
    ds_read_b64_tr_b16 v[176:177], v251 offset:24
    ds_read_b64_tr_b16 v[178:179], v252 offset:24
    ds_read_b64_tr_b16 v[180:181], v248 offset:32
    ds_read_b64_tr_b16 v[182:183], v249 offset:32
    ds_read_b64_tr_b16 v[184:185], v250 offset:32
    ds_read_b64_tr_b16 v[186:187], v251 offset:32
    ds_read_b64_tr_b16 v[188:189], v252 offset:32
    s_waitcnt lgkmcnt(0)
    s_barrier
    v_mfma_f32_16x16x32_bf16 v[28:31], v[210:213], v[230:233], v[28:31]
    ds_read_b64_tr_b16 v[190:191], v9 offset:18432
    v_mfma_f32_16x16x32_bf16 v[48:51], v[210:213], v[234:237], v[48:51]
    ds_read_b64_tr_b16 v[192:193], v9 offset:23040
    v_mfma_f32_16x16x32_bf16 v[68:71], v[210:213], v[238:241], v[68:71]
    ds_read_b128 v[108:111], v11 offset:16384
    v_mfma_f32_16x16x32_bf16 v[88:91], v[210:213], v[242:245], v[88:91]
    ds_read_b128 v[112:115], v11 offset:18432
    v_mfma_f32_16x16x32_bf16 v[32:35], v[214:217], v[230:233], v[32:35]
    ds_read_b128 v[116:119], v11 offset:20480
    v_mfma_f32_16x16x32_bf16 v[52:55], v[214:217], v[234:237], v[52:55]
    ds_read_b128 v[120:123], v11 offset:22528
    v_mfma_f32_16x16x32_bf16 v[72:75], v[214:217], v[238:241], v[72:75]
    ds_read_b64_tr_b16 v[194:195], v9 offset:18464
    v_mfma_f32_16x16x32_bf16 v[92:95], v[214:217], v[242:245], v[92:95]
    ds_read_b64_tr_b16 v[196:197], v9 offset:23072
    v_mfma_f32_16x16x32_bf16 v[36:39], v[218:221], v[230:233], v[36:39]
    ds_read_b64_tr_b16 v[198:199], v9 offset:18496
    v_mfma_f32_16x16x32_bf16 v[56:59], v[218:221], v[234:237], v[56:59]
    ds_read_b64_tr_b16 v[200:201], v9 offset:23104
    v_mfma_f32_16x16x32_bf16 v[76:79], v[218:221], v[238:241], v[76:79]
    ds_read_b64_tr_b16 v[202:203], v9 offset:18528
    v_mfma_f32_16x16x32_bf16 v[96:99], v[218:221], v[242:245], v[96:99]
    ds_read_b64_tr_b16 v[204:205], v9 offset:23136
    v_mfma_f32_16x16x32_bf16 v[40:43], v[222:225], v[230:233], v[40:43]
    ds_read_b64_tr_b16 v[206:207], v10 offset:18560
    v_mfma_f32_16x16x32_bf16 v[60:63], v[222:225], v[234:237], v[60:63]
    ds_read_b64_tr_b16 v[208:209], v10 offset:23168
    v_mfma_f32_16x16x32_bf16 v[80:83], v[222:225], v[238:241], v[80:83]
    v_mfma_f32_16x16x32_bf16 v[100:103], v[222:225], v[242:245], v[100:103]
    v_mfma_f32_16x16x32_bf16 v[44:47], v[226:229], v[230:233], v[44:47]
    v_mfma_f32_16x16x32_bf16 v[64:67], v[226:229], v[234:237], v[64:67]
    v_mfma_f32_16x16x32_bf16 v[84:87], v[226:229], v[238:241], v[84:87]
    v_mfma_f32_16x16x32_bf16 v[104:107], v[226:229], v[242:245], v[104:107]
    s_waitcnt lgkmcnt(8)
    v_mfma_f32_16x16x32_bf16 v[28:31], v[190:193], v[108:111], v[28:31]
    ds_read_b64_tr_b16 v[210:211], v9 offset:27648
    v_mfma_f32_16x16x32_bf16 v[48:51], v[190:193], v[112:115], v[48:51]
    ds_read_b64_tr_b16 v[212:213], v9 offset:32256
    v_mfma_f32_16x16x32_bf16 v[68:71], v[190:193], v[116:119], v[68:71]
    ds_read_b128 v[230:233], v12 offset:16384
    v_mfma_f32_16x16x32_bf16 v[88:91], v[190:193], v[120:123], v[88:91]
    ds_read_b128 v[234:237], v12 offset:18432
    s_waitcnt lgkmcnt(10)
    v_mfma_f32_16x16x32_bf16 v[32:35], v[194:197], v[108:111], v[32:35]
    ds_read_b128 v[238:241], v12 offset:20480
    v_mfma_f32_16x16x32_bf16 v[52:55], v[194:197], v[112:115], v[52:55]
    ds_read_b128 v[242:245], v12 offset:22528
    v_mfma_f32_16x16x32_bf16 v[72:75], v[194:197], v[116:119], v[72:75]
    ds_read_b64_tr_b16 v[214:215], v9 offset:27680
    v_mfma_f32_16x16x32_bf16 v[92:95], v[194:197], v[120:123], v[92:95]
    ds_read_b64_tr_b16 v[216:217], v9 offset:32288
    s_waitcnt lgkmcnt(12)
    v_mfma_f32_16x16x32_bf16 v[36:39], v[198:201], v[108:111], v[36:39]
    ds_read_b64_tr_b16 v[218:219], v9 offset:27712
    v_mfma_f32_16x16x32_bf16 v[56:59], v[198:201], v[112:115], v[56:59]
    ds_read_b64_tr_b16 v[220:221], v9 offset:32320
    v_mfma_f32_16x16x32_bf16 v[76:79], v[198:201], v[116:119], v[76:79]
    ds_read_b64_tr_b16 v[222:223], v9 offset:27744
    v_mfma_f32_16x16x32_bf16 v[96:99], v[198:201], v[120:123], v[96:99]
    ds_read_b64_tr_b16 v[224:225], v9 offset:32352
    s_waitcnt lgkmcnt(14)
    v_mfma_f32_16x16x32_bf16 v[40:43], v[202:205], v[108:111], v[40:43]
    ds_read_b64_tr_b16 v[226:227], v10 offset:27776
    v_mfma_f32_16x16x32_bf16 v[60:63], v[202:205], v[112:115], v[60:63]
    ds_read_b64_tr_b16 v[228:229], v10 offset:32384
    v_mfma_f32_16x16x32_bf16 v[80:83], v[202:205], v[116:119], v[80:83]
    v_mfma_f32_16x16x32_bf16 v[100:103], v[202:205], v[120:123], v[100:103]
    s_waitcnt lgkmcnt(14)
    v_mfma_f32_16x16x32_bf16 v[44:47], v[206:209], v[108:111], v[44:47]
    v_mfma_f32_16x16x32_bf16 v[64:67], v[206:209], v[112:115], v[64:67]
    v_mfma_f32_16x16x32_bf16 v[84:87], v[206:209], v[116:119], v[84:87]
    v_mfma_f32_16x16x32_bf16 v[104:107], v[206:209], v[120:123], v[104:107]
    s_waitcnt lgkmcnt(0)
    s_barrier
    v_mfma_f32_16x16x32_bf16 v[28:31], v[210:213], v[230:233], v[28:31]
    ds_read_b64_tr_b16 v[190:191], v9 offset:36864
    v_mfma_f32_16x16x32_bf16 v[48:51], v[210:213], v[234:237], v[48:51]
    ds_read_b64_tr_b16 v[192:193], v9 offset:41472
    v_mfma_f32_16x16x32_bf16 v[68:71], v[210:213], v[238:241], v[68:71]
    ds_read_b128 v[108:111], v11 offset:51200
    v_mfma_f32_16x16x32_bf16 v[88:91], v[210:213], v[242:245], v[88:91]
    ds_read_b128 v[112:115], v11 offset:53248
    v_mfma_f32_16x16x32_bf16 v[32:35], v[214:217], v[230:233], v[32:35]
    ds_read_b128 v[116:119], v11 offset:55296
    v_mfma_f32_16x16x32_bf16 v[52:55], v[214:217], v[234:237], v[52:55]
    ds_read_b128 v[120:123], v11 offset:57344
    v_mfma_f32_16x16x32_bf16 v[72:75], v[214:217], v[238:241], v[72:75]
    ds_read_b64_tr_b16 v[194:195], v9 offset:36896
    v_mfma_f32_16x16x32_bf16 v[92:95], v[214:217], v[242:245], v[92:95]
    ds_read_b64_tr_b16 v[196:197], v9 offset:41504
    v_mfma_f32_16x16x32_bf16 v[36:39], v[218:221], v[230:233], v[36:39]
    ds_read_b64_tr_b16 v[198:199], v9 offset:36928
    v_mfma_f32_16x16x32_bf16 v[56:59], v[218:221], v[234:237], v[56:59]
    ds_read_b64_tr_b16 v[200:201], v9 offset:41536
    v_mfma_f32_16x16x32_bf16 v[76:79], v[218:221], v[238:241], v[76:79]
    ds_read_b64_tr_b16 v[202:203], v9 offset:36960
    v_mfma_f32_16x16x32_bf16 v[96:99], v[218:221], v[242:245], v[96:99]
    ds_read_b64_tr_b16 v[204:205], v9 offset:41568
    v_mfma_f32_16x16x32_bf16 v[40:43], v[222:225], v[230:233], v[40:43]
    ds_read_b64_tr_b16 v[206:207], v10 offset:36992
    v_mfma_f32_16x16x32_bf16 v[60:63], v[222:225], v[234:237], v[60:63]
    ds_read_b64_tr_b16 v[208:209], v10 offset:41600
    v_mfma_f32_16x16x32_bf16 v[80:83], v[222:225], v[238:241], v[80:83]
    v_mfma_f32_16x16x32_bf16 v[100:103], v[222:225], v[242:245], v[100:103]
    v_mfma_f32_16x16x32_bf16 v[44:47], v[226:229], v[230:233], v[44:47]
    v_mfma_f32_16x16x32_bf16 v[64:67], v[226:229], v[234:237], v[64:67]
    v_mfma_f32_16x16x32_bf16 v[84:87], v[226:229], v[238:241], v[84:87]
    v_mfma_f32_16x16x32_bf16 v[104:107], v[226:229], v[242:245], v[104:107]
    s_waitcnt lgkmcnt(8)
    v_mfma_f32_16x16x32_bf16 v[28:31], v[190:193], v[108:111], v[28:31]
    ds_read_b64_tr_b16 v[210:211], v9 offset:46080
    v_mfma_f32_16x16x32_bf16 v[48:51], v[190:193], v[112:115], v[48:51]
    ds_read_b64_tr_b16 v[212:213], v9 offset:50688
    v_mfma_f32_16x16x32_bf16 v[68:71], v[190:193], v[116:119], v[68:71]
    ds_read_b128 v[230:233], v12 offset:51200
    v_mfma_f32_16x16x32_bf16 v[88:91], v[190:193], v[120:123], v[88:91]
    ds_read_b128 v[234:237], v12 offset:53248
    s_waitcnt lgkmcnt(10)
    v_mfma_f32_16x16x32_bf16 v[32:35], v[194:197], v[108:111], v[32:35]
    ds_read_b128 v[238:241], v12 offset:55296
    v_mfma_f32_16x16x32_bf16 v[52:55], v[194:197], v[112:115], v[52:55]
    ds_read_b128 v[242:245], v12 offset:57344
    v_mfma_f32_16x16x32_bf16 v[72:75], v[194:197], v[116:119], v[72:75]
    ds_read_b64_tr_b16 v[214:215], v9 offset:46112
    v_mfma_f32_16x16x32_bf16 v[92:95], v[194:197], v[120:123], v[92:95]
    ds_read_b64_tr_b16 v[216:217], v9 offset:50720
    s_waitcnt lgkmcnt(12)
    v_mfma_f32_16x16x32_bf16 v[36:39], v[198:201], v[108:111], v[36:39]
    ds_read_b64_tr_b16 v[218:219], v9 offset:46144
    v_mfma_f32_16x16x32_bf16 v[56:59], v[198:201], v[112:115], v[56:59]
    ds_read_b64_tr_b16 v[220:221], v9 offset:50752
    v_mfma_f32_16x16x32_bf16 v[76:79], v[198:201], v[116:119], v[76:79]
    ds_read_b64_tr_b16 v[222:223], v9 offset:46176
    v_mfma_f32_16x16x32_bf16 v[96:99], v[198:201], v[120:123], v[96:99]
    ds_read_b64_tr_b16 v[224:225], v9 offset:50784
    s_waitcnt lgkmcnt(14)
    v_mfma_f32_16x16x32_bf16 v[40:43], v[202:205], v[108:111], v[40:43]
    ds_read_b64_tr_b16 v[226:227], v10 offset:46208
    v_mfma_f32_16x16x32_bf16 v[60:63], v[202:205], v[112:115], v[60:63]
    ds_read_b64_tr_b16 v[228:229], v10 offset:50816
    v_mfma_f32_16x16x32_bf16 v[80:83], v[202:205], v[116:119], v[80:83]
    v_mfma_f32_16x16x32_bf16 v[100:103], v[202:205], v[120:123], v[100:103]
    s_waitcnt lgkmcnt(14)
    v_mfma_f32_16x16x32_bf16 v[44:47], v[206:209], v[108:111], v[44:47]
    v_mfma_f32_16x16x32_bf16 v[64:67], v[206:209], v[112:115], v[64:67]
    v_mfma_f32_16x16x32_bf16 v[84:87], v[206:209], v[116:119], v[84:87]
    v_mfma_f32_16x16x32_bf16 v[104:107], v[206:209], v[120:123], v[104:107]
    s_waitcnt lgkmcnt(0)
    s_barrier
    v_mfma_f32_16x16x32_bf16 v[28:31], v[210:213], v[230:233], v[28:31]
    ds_read_b64_tr_b16 v[190:191], v9 offset:0
    v_mfma_f32_16x16x32_bf16 v[48:51], v[210:213], v[234:237], v[48:51]
    ds_read_b64_tr_b16 v[192:193], v9 offset:4608
    v_mfma_f32_16x16x32_bf16 v[68:71], v[210:213], v[238:241], v[68:71]
    ds_read_b128 v[108:111], v11 offset:0
    v_mfma_f32_16x16x32_bf16 v[88:91], v[210:213], v[242:245], v[88:91]
    ds_read_b128 v[112:115], v11 offset:2048
    v_mfma_f32_16x16x32_bf16 v[32:35], v[214:217], v[230:233], v[32:35]
    ds_read_b128 v[116:119], v11 offset:4096
    v_mfma_f32_16x16x32_bf16 v[52:55], v[214:217], v[234:237], v[52:55]
    ds_read_b128 v[120:123], v11 offset:6144
    v_mfma_f32_16x16x32_bf16 v[72:75], v[214:217], v[238:241], v[72:75]
    ds_read_b64_tr_b16 v[194:195], v9 offset:32
    v_mfma_f32_16x16x32_bf16 v[92:95], v[214:217], v[242:245], v[92:95]
    ds_read_b64_tr_b16 v[196:197], v9 offset:4640
    v_mfma_f32_16x16x32_bf16 v[36:39], v[218:221], v[230:233], v[36:39]
    ds_read_b64_tr_b16 v[198:199], v9 offset:64
    v_mfma_f32_16x16x32_bf16 v[56:59], v[218:221], v[234:237], v[56:59]
    ds_read_b64_tr_b16 v[200:201], v9 offset:4672
    v_mfma_f32_16x16x32_bf16 v[76:79], v[218:221], v[238:241], v[76:79]
    ds_read_b64_tr_b16 v[202:203], v9 offset:96
    v_mfma_f32_16x16x32_bf16 v[96:99], v[218:221], v[242:245], v[96:99]
    ds_read_b64_tr_b16 v[204:205], v9 offset:4704
    v_mfma_f32_16x16x32_bf16 v[40:43], v[222:225], v[230:233], v[40:43]
    ds_read_b64_tr_b16 v[206:207], v10 offset:128
    v_mfma_f32_16x16x32_bf16 v[60:63], v[222:225], v[234:237], v[60:63]
    ds_read_b64_tr_b16 v[208:209], v10 offset:4736
    v_mfma_f32_16x16x32_bf16 v[80:83], v[222:225], v[238:241], v[80:83]
    v_mfma_f32_16x16x32_bf16 v[100:103], v[222:225], v[242:245], v[100:103]
    v_mfma_f32_16x16x32_bf16 v[44:47], v[226:229], v[230:233], v[44:47]
    v_mfma_f32_16x16x32_bf16 v[64:67], v[226:229], v[234:237], v[64:67]
    v_mfma_f32_16x16x32_bf16 v[84:87], v[226:229], v[238:241], v[84:87]
    v_mfma_f32_16x16x32_bf16 v[104:107], v[226:229], v[242:245], v[104:107]
    s_waitcnt lgkmcnt(8)
    v_mfma_f32_16x16x32_bf16 v[28:31], v[190:193], v[108:111], v[28:31]
    ds_read_b64_tr_b16 v[210:211], v9 offset:9216
    v_mfma_f32_16x16x32_bf16 v[48:51], v[190:193], v[112:115], v[48:51]
    ds_read_b64_tr_b16 v[212:213], v9 offset:13824
    v_mfma_f32_16x16x32_bf16 v[68:71], v[190:193], v[116:119], v[68:71]
    ds_read_b128 v[230:233], v12 offset:0
    v_mfma_f32_16x16x32_bf16 v[88:91], v[190:193], v[120:123], v[88:91]
    ds_read_b128 v[234:237], v12 offset:2048
    s_waitcnt lgkmcnt(10)
    v_mfma_f32_16x16x32_bf16 v[32:35], v[194:197], v[108:111], v[32:35]
    ds_read_b128 v[238:241], v12 offset:4096
    v_mfma_f32_16x16x32_bf16 v[52:55], v[194:197], v[112:115], v[52:55]
    ds_read_b128 v[242:245], v12 offset:6144
    v_mfma_f32_16x16x32_bf16 v[72:75], v[194:197], v[116:119], v[72:75]
    ds_read_b64_tr_b16 v[214:215], v9 offset:9248
    v_mfma_f32_16x16x32_bf16 v[92:95], v[194:197], v[120:123], v[92:95]
    ds_read_b64_tr_b16 v[216:217], v9 offset:13856
    s_waitcnt lgkmcnt(12)
    v_mfma_f32_16x16x32_bf16 v[36:39], v[198:201], v[108:111], v[36:39]
    ds_read_b64_tr_b16 v[218:219], v9 offset:9280
    v_mfma_f32_16x16x32_bf16 v[56:59], v[198:201], v[112:115], v[56:59]
    ds_read_b64_tr_b16 v[220:221], v9 offset:13888
    v_mfma_f32_16x16x32_bf16 v[76:79], v[198:201], v[116:119], v[76:79]
    ds_read_b64_tr_b16 v[222:223], v9 offset:9312
    v_mfma_f32_16x16x32_bf16 v[96:99], v[198:201], v[120:123], v[96:99]
    ds_read_b64_tr_b16 v[224:225], v9 offset:13920
    s_waitcnt lgkmcnt(14)
    v_mfma_f32_16x16x32_bf16 v[40:43], v[202:205], v[108:111], v[40:43]
    ds_read_b64_tr_b16 v[226:227], v10 offset:9344
    v_mfma_f32_16x16x32_bf16 v[60:63], v[202:205], v[112:115], v[60:63]
    ds_read_b64_tr_b16 v[228:229], v10 offset:13952
    v_mfma_f32_16x16x32_bf16 v[80:83], v[202:205], v[116:119], v[80:83]
    v_mfma_f32_16x16x32_bf16 v[100:103], v[202:205], v[120:123], v[100:103]
    s_waitcnt lgkmcnt(14)
    v_mfma_f32_16x16x32_bf16 v[44:47], v[206:209], v[108:111], v[44:47]
    v_mfma_f32_16x16x32_bf16 v[64:67], v[206:209], v[112:115], v[64:67]
    v_mfma_f32_16x16x32_bf16 v[84:87], v[206:209], v[116:119], v[84:87]
    v_mfma_f32_16x16x32_bf16 v[104:107], v[206:209], v[120:123], v[104:107]
    s_waitcnt lgkmcnt(0)
    s_barrier
    v_mfma_f32_16x16x32_bf16 v[28:31], v[210:213], v[230:233], v[28:31]
    ds_read_b64_tr_b16 v[190:191], v9 offset:18432
    v_mfma_f32_16x16x32_bf16 v[48:51], v[210:213], v[234:237], v[48:51]
    ds_read_b64_tr_b16 v[192:193], v9 offset:23040
    v_mfma_f32_16x16x32_bf16 v[68:71], v[210:213], v[238:241], v[68:71]
    ds_read_b128 v[108:111], v11 offset:16384
    v_mfma_f32_16x16x32_bf16 v[88:91], v[210:213], v[242:245], v[88:91]
    ds_read_b128 v[112:115], v11 offset:18432
    v_mfma_f32_16x16x32_bf16 v[32:35], v[214:217], v[230:233], v[32:35]
    ds_read_b128 v[116:119], v11 offset:20480
    v_mfma_f32_16x16x32_bf16 v[52:55], v[214:217], v[234:237], v[52:55]
    ds_read_b128 v[120:123], v11 offset:22528
    v_mfma_f32_16x16x32_bf16 v[72:75], v[214:217], v[238:241], v[72:75]
    ds_read_b64_tr_b16 v[194:195], v9 offset:18464
    v_mfma_f32_16x16x32_bf16 v[92:95], v[214:217], v[242:245], v[92:95]
    ds_read_b64_tr_b16 v[196:197], v9 offset:23072
    v_mfma_f32_16x16x32_bf16 v[36:39], v[218:221], v[230:233], v[36:39]
    ds_read_b64_tr_b16 v[198:199], v9 offset:18496
    v_mfma_f32_16x16x32_bf16 v[56:59], v[218:221], v[234:237], v[56:59]
    ds_read_b64_tr_b16 v[200:201], v9 offset:23104
    v_mfma_f32_16x16x32_bf16 v[76:79], v[218:221], v[238:241], v[76:79]
    ds_read_b64_tr_b16 v[202:203], v9 offset:18528
    v_mfma_f32_16x16x32_bf16 v[96:99], v[218:221], v[242:245], v[96:99]
    ds_read_b64_tr_b16 v[204:205], v9 offset:23136
    v_mfma_f32_16x16x32_bf16 v[40:43], v[222:225], v[230:233], v[40:43]
    ds_read_b64_tr_b16 v[206:207], v10 offset:18560
    v_mfma_f32_16x16x32_bf16 v[60:63], v[222:225], v[234:237], v[60:63]
    ds_read_b64_tr_b16 v[208:209], v10 offset:23168
    v_mfma_f32_16x16x32_bf16 v[80:83], v[222:225], v[238:241], v[80:83]
    v_mfma_f32_16x16x32_bf16 v[100:103], v[222:225], v[242:245], v[100:103]
    v_mfma_f32_16x16x32_bf16 v[44:47], v[226:229], v[230:233], v[44:47]
    v_mfma_f32_16x16x32_bf16 v[64:67], v[226:229], v[234:237], v[64:67]
    v_mfma_f32_16x16x32_bf16 v[84:87], v[226:229], v[238:241], v[84:87]
    v_mfma_f32_16x16x32_bf16 v[104:107], v[226:229], v[242:245], v[104:107]
    s_waitcnt lgkmcnt(8)
    v_mfma_f32_16x16x32_bf16 v[28:31], v[190:193], v[108:111], v[28:31]
    ds_read_b64_tr_b16 v[210:211], v9 offset:27648
    v_mfma_f32_16x16x32_bf16 v[48:51], v[190:193], v[112:115], v[48:51]
    ds_read_b64_tr_b16 v[212:213], v9 offset:32256
    v_mfma_f32_16x16x32_bf16 v[68:71], v[190:193], v[116:119], v[68:71]
    ds_read_b128 v[230:233], v12 offset:16384
    v_mfma_f32_16x16x32_bf16 v[88:91], v[190:193], v[120:123], v[88:91]
    ds_read_b128 v[234:237], v12 offset:18432
    s_waitcnt lgkmcnt(10)
    v_mfma_f32_16x16x32_bf16 v[32:35], v[194:197], v[108:111], v[32:35]
    ds_read_b128 v[238:241], v12 offset:20480
    v_mfma_f32_16x16x32_bf16 v[52:55], v[194:197], v[112:115], v[52:55]
    ds_read_b128 v[242:245], v12 offset:22528
    v_mfma_f32_16x16x32_bf16 v[72:75], v[194:197], v[116:119], v[72:75]
    ds_read_b64_tr_b16 v[214:215], v9 offset:27680
    v_mfma_f32_16x16x32_bf16 v[92:95], v[194:197], v[120:123], v[92:95]
    ds_read_b64_tr_b16 v[216:217], v9 offset:32288
    s_waitcnt lgkmcnt(12)
    v_mfma_f32_16x16x32_bf16 v[36:39], v[198:201], v[108:111], v[36:39]
    ds_read_b64_tr_b16 v[218:219], v9 offset:27712
    v_mfma_f32_16x16x32_bf16 v[56:59], v[198:201], v[112:115], v[56:59]
    ds_read_b64_tr_b16 v[220:221], v9 offset:32320
    v_mfma_f32_16x16x32_bf16 v[76:79], v[198:201], v[116:119], v[76:79]
    ds_read_b64_tr_b16 v[222:223], v9 offset:27744
    v_mfma_f32_16x16x32_bf16 v[96:99], v[198:201], v[120:123], v[96:99]
    ds_read_b64_tr_b16 v[224:225], v9 offset:32352
    s_waitcnt lgkmcnt(14)
    v_mfma_f32_16x16x32_bf16 v[40:43], v[202:205], v[108:111], v[40:43]
    ds_read_b64_tr_b16 v[226:227], v10 offset:27776
    v_mfma_f32_16x16x32_bf16 v[60:63], v[202:205], v[112:115], v[60:63]
    ds_read_b64_tr_b16 v[228:229], v10 offset:32384
    v_mfma_f32_16x16x32_bf16 v[80:83], v[202:205], v[116:119], v[80:83]
    v_mfma_f32_16x16x32_bf16 v[100:103], v[202:205], v[120:123], v[100:103]
    s_waitcnt lgkmcnt(14)
    v_mfma_f32_16x16x32_bf16 v[44:47], v[206:209], v[108:111], v[44:47]
    v_mfma_f32_16x16x32_bf16 v[64:67], v[206:209], v[112:115], v[64:67]
    v_mfma_f32_16x16x32_bf16 v[84:87], v[206:209], v[116:119], v[84:87]
    v_mfma_f32_16x16x32_bf16 v[104:107], v[206:209], v[120:123], v[104:107]
    s_waitcnt lgkmcnt(0)
    s_barrier
    v_mfma_f32_16x16x32_bf16 v[28:31], v[210:213], v[230:233], v[28:31]
    ds_read_b64_tr_b16 v[190:191], v9 offset:36864
    v_mfma_f32_16x16x32_bf16 v[48:51], v[210:213], v[234:237], v[48:51]
    ds_read_b64_tr_b16 v[192:193], v9 offset:41472
    v_mfma_f32_16x16x32_bf16 v[68:71], v[210:213], v[238:241], v[68:71]
    ds_read_b128 v[108:111], v11 offset:51200
    v_mfma_f32_16x16x32_bf16 v[88:91], v[210:213], v[242:245], v[88:91]
    ds_read_b128 v[112:115], v11 offset:53248
    v_mfma_f32_16x16x32_bf16 v[32:35], v[214:217], v[230:233], v[32:35]
    ds_read_b128 v[116:119], v11 offset:55296
    v_mfma_f32_16x16x32_bf16 v[52:55], v[214:217], v[234:237], v[52:55]
    ds_read_b128 v[120:123], v11 offset:57344
    v_mfma_f32_16x16x32_bf16 v[72:75], v[214:217], v[238:241], v[72:75]
    ds_read_b64_tr_b16 v[194:195], v9 offset:36896
    v_mfma_f32_16x16x32_bf16 v[92:95], v[214:217], v[242:245], v[92:95]
    ds_read_b64_tr_b16 v[196:197], v9 offset:41504
    v_mfma_f32_16x16x32_bf16 v[36:39], v[218:221], v[230:233], v[36:39]
    ds_read_b64_tr_b16 v[198:199], v9 offset:36928
    v_mfma_f32_16x16x32_bf16 v[56:59], v[218:221], v[234:237], v[56:59]
    ds_read_b64_tr_b16 v[200:201], v9 offset:41536
    v_mfma_f32_16x16x32_bf16 v[76:79], v[218:221], v[238:241], v[76:79]
    ds_read_b64_tr_b16 v[202:203], v9 offset:36960
    v_mfma_f32_16x16x32_bf16 v[96:99], v[218:221], v[242:245], v[96:99]
    ds_read_b64_tr_b16 v[204:205], v9 offset:41568
    v_mfma_f32_16x16x32_bf16 v[40:43], v[222:225], v[230:233], v[40:43]
    ds_read_b64_tr_b16 v[206:207], v10 offset:36992
    v_mfma_f32_16x16x32_bf16 v[60:63], v[222:225], v[234:237], v[60:63]
    ds_read_b64_tr_b16 v[208:209], v10 offset:41600
    v_mfma_f32_16x16x32_bf16 v[80:83], v[222:225], v[238:241], v[80:83]
    v_mfma_f32_16x16x32_bf16 v[100:103], v[222:225], v[242:245], v[100:103]
    v_mfma_f32_16x16x32_bf16 v[44:47], v[226:229], v[230:233], v[44:47]
    v_mfma_f32_16x16x32_bf16 v[64:67], v[226:229], v[234:237], v[64:67]
    v_mfma_f32_16x16x32_bf16 v[84:87], v[226:229], v[238:241], v[84:87]
    v_mfma_f32_16x16x32_bf16 v[104:107], v[226:229], v[242:245], v[104:107]
    s_waitcnt lgkmcnt(8)
    v_mfma_f32_16x16x32_bf16 v[28:31], v[190:193], v[108:111], v[28:31]
    ds_read_b64_tr_b16 v[210:211], v9 offset:46080
    v_mfma_f32_16x16x32_bf16 v[48:51], v[190:193], v[112:115], v[48:51]
    ds_read_b64_tr_b16 v[212:213], v9 offset:50688
    v_mfma_f32_16x16x32_bf16 v[68:71], v[190:193], v[116:119], v[68:71]
    ds_read_b128 v[230:233], v12 offset:51200
    v_mfma_f32_16x16x32_bf16 v[88:91], v[190:193], v[120:123], v[88:91]
    ds_read_b128 v[234:237], v12 offset:53248
    s_waitcnt lgkmcnt(10)
    v_mfma_f32_16x16x32_bf16 v[32:35], v[194:197], v[108:111], v[32:35]
    ds_read_b128 v[238:241], v12 offset:55296
    v_mfma_f32_16x16x32_bf16 v[52:55], v[194:197], v[112:115], v[52:55]
    ds_read_b128 v[242:245], v12 offset:57344
    v_mfma_f32_16x16x32_bf16 v[72:75], v[194:197], v[116:119], v[72:75]
    ds_read_b64_tr_b16 v[214:215], v9 offset:46112
    v_mfma_f32_16x16x32_bf16 v[92:95], v[194:197], v[120:123], v[92:95]
    ds_read_b64_tr_b16 v[216:217], v9 offset:50720
    s_waitcnt lgkmcnt(12)
    v_mfma_f32_16x16x32_bf16 v[36:39], v[198:201], v[108:111], v[36:39]
    ds_read_b64_tr_b16 v[218:219], v9 offset:46144
    v_mfma_f32_16x16x32_bf16 v[56:59], v[198:201], v[112:115], v[56:59]
    ds_read_b64_tr_b16 v[220:221], v9 offset:50752
    v_mfma_f32_16x16x32_bf16 v[76:79], v[198:201], v[116:119], v[76:79]
    ds_read_b64_tr_b16 v[222:223], v9 offset:46176
    v_mfma_f32_16x16x32_bf16 v[96:99], v[198:201], v[120:123], v[96:99]
    ds_read_b64_tr_b16 v[224:225], v9 offset:50784
    s_waitcnt lgkmcnt(14)
    v_mfma_f32_16x16x32_bf16 v[40:43], v[202:205], v[108:111], v[40:43]
    ds_read_b64_tr_b16 v[226:227], v10 offset:46208
    v_mfma_f32_16x16x32_bf16 v[60:63], v[202:205], v[112:115], v[60:63]
    ds_read_b64_tr_b16 v[228:229], v10 offset:50816
    v_mfma_f32_16x16x32_bf16 v[80:83], v[202:205], v[116:119], v[80:83]
    v_mfma_f32_16x16x32_bf16 v[100:103], v[202:205], v[120:123], v[100:103]
    s_waitcnt lgkmcnt(14)
    v_mfma_f32_16x16x32_bf16 v[44:47], v[206:209], v[108:111], v[44:47]
    v_mfma_f32_16x16x32_bf16 v[64:67], v[206:209], v[112:115], v[64:67]
    v_mfma_f32_16x16x32_bf16 v[84:87], v[206:209], v[116:119], v[84:87]
    v_mfma_f32_16x16x32_bf16 v[104:107], v[206:209], v[120:123], v[104:107]
    s_waitcnt lgkmcnt(0)
    s_barrier
    v_mfma_f32_16x16x32_bf16 v[28:31], v[210:213], v[230:233], v[28:31]
    ds_read_b64_tr_b16 v[190:191], v9 offset:0
    v_mfma_f32_16x16x32_bf16 v[48:51], v[210:213], v[234:237], v[48:51]
    ds_read_b64_tr_b16 v[192:193], v9 offset:4608
    v_mfma_f32_16x16x32_bf16 v[68:71], v[210:213], v[238:241], v[68:71]
    ds_read_b128 v[108:111], v11 offset:0
    v_mfma_f32_16x16x32_bf16 v[88:91], v[210:213], v[242:245], v[88:91]
    ds_read_b128 v[112:115], v11 offset:2048
    v_mfma_f32_16x16x32_bf16 v[32:35], v[214:217], v[230:233], v[32:35]
    ds_read_b128 v[116:119], v11 offset:4096
    v_mfma_f32_16x16x32_bf16 v[52:55], v[214:217], v[234:237], v[52:55]
    ds_read_b128 v[120:123], v11 offset:6144
    v_mfma_f32_16x16x32_bf16 v[72:75], v[214:217], v[238:241], v[72:75]
    ds_read_b64_tr_b16 v[194:195], v9 offset:32
    v_mfma_f32_16x16x32_bf16 v[92:95], v[214:217], v[242:245], v[92:95]
    ds_read_b64_tr_b16 v[196:197], v9 offset:4640
    v_mfma_f32_16x16x32_bf16 v[36:39], v[218:221], v[230:233], v[36:39]
    ds_read_b64_tr_b16 v[198:199], v9 offset:64
    v_mfma_f32_16x16x32_bf16 v[56:59], v[218:221], v[234:237], v[56:59]
    ds_read_b64_tr_b16 v[200:201], v9 offset:4672
    v_mfma_f32_16x16x32_bf16 v[76:79], v[218:221], v[238:241], v[76:79]
    ds_read_b64_tr_b16 v[202:203], v9 offset:96
    v_mfma_f32_16x16x32_bf16 v[96:99], v[218:221], v[242:245], v[96:99]
    ds_read_b64_tr_b16 v[204:205], v9 offset:4704
    v_mfma_f32_16x16x32_bf16 v[40:43], v[222:225], v[230:233], v[40:43]
    ds_read_b64_tr_b16 v[206:207], v10 offset:128
    v_mfma_f32_16x16x32_bf16 v[60:63], v[222:225], v[234:237], v[60:63]
    ds_read_b64_tr_b16 v[208:209], v10 offset:4736
    v_mfma_f32_16x16x32_bf16 v[80:83], v[222:225], v[238:241], v[80:83]
    v_mfma_f32_16x16x32_bf16 v[100:103], v[222:225], v[242:245], v[100:103]
    v_mfma_f32_16x16x32_bf16 v[44:47], v[226:229], v[230:233], v[44:47]
    v_mfma_f32_16x16x32_bf16 v[64:67], v[226:229], v[234:237], v[64:67]
    v_mfma_f32_16x16x32_bf16 v[84:87], v[226:229], v[238:241], v[84:87]
    v_mfma_f32_16x16x32_bf16 v[104:107], v[226:229], v[242:245], v[104:107]
    s_waitcnt lgkmcnt(8)
    v_mfma_f32_16x16x32_bf16 v[28:31], v[190:193], v[108:111], v[28:31]
    ds_read_b64_tr_b16 v[210:211], v9 offset:9216
    v_mfma_f32_16x16x32_bf16 v[48:51], v[190:193], v[112:115], v[48:51]
    ds_read_b64_tr_b16 v[212:213], v9 offset:13824
    v_mfma_f32_16x16x32_bf16 v[68:71], v[190:193], v[116:119], v[68:71]
    ds_read_b128 v[230:233], v12 offset:0
    v_mfma_f32_16x16x32_bf16 v[88:91], v[190:193], v[120:123], v[88:91]
    ds_read_b128 v[234:237], v12 offset:2048
    s_waitcnt lgkmcnt(10)
    v_mfma_f32_16x16x32_bf16 v[32:35], v[194:197], v[108:111], v[32:35]
    ds_read_b128 v[238:241], v12 offset:4096
    v_mfma_f32_16x16x32_bf16 v[52:55], v[194:197], v[112:115], v[52:55]
    ds_read_b128 v[242:245], v12 offset:6144
    v_mfma_f32_16x16x32_bf16 v[72:75], v[194:197], v[116:119], v[72:75]
    ds_read_b64_tr_b16 v[214:215], v9 offset:9248
    v_mfma_f32_16x16x32_bf16 v[92:95], v[194:197], v[120:123], v[92:95]
    ds_read_b64_tr_b16 v[216:217], v9 offset:13856
    s_waitcnt lgkmcnt(12)
    v_mfma_f32_16x16x32_bf16 v[36:39], v[198:201], v[108:111], v[36:39]
    ds_read_b64_tr_b16 v[218:219], v9 offset:9280
    v_mfma_f32_16x16x32_bf16 v[56:59], v[198:201], v[112:115], v[56:59]
    ds_read_b64_tr_b16 v[220:221], v9 offset:13888
    v_mfma_f32_16x16x32_bf16 v[76:79], v[198:201], v[116:119], v[76:79]
    ds_read_b64_tr_b16 v[222:223], v9 offset:9312
    v_mfma_f32_16x16x32_bf16 v[96:99], v[198:201], v[120:123], v[96:99]
    ds_read_b64_tr_b16 v[224:225], v9 offset:13920
    s_waitcnt lgkmcnt(14)
    v_mfma_f32_16x16x32_bf16 v[40:43], v[202:205], v[108:111], v[40:43]
    ds_read_b64_tr_b16 v[226:227], v10 offset:9344
    v_mfma_f32_16x16x32_bf16 v[60:63], v[202:205], v[112:115], v[60:63]
    ds_read_b64_tr_b16 v[228:229], v10 offset:13952
    v_mfma_f32_16x16x32_bf16 v[80:83], v[202:205], v[116:119], v[80:83]
    v_mfma_f32_16x16x32_bf16 v[100:103], v[202:205], v[120:123], v[100:103]
    s_waitcnt lgkmcnt(14)
    v_mfma_f32_16x16x32_bf16 v[44:47], v[206:209], v[108:111], v[44:47]
    v_mfma_f32_16x16x32_bf16 v[64:67], v[206:209], v[112:115], v[64:67]
    v_mfma_f32_16x16x32_bf16 v[84:87], v[206:209], v[116:119], v[84:87]
    v_mfma_f32_16x16x32_bf16 v[104:107], v[206:209], v[120:123], v[104:107]
    s_waitcnt lgkmcnt(0)
    s_barrier
    v_mfma_f32_16x16x32_bf16 v[28:31], v[210:213], v[230:233], v[28:31]
    ds_read_b64_tr_b16 v[190:191], v9 offset:18432
    v_mfma_f32_16x16x32_bf16 v[48:51], v[210:213], v[234:237], v[48:51]
    ds_read_b64_tr_b16 v[192:193], v9 offset:23040
    v_mfma_f32_16x16x32_bf16 v[68:71], v[210:213], v[238:241], v[68:71]
    ds_read_b128 v[108:111], v11 offset:16384
    v_mfma_f32_16x16x32_bf16 v[88:91], v[210:213], v[242:245], v[88:91]
    ds_read_b128 v[112:115], v11 offset:18432
    v_mfma_f32_16x16x32_bf16 v[32:35], v[214:217], v[230:233], v[32:35]
    ds_read_b128 v[116:119], v11 offset:20480
    v_mfma_f32_16x16x32_bf16 v[52:55], v[214:217], v[234:237], v[52:55]
    ds_read_b128 v[120:123], v11 offset:22528
    v_mfma_f32_16x16x32_bf16 v[72:75], v[214:217], v[238:241], v[72:75]
    ds_read_b64_tr_b16 v[194:195], v9 offset:18464
    v_mfma_f32_16x16x32_bf16 v[92:95], v[214:217], v[242:245], v[92:95]
    ds_read_b64_tr_b16 v[196:197], v9 offset:23072
    v_mfma_f32_16x16x32_bf16 v[36:39], v[218:221], v[230:233], v[36:39]
    ds_read_b64_tr_b16 v[198:199], v9 offset:18496
    v_mfma_f32_16x16x32_bf16 v[56:59], v[218:221], v[234:237], v[56:59]
    ds_read_b64_tr_b16 v[200:201], v9 offset:23104
    v_mfma_f32_16x16x32_bf16 v[76:79], v[218:221], v[238:241], v[76:79]
    ds_read_b64_tr_b16 v[202:203], v9 offset:18528
    v_mfma_f32_16x16x32_bf16 v[96:99], v[218:221], v[242:245], v[96:99]
    ds_read_b64_tr_b16 v[204:205], v9 offset:23136
    v_mfma_f32_16x16x32_bf16 v[40:43], v[222:225], v[230:233], v[40:43]
    ds_read_b64_tr_b16 v[206:207], v10 offset:18560
    v_mfma_f32_16x16x32_bf16 v[60:63], v[222:225], v[234:237], v[60:63]
    ds_read_b64_tr_b16 v[208:209], v10 offset:23168
    v_mfma_f32_16x16x32_bf16 v[80:83], v[222:225], v[238:241], v[80:83]
    v_mfma_f32_16x16x32_bf16 v[100:103], v[222:225], v[242:245], v[100:103]
    v_mfma_f32_16x16x32_bf16 v[44:47], v[226:229], v[230:233], v[44:47]
    v_mfma_f32_16x16x32_bf16 v[64:67], v[226:229], v[234:237], v[64:67]
    v_mfma_f32_16x16x32_bf16 v[84:87], v[226:229], v[238:241], v[84:87]
    v_mfma_f32_16x16x32_bf16 v[104:107], v[226:229], v[242:245], v[104:107]
    s_waitcnt lgkmcnt(8)
    v_mfma_f32_16x16x32_bf16 v[28:31], v[190:193], v[108:111], v[28:31]
    ds_read_b64_tr_b16 v[210:211], v9 offset:27648
    v_mfma_f32_16x16x32_bf16 v[48:51], v[190:193], v[112:115], v[48:51]
    ds_read_b64_tr_b16 v[212:213], v9 offset:32256
    v_mfma_f32_16x16x32_bf16 v[68:71], v[190:193], v[116:119], v[68:71]
    ds_read_b128 v[230:233], v12 offset:16384
    v_mfma_f32_16x16x32_bf16 v[88:91], v[190:193], v[120:123], v[88:91]
    ds_read_b128 v[234:237], v12 offset:18432
    s_waitcnt lgkmcnt(10)
    v_mfma_f32_16x16x32_bf16 v[32:35], v[194:197], v[108:111], v[32:35]
    ds_read_b128 v[238:241], v12 offset:20480
    v_mfma_f32_16x16x32_bf16 v[52:55], v[194:197], v[112:115], v[52:55]
    ds_read_b128 v[242:245], v12 offset:22528
    v_mfma_f32_16x16x32_bf16 v[72:75], v[194:197], v[116:119], v[72:75]
    ds_read_b64_tr_b16 v[214:215], v9 offset:27680
    v_mfma_f32_16x16x32_bf16 v[92:95], v[194:197], v[120:123], v[92:95]
    ds_read_b64_tr_b16 v[216:217], v9 offset:32288
    s_waitcnt lgkmcnt(12)
    v_mfma_f32_16x16x32_bf16 v[36:39], v[198:201], v[108:111], v[36:39]
    ds_read_b64_tr_b16 v[218:219], v9 offset:27712
    v_mfma_f32_16x16x32_bf16 v[56:59], v[198:201], v[112:115], v[56:59]
    ds_read_b64_tr_b16 v[220:221], v9 offset:32320
    v_mfma_f32_16x16x32_bf16 v[76:79], v[198:201], v[116:119], v[76:79]
    ds_read_b64_tr_b16 v[222:223], v9 offset:27744
    v_mfma_f32_16x16x32_bf16 v[96:99], v[198:201], v[120:123], v[96:99]
    ds_read_b64_tr_b16 v[224:225], v9 offset:32352
    s_waitcnt lgkmcnt(14)
    v_mfma_f32_16x16x32_bf16 v[40:43], v[202:205], v[108:111], v[40:43]
    ds_read_b64_tr_b16 v[226:227], v10 offset:27776
    v_mfma_f32_16x16x32_bf16 v[60:63], v[202:205], v[112:115], v[60:63]
    ds_read_b64_tr_b16 v[228:229], v10 offset:32384
    v_mfma_f32_16x16x32_bf16 v[80:83], v[202:205], v[116:119], v[80:83]
    v_mfma_f32_16x16x32_bf16 v[100:103], v[202:205], v[120:123], v[100:103]
    s_waitcnt lgkmcnt(14)
    v_mfma_f32_16x16x32_bf16 v[44:47], v[206:209], v[108:111], v[44:47]
    v_mfma_f32_16x16x32_bf16 v[64:67], v[206:209], v[112:115], v[64:67]
    v_mfma_f32_16x16x32_bf16 v[84:87], v[206:209], v[116:119], v[84:87]
    v_mfma_f32_16x16x32_bf16 v[104:107], v[206:209], v[120:123], v[104:107]
    s_waitcnt lgkmcnt(0)
    s_barrier
    v_mfma_f32_16x16x32_bf16 v[28:31], v[210:213], v[230:233], v[28:31]
    ds_read_b64_tr_b16 v[190:191], v9 offset:36864
    v_mfma_f32_16x16x32_bf16 v[48:51], v[210:213], v[234:237], v[48:51]
    ds_read_b64_tr_b16 v[192:193], v9 offset:41472
    v_mfma_f32_16x16x32_bf16 v[68:71], v[210:213], v[238:241], v[68:71]
    ds_read_b128 v[108:111], v11 offset:51200
    v_mfma_f32_16x16x32_bf16 v[88:91], v[210:213], v[242:245], v[88:91]
    ds_read_b128 v[112:115], v11 offset:53248
    v_mfma_f32_16x16x32_bf16 v[32:35], v[214:217], v[230:233], v[32:35]
    ds_read_b128 v[116:119], v11 offset:55296
    v_mfma_f32_16x16x32_bf16 v[52:55], v[214:217], v[234:237], v[52:55]
    ds_read_b128 v[120:123], v11 offset:57344
    v_mfma_f32_16x16x32_bf16 v[72:75], v[214:217], v[238:241], v[72:75]
    ds_read_b64_tr_b16 v[194:195], v9 offset:36896
    v_mfma_f32_16x16x32_bf16 v[92:95], v[214:217], v[242:245], v[92:95]
    ds_read_b64_tr_b16 v[196:197], v9 offset:41504
    v_mfma_f32_16x16x32_bf16 v[36:39], v[218:221], v[230:233], v[36:39]
    ds_read_b64_tr_b16 v[198:199], v9 offset:36928
    v_mfma_f32_16x16x32_bf16 v[56:59], v[218:221], v[234:237], v[56:59]
    ds_read_b64_tr_b16 v[200:201], v9 offset:41536
    v_mfma_f32_16x16x32_bf16 v[76:79], v[218:221], v[238:241], v[76:79]
    ds_read_b64_tr_b16 v[202:203], v9 offset:36960
    v_mfma_f32_16x16x32_bf16 v[96:99], v[218:221], v[242:245], v[96:99]
    ds_read_b64_tr_b16 v[204:205], v9 offset:41568
    v_mfma_f32_16x16x32_bf16 v[40:43], v[222:225], v[230:233], v[40:43]
    ds_read_b64_tr_b16 v[206:207], v10 offset:36992
    v_mfma_f32_16x16x32_bf16 v[60:63], v[222:225], v[234:237], v[60:63]
    ds_read_b64_tr_b16 v[208:209], v10 offset:41600
    v_mfma_f32_16x16x32_bf16 v[80:83], v[222:225], v[238:241], v[80:83]
    v_mfma_f32_16x16x32_bf16 v[100:103], v[222:225], v[242:245], v[100:103]
    v_mfma_f32_16x16x32_bf16 v[44:47], v[226:229], v[230:233], v[44:47]
    v_mfma_f32_16x16x32_bf16 v[64:67], v[226:229], v[234:237], v[64:67]
    v_mfma_f32_16x16x32_bf16 v[84:87], v[226:229], v[238:241], v[84:87]
    v_mfma_f32_16x16x32_bf16 v[104:107], v[226:229], v[242:245], v[104:107]
    s_waitcnt lgkmcnt(8)
    v_mfma_f32_16x16x32_bf16 v[28:31], v[190:193], v[108:111], v[28:31]
    ds_read_b64_tr_b16 v[210:211], v9 offset:46080
    v_mfma_f32_16x16x32_bf16 v[48:51], v[190:193], v[112:115], v[48:51]
    ds_read_b64_tr_b16 v[212:213], v9 offset:50688
    v_mfma_f32_16x16x32_bf16 v[68:71], v[190:193], v[116:119], v[68:71]
    ds_read_b128 v[230:233], v12 offset:51200
    v_mfma_f32_16x16x32_bf16 v[88:91], v[190:193], v[120:123], v[88:91]
    ds_read_b128 v[234:237], v12 offset:53248
    s_waitcnt lgkmcnt(10)
    v_mfma_f32_16x16x32_bf16 v[32:35], v[194:197], v[108:111], v[32:35]
    ds_read_b128 v[238:241], v12 offset:55296
    v_mfma_f32_16x16x32_bf16 v[52:55], v[194:197], v[112:115], v[52:55]
    ds_read_b128 v[242:245], v12 offset:57344
    v_mfma_f32_16x16x32_bf16 v[72:75], v[194:197], v[116:119], v[72:75]
    ds_read_b64_tr_b16 v[214:215], v9 offset:46112
    v_mfma_f32_16x16x32_bf16 v[92:95], v[194:197], v[120:123], v[92:95]
    ds_read_b64_tr_b16 v[216:217], v9 offset:50720
    s_waitcnt lgkmcnt(12)
    v_mfma_f32_16x16x32_bf16 v[36:39], v[198:201], v[108:111], v[36:39]
    ds_read_b64_tr_b16 v[218:219], v9 offset:46144
    v_mfma_f32_16x16x32_bf16 v[56:59], v[198:201], v[112:115], v[56:59]
    ds_read_b64_tr_b16 v[220:221], v9 offset:50752
    v_mfma_f32_16x16x32_bf16 v[76:79], v[198:201], v[116:119], v[76:79]
    ds_read_b64_tr_b16 v[222:223], v9 offset:46176
    v_mfma_f32_16x16x32_bf16 v[96:99], v[198:201], v[120:123], v[96:99]
    ds_read_b64_tr_b16 v[224:225], v9 offset:50784
    s_waitcnt lgkmcnt(14)
    v_mfma_f32_16x16x32_bf16 v[40:43], v[202:205], v[108:111], v[40:43]
    ds_read_b64_tr_b16 v[226:227], v10 offset:46208
    v_mfma_f32_16x16x32_bf16 v[60:63], v[202:205], v[112:115], v[60:63]
    ds_read_b64_tr_b16 v[228:229], v10 offset:50816
    v_mfma_f32_16x16x32_bf16 v[80:83], v[202:205], v[116:119], v[80:83]
    v_mfma_f32_16x16x32_bf16 v[100:103], v[202:205], v[120:123], v[100:103]
    s_waitcnt lgkmcnt(14)
    v_mfma_f32_16x16x32_bf16 v[44:47], v[206:209], v[108:111], v[44:47]
    v_mfma_f32_16x16x32_bf16 v[64:67], v[206:209], v[112:115], v[64:67]
    v_mfma_f32_16x16x32_bf16 v[84:87], v[206:209], v[116:119], v[84:87]
    v_mfma_f32_16x16x32_bf16 v[104:107], v[206:209], v[120:123], v[104:107]
    s_setprio 2
    s_waitcnt lgkmcnt(8)
    v_mfma_f32_16x16x32_bf16 v[28:31], v[210:213], v[230:233], v[28:31]
    v_mfma_f32_16x16x32_bf16 v[48:51], v[210:213], v[234:237], v[48:51]
    v_mfma_f32_16x16x32_bf16 v[68:71], v[210:213], v[238:241], v[68:71]
    v_mfma_f32_16x16x32_bf16 v[88:91], v[210:213], v[242:245], v[88:91]
    s_waitcnt lgkmcnt(6)
    v_mfma_f32_16x16x32_bf16 v[32:35], v[214:217], v[230:233], v[32:35]
    v_mfma_f32_16x16x32_bf16 v[52:55], v[214:217], v[234:237], v[52:55]
    v_mfma_f32_16x16x32_bf16 v[72:75], v[214:217], v[238:241], v[72:75]
    v_mfma_f32_16x16x32_bf16 v[92:95], v[214:217], v[242:245], v[92:95]
    s_waitcnt lgkmcnt(4)
    v_mfma_f32_16x16x32_bf16 v[36:39], v[218:221], v[230:233], v[36:39]
    v_mfma_f32_16x16x32_bf16 v[56:59], v[218:221], v[234:237], v[56:59]
    v_mfma_f32_16x16x32_bf16 v[76:79], v[218:221], v[238:241], v[76:79]
    v_mfma_f32_16x16x32_bf16 v[96:99], v[218:221], v[242:245], v[96:99]
    s_waitcnt lgkmcnt(2)
    v_mfma_f32_16x16x32_bf16 v[40:43], v[222:225], v[230:233], v[40:43]
    v_mfma_f32_16x16x32_bf16 v[60:63], v[222:225], v[234:237], v[60:63]
    v_mfma_f32_16x16x32_bf16 v[80:83], v[222:225], v[238:241], v[80:83]
    v_mfma_f32_16x16x32_bf16 v[100:103], v[222:225], v[242:245], v[100:103]
    s_waitcnt lgkmcnt(0)
    v_mfma_f32_16x16x32_bf16 v[44:47], v[226:229], v[230:233], v[44:47]
    v_mfma_f32_16x16x32_bf16 v[64:67], v[226:229], v[234:237], v[64:67]
    v_mfma_f32_16x16x32_bf16 v[84:87], v[226:229], v[238:241], v[84:87]
    v_mfma_f32_16x16x32_bf16 v[104:107], v[226:229], v[242:245], v[104:107]
    v_mov_b32 v111, s76
    v_mov_b32 v233, s76
    v_mov_b32 v115, s76
    v_mov_b32 v237, s76
    v_mov_b32 v119, s76
    v_mov_b32 v241, s76
    v_cvt_pk_bf16_f32 v190, v28, v29
    v_cvt_pk_bf16_f32 v191, v30, v31
    v_cvt_pk_bf16_f32 v192, v32, v33
    v_cvt_pk_bf16_f32 v193, v34, v35
    v_cvt_pk_bf16_f32 v194, v36, v37
    v_cvt_pk_bf16_f32 v195, v38, v39
    v_cvt_pk_bf16_f32 v196, v40, v41
    v_cvt_pk_bf16_f32 v197, v42, v43
    v_cvt_pk_bf16_f32 v198, v44, v45
    v_cvt_pk_bf16_f32 v199, v46, v47
    s_nop 1
    v_mfma_f32_16x16x16_bf16 v[28:31], v[148:149], v[198:199], 0
    v_cvt_pk_bf16_f32 v200, v48, v49
    v_cvt_pk_bf16_f32 v201, v50, v51
    v_mfma_f32_16x16x16_bf16 v[32:35], v[158:159], v[198:199], 0
    v_cvt_pk_bf16_f32 v202, v52, v53
    v_cvt_pk_bf16_f32 v203, v54, v55
    v_mfma_f32_16x16x16_bf16 v[36:39], v[168:169], v[198:199], 0
    v_cvt_pk_bf16_f32 v204, v56, v57
    v_cvt_pk_bf16_f32 v205, v58, v59
    v_mfma_f32_16x16x16_bf16 v[40:43], v[178:179], v[198:199], 0
    v_cvt_pk_bf16_f32 v206, v60, v61
    v_cvt_pk_bf16_f32 v207, v62, v63
    v_mfma_f32_16x16x16_bf16 v[44:47], v[188:189], v[198:199], 0
    v_cvt_pk_bf16_f32 v208, v64, v65
    v_cvt_pk_bf16_f32 v209, v66, v67
    v_mfma_f32_16x16x32_bf16 v[28:31], v[140:143], v[190:193], v[28:31]
    v_mfma_f32_16x16x32_bf16 v[32:35], v[150:153], v[190:193], v[32:35]
    v_mfma_f32_16x16x32_bf16 v[36:39], v[160:163], v[190:193], v[36:39]
    v_mfma_f32_16x16x32_bf16 v[40:43], v[170:173], v[190:193], v[40:43]
    v_mfma_f32_16x16x32_bf16 v[44:47], v[180:183], v[190:193], v[44:47]
    v_mfma_f32_16x16x32_bf16 v[28:31], v[144:147], v[194:197], v[28:31]
    v_mfma_f32_16x16x32_bf16 v[32:35], v[154:157], v[194:197], v[32:35]
    v_mfma_f32_16x16x32_bf16 v[36:39], v[164:167], v[194:197], v[36:39]
    v_mfma_f32_16x16x32_bf16 v[40:43], v[174:177], v[194:197], v[40:43]
    v_mfma_f32_16x16x32_bf16 v[44:47], v[184:187], v[194:197], v[44:47]
    v_mfma_f32_16x16x16_bf16 v[48:51], v[148:149], v[208:209], 0
    v_cvt_pk_bf16_f32 v210, v68, v69
    v_cvt_pk_bf16_f32 v211, v70, v71
    v_mfma_f32_16x16x16_bf16 v[52:55], v[158:159], v[208:209], 0
    v_cvt_pk_bf16_f32 v212, v72, v73
    v_cvt_pk_bf16_f32 v213, v74, v75
    v_mfma_f32_16x16x16_bf16 v[56:59], v[168:169], v[208:209], 0
    v_cvt_pk_bf16_f32 v214, v76, v77
    v_cvt_pk_bf16_f32 v215, v78, v79
    v_mfma_f32_16x16x16_bf16 v[60:63], v[178:179], v[208:209], 0
    v_cvt_pk_bf16_f32 v216, v80, v81
    v_cvt_pk_bf16_f32 v217, v82, v83
    v_mfma_f32_16x16x16_bf16 v[64:67], v[188:189], v[208:209], 0
    v_cvt_pk_bf16_f32 v218, v84, v85
    v_cvt_pk_bf16_f32 v219, v86, v87
    v_mfma_f32_16x16x32_bf16 v[48:51], v[140:143], v[200:203], v[48:51]
    v_cvt_pk_bf16_f32 v108, v28, v29
    v_cvt_pk_bf16_f32 v109, v30, v31
    v_mfma_f32_16x16x32_bf16 v[52:55], v[150:153], v[200:203], v[52:55]
    v_cvt_pk_bf16_f32 v110, v32, v33
    buffer_store_dwordx4 v[108:111], v27, s[48:51], s10 offen offset:0 sc1
    v_mfma_f32_16x16x32_bf16 v[56:59], v[160:163], v[200:203], v[56:59]
    v_cvt_pk_bf16_f32 v112, v34, v35
    v_cvt_pk_bf16_f32 v113, v36, v37
    v_mfma_f32_16x16x32_bf16 v[60:63], v[170:173], v[200:203], v[60:63]
    v_cvt_pk_bf16_f32 v114, v38, v39
    buffer_store_dwordx4 v[112:115], v27, s[48:51], s11 offen offset:0 sc1
    v_mfma_f32_16x16x32_bf16 v[64:67], v[180:183], v[200:203], v[64:67]
    v_cvt_pk_bf16_f32 v116, v40, v41
    v_cvt_pk_bf16_f32 v117, v42, v43
    v_mfma_f32_16x16x32_bf16 v[48:51], v[144:147], v[204:207], v[48:51]
    v_cvt_pk_bf16_f32 v118, v44, v45
    buffer_store_dwordx4 v[116:119], v27, s[48:51], s12 offen offset:0 sc1
    v_mfma_f32_16x16x32_bf16 v[52:55], v[154:157], v[204:207], v[52:55]
    v_mfma_f32_16x16x32_bf16 v[56:59], v[164:167], v[204:207], v[56:59]
    v_mfma_f32_16x16x32_bf16 v[60:63], v[174:177], v[204:207], v[60:63]
    v_mfma_f32_16x16x32_bf16 v[64:67], v[184:187], v[204:207], v[64:67]
    v_mfma_f32_16x16x16_bf16 v[68:71], v[148:149], v[218:219], 0
    v_cvt_pk_bf16_f32 v220, v88, v89
    v_cvt_pk_bf16_f32 v221, v90, v91
    v_mfma_f32_16x16x16_bf16 v[72:75], v[158:159], v[218:219], 0
    v_cvt_pk_bf16_f32 v222, v92, v93
    v_cvt_pk_bf16_f32 v223, v94, v95
    v_mfma_f32_16x16x16_bf16 v[76:79], v[168:169], v[218:219], 0
    v_cvt_pk_bf16_f32 v224, v96, v97
    v_cvt_pk_bf16_f32 v225, v98, v99
    v_mfma_f32_16x16x16_bf16 v[80:83], v[178:179], v[218:219], 0
    v_cvt_pk_bf16_f32 v226, v100, v101
    v_cvt_pk_bf16_f32 v227, v102, v103
    v_mfma_f32_16x16x16_bf16 v[84:87], v[188:189], v[218:219], 0
    v_cvt_pk_bf16_f32 v228, v104, v105
    v_cvt_pk_bf16_f32 v229, v106, v107
    v_mfma_f32_16x16x32_bf16 v[68:71], v[140:143], v[210:213], v[68:71]
    v_cvt_pk_bf16_f32 v230, v48, v49
    v_cvt_pk_bf16_f32 v231, v50, v51
    v_mfma_f32_16x16x32_bf16 v[72:75], v[150:153], v[210:213], v[72:75]
    v_cvt_pk_bf16_f32 v232, v52, v53
    buffer_store_dwordx4 v[230:233], v27, s[48:51], s10 offen offset:256 sc1
    v_mfma_f32_16x16x32_bf16 v[76:79], v[160:163], v[210:213], v[76:79]
    v_cvt_pk_bf16_f32 v234, v54, v55
    v_cvt_pk_bf16_f32 v235, v56, v57
    v_mfma_f32_16x16x32_bf16 v[80:83], v[170:173], v[210:213], v[80:83]
    v_cvt_pk_bf16_f32 v236, v58, v59
    buffer_store_dwordx4 v[234:237], v27, s[48:51], s11 offen offset:256 sc1
    v_mfma_f32_16x16x32_bf16 v[84:87], v[180:183], v[210:213], v[84:87]
    v_cvt_pk_bf16_f32 v238, v60, v61
    v_cvt_pk_bf16_f32 v239, v62, v63
    v_mfma_f32_16x16x32_bf16 v[68:71], v[144:147], v[214:217], v[68:71]
    v_cvt_pk_bf16_f32 v240, v64, v65
    buffer_store_dwordx4 v[238:241], v27, s[48:51], s12 offen offset:256 sc1
    v_mfma_f32_16x16x32_bf16 v[72:75], v[154:157], v[214:217], v[72:75]
    v_mfma_f32_16x16x32_bf16 v[76:79], v[164:167], v[214:217], v[76:79]
    v_mfma_f32_16x16x32_bf16 v[80:83], v[174:177], v[214:217], v[80:83]
    v_mfma_f32_16x16x32_bf16 v[84:87], v[184:187], v[214:217], v[84:87]
    v_mfma_f32_16x16x16_bf16 v[88:91], v[148:149], v[228:229], 0
    s_nop 0
    s_nop 0
    v_mfma_f32_16x16x16_bf16 v[92:95], v[158:159], v[228:229], 0
    s_nop 0
    s_nop 0
    v_mfma_f32_16x16x16_bf16 v[96:99], v[168:169], v[228:229], 0
    s_nop 0
    s_nop 0
    v_mfma_f32_16x16x16_bf16 v[100:103], v[178:179], v[228:229], 0
    v_cvt_pk_bf16_f32 v108, v68, v69
    v_cvt_pk_bf16_f32 v109, v70, v71
    v_mfma_f32_16x16x16_bf16 v[104:107], v[188:189], v[228:229], 0
    v_cvt_pk_bf16_f32 v110, v72, v73
    buffer_store_dwordx4 v[108:111], v27, s[48:51], s10 offen offset:512 sc1
    v_mfma_f32_16x16x32_bf16 v[88:91], v[140:143], v[220:223], v[88:91]
    v_cvt_pk_bf16_f32 v112, v74, v75
    v_cvt_pk_bf16_f32 v113, v76, v77
    v_mfma_f32_16x16x32_bf16 v[92:95], v[150:153], v[220:223], v[92:95]
    v_cvt_pk_bf16_f32 v114, v78, v79
    buffer_store_dwordx4 v[112:115], v27, s[48:51], s11 offen offset:512 sc1
    v_mfma_f32_16x16x32_bf16 v[96:99], v[160:163], v[220:223], v[96:99]
    v_cvt_pk_bf16_f32 v116, v80, v81
    v_cvt_pk_bf16_f32 v117, v82, v83
    v_mfma_f32_16x16x32_bf16 v[100:103], v[170:173], v[220:223], v[100:103]
    v_cvt_pk_bf16_f32 v118, v84, v85
    buffer_store_dwordx4 v[116:119], v27, s[48:51], s12 offen offset:512 sc1
    v_mfma_f32_16x16x32_bf16 v[104:107], v[180:183], v[220:223], v[104:107]
    v_mfma_f32_16x16x32_bf16 v[88:91], v[144:147], v[224:227], v[88:91]
    v_mfma_f32_16x16x32_bf16 v[92:95], v[154:157], v[224:227], v[92:95]
    v_mfma_f32_16x16x32_bf16 v[96:99], v[164:167], v[224:227], v[96:99]
    v_mfma_f32_16x16x32_bf16 v[100:103], v[174:177], v[224:227], v[100:103]
    v_mfma_f32_16x16x32_bf16 v[104:107], v[184:187], v[224:227], v[104:107]
    s_nop 3
    v_cvt_pk_bf16_f32 v230, v88, v89
    v_cvt_pk_bf16_f32 v231, v90, v91
    v_cvt_pk_bf16_f32 v232, v92, v93
    buffer_store_dwordx4 v[230:233], v27, s[48:51], s10 offen offset:768 sc1
    v_cvt_pk_bf16_f32 v234, v94, v95
    v_cvt_pk_bf16_f32 v235, v96, v97
    v_cvt_pk_bf16_f32 v236, v98, v99
    buffer_store_dwordx4 v[234:237], v27, s[48:51], s11 offen offset:768 sc1
    v_cvt_pk_bf16_f32 v238, v100, v101
    v_cvt_pk_bf16_f32 v239, v102, v103
    v_cvt_pk_bf16_f32 v240, v104, v105
    buffer_store_dwordx4 v[238:241], v27, s[48:51], s12 offen offset:768 sc1
    s_setprio 0
    s_barrier
    s_barrier
    s_mov_b32 s77, 0
    s_mov_b32 s74, 1069066811
    v_mov_b32 v101, 0
    v_mov_b32 v113, 0
    v_mov_b32 v115, 0
    s_add_u32 s79, s32, 0
    buffer_load_dwordx4 v[140:143], v124, s[48:51], s79 offen sc1
    s_add_u32 s79, s32, 1024
    buffer_load_dwordx4 v[144:147], v124, s[48:51], s79 offen sc1
    s_add_u32 s79, s32, 2048
    buffer_load_dwordx4 v[148:151], v124, s[48:51], s79 offen sc1
    s_add_u32 s79, s32, 3072
    buffer_load_dwordx4 v[152:155], v124, s[48:51], s79 offen sc1
    s_add_u32 s79, s32, 4096
    buffer_load_dwordx4 v[156:159], v124, s[48:51], s79 offen sc1
    s_add_u32 s79, s32, 5120
    buffer_load_dwordx4 v[160:163], v124, s[48:51], s79 offen sc1
    s_add_u32 s79, s32, 6144
    buffer_load_dwordx4 v[164:167], v124, s[48:51], s79 offen sc1
    s_add_u32 s79, s32, 7168
    buffer_load_dwordx4 v[168:171], v124, s[48:51], s79 offen sc1
    s_add_u32 s79, s32, 8192
    buffer_load_dwordx4 v[172:175], v124, s[48:51], s79 offen sc1
    s_add_u32 s79, s32, 9216
    buffer_load_dwordx4 v[176:179], v124, s[48:51], s79 offen sc1
    s_add_u32 s79, s32, 10240
    buffer_load_dwordx4 v[180:183], v124, s[48:51], s79 offen sc1
    s_add_u32 s79, s32, 11264
    buffer_load_dwordx4 v[184:187], v124, s[48:51], s79 offen sc1
    s_add_u32 s79, s32, 12288
    buffer_load_dwordx4 v[188:191], v124, s[48:51], s79 offen sc1
    s_add_u32 s79, s32, 13312
    buffer_load_dwordx4 v[192:195], v124, s[48:51], s79 offen sc1
    s_add_u32 s79, s32, 14336
    buffer_load_dwordx4 v[196:199], v124, s[48:51], s79 offen sc1
    s_add_u32 s79, s32, 15360
    buffer_load_dwordx4 v[200:203], v124, s[48:51], s79 offen sc1
    s_add_u32 s79, s32, 16384
    buffer_load_dwordx4 v[204:207], v124, s[48:51], s79 offen sc1
    s_add_u32 s79, s32, 17408
    buffer_load_dwordx4 v[208:211], v124, s[48:51], s79 offen sc1
    s_add_u32 s79, s32, 18432
    buffer_load_dwordx4 v[212:215], v124, s[48:51], s79 offen sc1
    s_add_u32 s79, s32, 19456
    buffer_load_dwordx4 v[216:219], v124, s[48:51], s79 offen sc1
    s_add_u32 s79, s32, 20480
    buffer_load_dwordx4 v[220:223], v124, s[48:51], s79 offen sc1
    s_add_u32 s79, s32, 21504
    buffer_load_dwordx4 v[224:227], v124, s[48:51], s79 offen sc1
    s_add_u32 s79, s32, 22528
    buffer_load_dwordx4 v[228:231], v124, s[48:51], s79 offen sc1
    s_add_u32 s79, s32, 23552
    buffer_load_dwordx4 v[232:235], v124, s[48:51], s79 offen sc1
    s_add_u32 s79, s32, 24576
    buffer_load_dwordx4 v[236:239], v124, s[48:51], s79 offen sc1
    s_add_u32 s79, s32, 25600
    buffer_load_dwordx4 v[240:243], v124, s[48:51], s79 offen sc1
    s_add_u32 s79, s32, 26624
    buffer_load_dwordx4 v[244:247], v124, s[48:51], s79 offen sc1
    buffer_load_dwordx4 v[28:31], v128, s[48:51], s16 offen sc1
    buffer_load_dwordx4 v[32:35], v128, s[48:51], s17 offen sc1
    buffer_load_dwordx4 v[36:39], v128, s[48:51], s18 offen sc1
    s_waitcnt vmcnt(0)
    s_branch L_TQ
L_TK:
    s_add_u32 s79, s32, 0
    s_nop 0
    buffer_load_dwordx4 v[140:143], v124, s[48:51], s79 offen sc1
    s_add_u32 s79, s32, 1024
    buffer_load_dwordx4 v[144:147], v124, s[48:51], s79 offen sc1
    s_add_u32 s79, s32, 2048
    buffer_load_dwordx4 v[148:151], v124, s[48:51], s79 offen sc1
    s_add_u32 s79, s32, 3072
    buffer_load_dwordx4 v[152:155], v124, s[48:51], s79 offen sc1
    s_add_u32 s79, s32, 4096
    buffer_load_dwordx4 v[156:159], v124, s[48:51], s79 offen sc1
    s_add_u32 s79, s32, 5120
    buffer_load_dwordx4 v[160:163], v124, s[48:51], s79 offen sc1
    s_add_u32 s79, s32, 6144
    buffer_load_dwordx4 v[164:167], v124, s[48:51], s79 offen sc1
    s_add_u32 s79, s32, 7168
    buffer_load_dwordx4 v[168:171], v124, s[48:51], s79 offen sc1
    s_add_u32 s79, s32, 8192
    buffer_load_dwordx4 v[172:175], v124, s[48:51], s79 offen sc1
    s_add_u32 s79, s32, 9216
    buffer_load_dwordx4 v[176:179], v124, s[48:51], s79 offen sc1
    s_add_u32 s79, s32, 10240
    buffer_load_dwordx4 v[180:183], v124, s[48:51], s79 offen sc1
    s_add_u32 s79, s32, 11264
    buffer_load_dwordx4 v[184:187], v124, s[48:51], s79 offen sc1
    s_mov_b32 s77, 0
    s_mov_b32 s74, 1069066811
    v_mov_b32 v101, 0
    v_mov_b32 v113, 0
    v_mov_b32 v115, 0
    s_waitcnt vmcnt(12)
    buffer_load_dwordx4 v[52:55], v130, s[48:51], s20 offen sc1
    s_nop 0
    buffer_load_dwordx4 v[56:59], v130, s[48:51], s21 offen sc1
    buffer_load_dwordx4 v[60:63], v130, s[48:51], s22 offen sc1
    buffer_load_dwordx4 v[64:67], v130, s[48:51], s23 offen sc1
L_QchkK:
    v_sad_u32 v20, v31, s76, 0
    v_sad_u32 v20, v35, s76, v20
    v_sad_u32 v20, v39, s76, v20
    v_cmp_ne_u32 vcc, 0, v20
    s_cbranch_vccnz L_QretryK
L_QokK:
    v_dot2_f32_bf16 v68, v28, v134, 0
    v_dot2_f32_bf16 v69, v28, v135, 0
    v_dot2_f32_bf16 v70, v29, v134, 0
    v_dot2_f32_bf16 v71, v29, v135, 0
    v_dot2_f32_bf16 v72, v30, v134, 0
    v_dot2_f32_bf16 v73, v30, v135, 0
    v_dot2_f32_bf16 v74, v32, v134, 0
    v_dot2_f32_bf16 v75, v32, v135, 0
    v_dot2_f32_bf16 v76, v33, v134, 0
    v_dot2_f32_bf16 v77, v33, v135, 0
    v_dot2_f32_bf16 v78, v34, v134, 0
    v_dot2_f32_bf16 v79, v34, v135, 0
    v_dot2_f32_bf16 v80, v36, v134, 0
    v_dot2_f32_bf16 v81, v36, v135, 0
    v_dot2_f32_bf16 v82, v37, v134, 0
    v_dot2_f32_bf16 v83, v37, v135, 0
    v_dot2_f32_bf16 v84, v38, v134, 0
    v_dot2_f32_bf16 v85, v38, v135, 0
    v_max3_f32 v86, v68, v69, v70
    v_max3_f32 v87, v71, v72, v73
    v_max3_f32 v87, v87, v74, v75
    v_max3_f32 v86, v86, v76, v77
    v_max3_f32 v87, v87, v78, v79
    v_max3_f32 v86, v86, v80, v81
    v_max3_f32 v87, v87, v82, v83
    v_max3_f32 v86, v86, v84, v85
    v_max_f32 v86, v86, v87
    v_mul_f32 v86, s74, v86
    v_pk_fma_f32 v[68:69], v[68:69], s[74:75], v[86:87] op_sel_hi:[1,0,0] neg_lo:[0,0,1] neg_hi:[0,0,1]
    v_pk_fma_f32 v[70:71], v[70:71], s[74:75], v[86:87] op_sel_hi:[1,0,0] neg_lo:[0,0,1] neg_hi:[0,0,1]
    v_pk_fma_f32 v[72:73], v[72:73], s[74:75], v[86:87] op_sel_hi:[1,0,0] neg_lo:[0,0,1] neg_hi:[0,0,1]
    v_pk_fma_f32 v[74:75], v[74:75], s[74:75], v[86:87] op_sel_hi:[1,0,0] neg_lo:[0,0,1] neg_hi:[0,0,1]
    v_pk_fma_f32 v[76:77], v[76:77], s[74:75], v[86:87] op_sel_hi:[1,0,0] neg_lo:[0,0,1] neg_hi:[0,0,1]
    v_pk_fma_f32 v[78:79], v[78:79], s[74:75], v[86:87] op_sel_hi:[1,0,0] neg_lo:[0,0,1] neg_hi:[0,0,1]
    v_pk_fma_f32 v[80:81], v[80:81], s[74:75], v[86:87] op_sel_hi:[1,0,0] neg_lo:[0,0,1] neg_hi:[0,0,1]
    v_pk_fma_f32 v[82:83], v[82:83], s[74:75], v[86:87] op_sel_hi:[1,0,0] neg_lo:[0,0,1] neg_hi:[0,0,1]
    v_pk_fma_f32 v[84:85], v[84:85], s[74:75], v[86:87] op_sel_hi:[1,0,0] neg_lo:[0,0,1] neg_hi:[0,0,1]
    v_exp_f32 v68, v68
    v_exp_f32 v69, v69
    v_exp_f32 v70, v70
    v_exp_f32 v71, v71
    v_exp_f32 v72, v72
    v_exp_f32 v73, v73
    v_pk_add_f32 v[88:89], v[68:69], v[70:71]
    v_exp_f32 v74, v74
    v_exp_f32 v75, v75
    v_pk_add_f32 v[88:89], v[88:89], v[72:73]
    v_exp_f32 v76, v76
    v_exp_f32 v77, v77
    v_pk_add_f32 v[88:89], v[88:89], v[74:75]
    v_exp_f32 v78, v78
    v_exp_f32 v79, v79
    v_pk_add_f32 v[88:89], v[88:89], v[76:77]
    v_exp_f32 v80, v80
    v_exp_f32 v81, v81
    v_pk_add_f32 v[88:89], v[88:89], v[78:79]
    v_exp_f32 v82, v82
    v_exp_f32 v83, v83
    v_pk_add_f32 v[88:89], v[88:89], v[80:81]
    v_exp_f32 v84, v84
    v_exp_f32 v85, v85
    v_pk_add_f32 v[88:89], v[88:89], v[82:83]
    v_pk_add_f32 v[88:89], v[88:89], v[84:85]
    v_add_f32 v86, v88, v89
    v_rcp_f32 v86, v86
    s_nop 0
    v_pk_mul_f32 v[68:69], v[68:69], v[86:87] op_sel_hi:[1,0]
    v_pk_mul_f32 v[70:71], v[70:71], v[86:87] op_sel_hi:[1,0]
    s_nop 0
    v_pk_mul_f32 v[72:73], v[72:73], v[86:87] op_sel_hi:[1,0]
    v_pk_mul_f32 v[74:75], v[74:75], v[86:87] op_sel_hi:[1,0]
    v_pk_mul_f32 v[76:77], v[76:77], v[86:87] op_sel_hi:[1,0]
    v_pk_mul_f32 v[78:79], v[78:79], v[86:87] op_sel_hi:[1,0]
    v_pk_mul_f32 v[80:81], v[80:81], v[86:87] op_sel_hi:[1,0]
    v_pk_mul_f32 v[82:83], v[82:83], v[86:87] op_sel_hi:[1,0]
    v_pk_mul_f32 v[84:85], v[84:85], v[86:87] op_sel_hi:[1,0]
    v_cvt_pk_bf16_f32 v92, v68, v69
    v_cvt_pk_bf16_f32 v93, v70, v71
    v_cvt_pk_bf16_f32 v94, v72, v73
    v_cvt_pk_bf16_f32 v95, v74, v75
    v_cvt_pk_bf16_f32 v96, v76, v77
    v_cvt_pk_bf16_f32 v97, v78, v79
    v_cvt_pk_bf16_f32 v98, v80, v81
    v_cvt_pk_bf16_f32 v99, v82, v83
    v_cvt_pk_bf16_f32 v100, v84, v85
    s_branch L_RED
L_TV:
    s_mov_b32 s77, 0
    s_mov_b32 s74, 1069066811
    v_mov_b32 v101, 0
    v_mov_b32 v113, 0
    v_mov_b32 v115, 0
    s_waitcnt vmcnt(11)
L_TQ:
L_QchkV:
    v_sad_u32 v20, v31, s76, 0
    v_sad_u32 v20, v35, s76, v20
    v_sad_u32 v20, v39, s76, v20
    v_cmp_ne_u32 vcc, 0, v20
    s_cbranch_vccnz L_QretryV
L_QokV:
    v_dot2_f32_bf16 v68, v28, v134, 0
    v_dot2_f32_bf16 v69, v28, v135, 0
    v_dot2_f32_bf16 v70, v29, v134, 0
    v_dot2_f32_bf16 v71, v29, v135, 0
    v_dot2_f32_bf16 v72, v30, v134, 0
    v_dot2_f32_bf16 v73, v30, v135, 0
    v_dot2_f32_bf16 v74, v32, v134, 0
    v_dot2_f32_bf16 v75, v32, v135, 0
    v_dot2_f32_bf16 v76, v33, v134, 0
    v_dot2_f32_bf16 v77, v33, v135, 0
    v_dot2_f32_bf16 v78, v34, v134, 0
    v_dot2_f32_bf16 v79, v34, v135, 0
    v_dot2_f32_bf16 v80, v36, v134, 0
    v_dot2_f32_bf16 v81, v36, v135, 0
    v_dot2_f32_bf16 v82, v37, v134, 0
    v_dot2_f32_bf16 v83, v37, v135, 0
    v_dot2_f32_bf16 v84, v38, v134, 0
    v_dot2_f32_bf16 v85, v38, v135, 0
    v_max3_f32 v86, v68, v69, v70
    v_max3_f32 v87, v71, v72, v73
    v_max3_f32 v87, v87, v74, v75
    v_max3_f32 v86, v86, v76, v77
    v_max3_f32 v87, v87, v78, v79
    v_max3_f32 v86, v86, v80, v81
    v_max3_f32 v87, v87, v82, v83
    v_max3_f32 v86, v86, v84, v85
    v_max_f32 v86, v86, v87
    v_mul_f32 v86, s74, v86
    v_pk_fma_f32 v[68:69], v[68:69], s[74:75], v[86:87] op_sel_hi:[1,0,0] neg_lo:[0,0,1] neg_hi:[0,0,1]
    v_pk_fma_f32 v[70:71], v[70:71], s[74:75], v[86:87] op_sel_hi:[1,0,0] neg_lo:[0,0,1] neg_hi:[0,0,1]
    v_pk_fma_f32 v[72:73], v[72:73], s[74:75], v[86:87] op_sel_hi:[1,0,0] neg_lo:[0,0,1] neg_hi:[0,0,1]
    v_pk_fma_f32 v[74:75], v[74:75], s[74:75], v[86:87] op_sel_hi:[1,0,0] neg_lo:[0,0,1] neg_hi:[0,0,1]
    v_pk_fma_f32 v[76:77], v[76:77], s[74:75], v[86:87] op_sel_hi:[1,0,0] neg_lo:[0,0,1] neg_hi:[0,0,1]
    v_pk_fma_f32 v[78:79], v[78:79], s[74:75], v[86:87] op_sel_hi:[1,0,0] neg_lo:[0,0,1] neg_hi:[0,0,1]
    v_pk_fma_f32 v[80:81], v[80:81], s[74:75], v[86:87] op_sel_hi:[1,0,0] neg_lo:[0,0,1] neg_hi:[0,0,1]
    v_pk_fma_f32 v[82:83], v[82:83], s[74:75], v[86:87] op_sel_hi:[1,0,0] neg_lo:[0,0,1] neg_hi:[0,0,1]
    v_pk_fma_f32 v[84:85], v[84:85], s[74:75], v[86:87] op_sel_hi:[1,0,0] neg_lo:[0,0,1] neg_hi:[0,0,1]
    v_exp_f32 v68, v68
    v_exp_f32 v69, v69
    v_exp_f32 v70, v70
    v_exp_f32 v71, v71
    v_exp_f32 v72, v72
    v_exp_f32 v73, v73
    v_pk_add_f32 v[88:89], v[68:69], v[70:71]
    v_exp_f32 v74, v74
    v_exp_f32 v75, v75
    v_pk_add_f32 v[88:89], v[88:89], v[72:73]
    v_exp_f32 v76, v76
    v_exp_f32 v77, v77
    v_pk_add_f32 v[88:89], v[88:89], v[74:75]
    v_exp_f32 v78, v78
    v_exp_f32 v79, v79
    v_pk_add_f32 v[88:89], v[88:89], v[76:77]
    v_exp_f32 v80, v80
    v_exp_f32 v81, v81
    v_pk_add_f32 v[88:89], v[88:89], v[78:79]
    v_exp_f32 v82, v82
    v_exp_f32 v83, v83
    v_pk_add_f32 v[88:89], v[88:89], v[80:81]
    v_exp_f32 v84, v84
    v_exp_f32 v85, v85
    v_pk_add_f32 v[88:89], v[88:89], v[82:83]
    v_pk_add_f32 v[88:89], v[88:89], v[84:85]
    v_add_f32 v86, v88, v89
    v_rcp_f32 v86, v86
    s_nop 0
    v_pk_mul_f32 v[68:69], v[68:69], v[86:87] op_sel_hi:[1,0]
    s_nop 0
    v_pk_mul_f32 v[70:71], v[70:71], v[86:87] op_sel_hi:[1,0]
    v_pk_mul_f32 v[72:73], v[72:73], v[86:87] op_sel_hi:[1,0]
    v_pk_mul_f32 v[74:75], v[74:75], v[86:87] op_sel_hi:[1,0]
    v_pk_mul_f32 v[76:77], v[76:77], v[86:87] op_sel_hi:[1,0]
    v_pk_mul_f32 v[78:79], v[78:79], v[86:87] op_sel_hi:[1,0]
    v_pk_mul_f32 v[80:81], v[80:81], v[86:87] op_sel_hi:[1,0]
    v_pk_mul_f32 v[82:83], v[82:83], v[86:87] op_sel_hi:[1,0]
    v_pk_mul_f32 v[84:85], v[84:85], v[86:87] op_sel_hi:[1,0]
    v_cvt_pk_bf16_f32 v92, v68, v69
    v_cvt_pk_bf16_f32 v93, v70, v71
    v_cvt_pk_bf16_f32 v94, v72, v73
    v_cvt_pk_bf16_f32 v95, v74, v75
    v_cvt_pk_bf16_f32 v96, v76, v77
    v_cvt_pk_bf16_f32 v97, v78, v79
    v_cvt_pk_bf16_f32 v98, v80, v81
    v_cvt_pk_bf16_f32 v99, v82, v83
    v_cvt_pk_bf16_f32 v100, v84, v85
    buffer_load_dwordx4 v[52:55], v130, s[48:51], s20 offen sc1
    buffer_load_dwordx4 v[56:59], v130, s[48:51], s21 offen sc1
    buffer_load_dwordx4 v[60:63], v130, s[48:51], s22 offen sc1
    buffer_load_dwordx4 v[64:67], v130, s[48:51], s23 offen sc1
    s_cmp_eq_u32 s19, 0
    s_cbranch_scc1 L_RED
L_QchkW:
    v_sad_u32 v20, v43, s76, 0
    v_sad_u32 v20, v47, s76, v20
    v_sad_u32 v20, v51, s76, v20
    v_cmp_ne_u32 vcc, 0, v20
    s_cbranch_vccnz L_QretryW
L_QokW:
    v_dot2_f32_bf16 v68, v40, v134, 0
    v_dot2_f32_bf16 v69, v40, v135, 0
    v_dot2_f32_bf16 v70, v41, v134, 0
    v_dot2_f32_bf16 v71, v41, v135, 0
    v_dot2_f32_bf16 v72, v42, v134, 0
    v_dot2_f32_bf16 v73, v42, v135, 0
    v_dot2_f32_bf16 v74, v44, v134, 0
    v_dot2_f32_bf16 v75, v44, v135, 0
    v_dot2_f32_bf16 v76, v45, v134, 0
    v_dot2_f32_bf16 v77, v45, v135, 0
    v_dot2_f32_bf16 v78, v46, v134, 0
    v_dot2_f32_bf16 v79, v46, v135, 0
    v_dot2_f32_bf16 v80, v48, v134, 0
    v_dot2_f32_bf16 v81, v48, v135, 0
    v_dot2_f32_bf16 v82, v49, v134, 0
    v_dot2_f32_bf16 v83, v49, v135, 0
    v_dot2_f32_bf16 v84, v50, v134, 0
    v_dot2_f32_bf16 v85, v50, v135, 0
    v_max3_f32 v86, v68, v69, v70
    v_max3_f32 v87, v71, v72, v73
    v_max3_f32 v87, v87, v74, v75
    v_max3_f32 v86, v86, v76, v77
    v_max3_f32 v87, v87, v78, v79
    v_max3_f32 v86, v86, v80, v81
    v_max3_f32 v87, v87, v82, v83
    v_max3_f32 v86, v86, v84, v85
    v_max_f32 v86, v86, v87
    v_mul_f32 v86, s74, v86
    v_pk_fma_f32 v[68:69], v[68:69], s[74:75], v[86:87] op_sel_hi:[1,0,0] neg_lo:[0,0,1] neg_hi:[0,0,1]
    v_pk_fma_f32 v[70:71], v[70:71], s[74:75], v[86:87] op_sel_hi:[1,0,0] neg_lo:[0,0,1] neg_hi:[0,0,1]
    v_pk_fma_f32 v[72:73], v[72:73], s[74:75], v[86:87] op_sel_hi:[1,0,0] neg_lo:[0,0,1] neg_hi:[0,0,1]
    v_pk_fma_f32 v[74:75], v[74:75], s[74:75], v[86:87] op_sel_hi:[1,0,0] neg_lo:[0,0,1] neg_hi:[0,0,1]
    v_pk_fma_f32 v[76:77], v[76:77], s[74:75], v[86:87] op_sel_hi:[1,0,0] neg_lo:[0,0,1] neg_hi:[0,0,1]
    v_pk_fma_f32 v[78:79], v[78:79], s[74:75], v[86:87] op_sel_hi:[1,0,0] neg_lo:[0,0,1] neg_hi:[0,0,1]
    v_pk_fma_f32 v[80:81], v[80:81], s[74:75], v[86:87] op_sel_hi:[1,0,0] neg_lo:[0,0,1] neg_hi:[0,0,1]
    v_pk_fma_f32 v[82:83], v[82:83], s[74:75], v[86:87] op_sel_hi:[1,0,0] neg_lo:[0,0,1] neg_hi:[0,0,1]
    v_pk_fma_f32 v[84:85], v[84:85], s[74:75], v[86:87] op_sel_hi:[1,0,0] neg_lo:[0,0,1] neg_hi:[0,0,1]
    v_exp_f32 v68, v68
    v_exp_f32 v69, v69
    v_exp_f32 v70, v70
    v_exp_f32 v71, v71
    v_exp_f32 v72, v72
    v_exp_f32 v73, v73
    v_pk_add_f32 v[88:89], v[68:69], v[70:71]
    v_exp_f32 v74, v74
    v_exp_f32 v75, v75
    v_pk_add_f32 v[88:89], v[88:89], v[72:73]
    v_exp_f32 v76, v76
    v_exp_f32 v77, v77
    v_pk_add_f32 v[88:89], v[88:89], v[74:75]
    v_exp_f32 v78, v78
    v_exp_f32 v79, v79
    v_pk_add_f32 v[88:89], v[88:89], v[76:77]
    v_exp_f32 v80, v80
    v_exp_f32 v81, v81
    v_pk_add_f32 v[88:89], v[88:89], v[78:79]
    v_exp_f32 v82, v82
    v_exp_f32 v83, v83
    v_pk_add_f32 v[88:89], v[88:89], v[80:81]
    v_exp_f32 v84, v84
    v_exp_f32 v85, v85
    v_pk_add_f32 v[88:89], v[88:89], v[82:83]
    v_pk_add_f32 v[88:89], v[88:89], v[84:85]
    v_add_f32 v86, v88, v89
    v_rcp_f32 v86, v86
    s_nop 0
    v_pk_mul_f32 v[68:69], v[68:69], v[86:87] op_sel_hi:[1,0]
    v_pk_mul_f32 v[70:71], v[70:71], v[86:87] op_sel_hi:[1,0]
    v_pk_mul_f32 v[72:73], v[72:73], v[86:87] op_sel_hi:[1,0]
    s_nop 0
    v_pk_mul_f32 v[74:75], v[74:75], v[86:87] op_sel_hi:[1,0]
    v_pk_mul_f32 v[76:77], v[76:77], v[86:87] op_sel_hi:[1,0]
    v_pk_mul_f32 v[78:79], v[78:79], v[86:87] op_sel_hi:[1,0]
    v_pk_mul_f32 v[80:81], v[80:81], v[86:87] op_sel_hi:[1,0]
    v_pk_mul_f32 v[82:83], v[82:83], v[86:87] op_sel_hi:[1,0]
    v_pk_mul_f32 v[84:85], v[84:85], v[86:87] op_sel_hi:[1,0]
    v_cvt_pk_bf16_f32 v104, v68, v69
    v_cvt_pk_bf16_f32 v105, v70, v71
    v_cvt_pk_bf16_f32 v106, v72, v73
    v_cvt_pk_bf16_f32 v107, v74, v75
    v_cvt_pk_bf16_f32 v108, v76, v77
    v_cvt_pk_bf16_f32 v109, v78, v79
    v_cvt_pk_bf16_f32 v110, v80, v81
    v_cvt_pk_bf16_f32 v111, v82, v83
    v_cvt_pk_bf16_f32 v112, v84, v85
L_RED:
    s_waitcnt vmcnt(0)
L_Rchk:
    v_sad_u32 v20, v55, s76, 0
    v_sad_u32 v20, v59, s76, v20
    v_sad_u32 v20, v63, s76, v20
    v_sad_u32 v20, v67, s76, v20
    v_cmp_ne_u32 vcc, 0, v20
    s_nop 0
    s_and_b64 vcc, vcc, s[24:25]
    s_cbranch_vccnz L_Rretry
L_Rok:
    v_mov_b32 v55, 0
    v_mov_b32 v59, 0
    v_mov_b32 v63, 0
    v_mov_b32_e64 v67, 0
    v_mfma_f32_16x16x32_bf16 v[20:23], v[136:139], v[52:55], 0
    v_mfma_f32_16x16x32_bf16 v[20:23], v[136:139], v[56:59], v[20:23]
    v_mfma_f32_16x16x32_bf16 v[20:23], v[136:139], v[60:63], v[20:23]
    v_mfma_f32_16x16x32_bf16 v[20:23], v[136:139], v[64:67], v[20:23]
    v_mov_b32 v71, s76
    v_mov_b32 v75, s76
    v_mov_b32 v79, s76
    v_mov_b32 v83, s76
    s_nop 3
    v_cvt_pk_bf16_f32 v20, v20, v21
    s_mov_b64 exec, s[26:27]
    ds_write_b32 v131, v20
    s_mov_b64 exec, -1
    s_waitcnt lgkmcnt(0)
    s_barrier
    ds_read_b32 v114, v132 offset:32
    ds_read_b128 v[116:119], v132
    ds_read_b128 v[120:123], v132 offset:16
    s_cmp_eq_u32 s19, 0
    s_cbranch_scc1 L_O1
    s_waitcnt lgkmcnt(2)
    v_mfma_f32_32x32x8_bf16 v[28:43], v[114:115], v[100:101], 0
    v_mfma_f32_32x32x8_bf16 v[44:59], v[114:115], v[112:113], 0
    s_waitcnt lgkmcnt(0)
    s_nop 7
    v_mfma_f32_32x32x16_bf16 v[28:43], v[116:119], v[92:95], v[28:43]
    v_mfma_f32_32x32x16_bf16 v[28:43], v[120:123], v[96:99], v[28:43]
    v_mfma_f32_32x32x16_bf16 v[44:59], v[116:119], v[104:107], v[44:59]
    v_mfma_f32_32x32x16_bf16 v[44:59], v[120:123], v[108:111], v[44:59]
    s_nop 9
    v_add_f32 v40, 0x358637bd, v40
    v_rcp_f32 v40, v40
    s_nop 0
    v_mul_f32 v28, v40, v28
    v_mul_f32 v29, v40, v29
    v_mul_f32 v30, v40, v30
    v_mul_f32 v31, v40, v31
    v_mul_f32 v32, v40, v32
    v_mul_f32_e64 v33, v40, v33
    v_cvt_pk_bf16_f32 v68, v28, v29
    v_cvt_pk_bf16_f32 v69, v30, v31
    v_cvt_pk_bf16_f32 v70, v32, v33
    buffer_store_dwordx4 v[68:71], v133, s[48:51], s28 offen offset:0 sc1
    v_mul_f32 v34, v40, v34
    v_mul_f32 v35, v40, v35
    v_mul_f32 v36, v40, v36
    v_mul_f32 v37, v40, v37
    v_mul_f32 v38, v40, v38
    v_mul_f32 v39, v40, v39
    v_cvt_pk_bf16_f32 v72, v34, v35
    v_cvt_pk_bf16_f32 v73, v36, v37
    v_cvt_pk_bf16_f32 v74, v38, v39
    s_mov_b32 exec_hi, 0
    buffer_store_dwordx4 v[72:75], v133, s[48:51], s28 offen offset:512 sc1
    s_mov_b32 exec_hi, -1
    v_add_f32 v56, 0x358637bd, v56
    v_rcp_f32 v56, v56
    s_nop 0
    v_mul_f32 v44, v56, v44
    v_mul_f32 v45, v56, v45
    v_mul_f32 v46, v56, v46
    v_mul_f32 v47, v56, v47
    v_mul_f32 v48, v56, v48
    v_mul_f32 v49, v56, v49
    v_cvt_pk_bf16_f32 v76, v44, v45
    v_cvt_pk_bf16_f32 v77, v46, v47
    v_cvt_pk_bf16_f32 v78, v48, v49
    buffer_store_dwordx4 v[76:79], v133, s[48:51], s29 offen offset:0 sc1
    v_mul_f32 v50, v56, v50
    v_mul_f32 v51, v56, v51
    v_mul_f32 v52, v56, v52
    v_mul_f32 v53, v56, v53
    v_mul_f32 v54, v56, v54
    v_mul_f32 v55, v56, v55
    v_cvt_pk_bf16_f32 v80, v50, v51
    v_cvt_pk_bf16_f32 v81, v52, v53
    v_cvt_pk_bf16_f32 v82, v54, v55
    s_mov_b32 exec_hi, 0
    buffer_store_dwordx4 v[80:83], v133, s[48:51], s29 offen offset:512 sc1
    s_mov_b32 exec_hi, -1
    s_branch L_O2
L_O1:
    s_waitcnt lgkmcnt(2)
    v_mfma_f32_32x32x8_bf16 v[28:43], v[114:115], v[100:101], 0
    s_waitcnt lgkmcnt(0)
    s_nop 8
    v_mfma_f32_32x32x16_bf16 v[28:43], v[116:119], v[92:95], v[28:43]
    v_mfma_f32_32x32x16_bf16 v[28:43], v[120:123], v[96:99], v[28:43]
    s_nop 11
    v_add_f32 v40, 0x358637bd, v40
    v_rcp_f32 v40, v40
    s_nop 0
    v_mul_f32 v28, v40, v28
    v_mul_f32 v29, v40, v29
    v_mul_f32 v30, v40, v30
    v_mul_f32 v31, v40, v31
    v_mul_f32 v32, v40, v32
    v_mul_f32_e64 v33, v40, v33
    v_cvt_pk_bf16_f32 v68, v28, v29
    v_cvt_pk_bf16_f32 v69, v30, v31
    v_cvt_pk_bf16_f32 v70, v32, v33
    buffer_store_dwordx4 v[68:71], v133, s[48:51], s28 offen offset:0 sc1
    v_mul_f32 v34, v40, v34
    v_mul_f32 v35, v40, v35
    v_mul_f32 v36, v40, v36
    v_mul_f32 v37, v40, v37
    v_mul_f32 v38, v40, v38
    v_mul_f32 v39, v40, v39
    v_cvt_pk_bf16_f32 v72, v34, v35
    v_cvt_pk_bf16_f32 v73, v36, v37
    v_cvt_pk_bf16_f32 v74, v38, v39
    s_mov_b32 exec_hi, 0
    buffer_store_dwordx4 v[72:75], v133, s[48:51], s28 offen offset:512 sc1
    s_mov_b32 exec_hi, -1
L_O2:
    s_cmp_lt_u32 s3, 4
    s_cbranch_scc1 L_O3
    s_cmp_ge_u32 s7, 4
    s_cbranch_scc1 L_O3
    s_add_u32 s79, s32, 12288
    buffer_load_dwordx4 v[188:191], v124, s[48:51], s79 offen sc1
    s_add_u32 s79, s32, 13312
    buffer_load_dwordx4 v[192:195], v124, s[48:51], s79 offen sc1
    s_add_u32 s79, s32, 14336
    buffer_load_dwordx4 v[196:199], v124, s[48:51], s79 offen sc1
    s_add_u32 s79, s32, 15360
    buffer_load_dwordx4 v[200:203], v124, s[48:51], s79 offen sc1
    s_add_u32 s79, s32, 16384
    buffer_load_dwordx4 v[204:207], v124, s[48:51], s79 offen sc1
    s_add_u32 s79, s32, 17408
    buffer_load_dwordx4 v[208:211], v124, s[48:51], s79 offen sc1
    s_add_u32 s79, s32, 18432
    buffer_load_dwordx4 v[212:215], v124, s[48:51], s79 offen sc1
    s_add_u32 s79, s32, 19456
    buffer_load_dwordx4 v[216:219], v124, s[48:51], s79 offen sc1
    s_add_u32 s79, s32, 20480
    buffer_load_dwordx4 v[220:223], v124, s[48:51], s79 offen sc1
    s_add_u32 s79, s32, 21504
    buffer_load_dwordx4 v[224:227], v124, s[48:51], s79 offen sc1
    s_add_u32 s79, s32, 22528
    buffer_load_dwordx4 v[228:231], v124, s[48:51], s79 offen sc1
    s_add_u32 s79, s32, 23552
    buffer_load_dwordx4 v[232:235], v124, s[48:51], s79 offen sc1
    s_add_u32 s79, s32, 24576
    buffer_load_dwordx4 v[236:239], v124, s[48:51], s79 offen sc1
    s_add_u32 s79, s32, 25600
    buffer_load_dwordx4 v[240:243], v124, s[48:51], s79 offen sc1
    s_add_u32 s79, s32, 26624
    buffer_load_dwordx4 v[244:247], v124, s[48:51], s79 offen sc1
L_O3:
    s_waitcnt vmcnt(0)
    buffer_load_dwordx4 v[28:31], v2, s[48:51], s14 offen offset:0 sc1
    buffer_load_dwordx4 v[32:35], v2, s[48:51], s14 offen offset:512 sc1
    buffer_load_dwordx4 v[36:39], v2, s[48:51], s14 offen offset:1024 sc1
    buffer_load_dwordx4 v[40:43], v2, s[48:51], s14 offen offset:1536 sc1
    buffer_load_dwordx4 v[44:47], v2, s[48:51], s14 offen offset:2048 sc1
    buffer_load_dwordx4 v[48:51], v2, s[48:51], s14 offen offset:2560 sc1
    s_waitcnt vmcnt(0)
L_Ochk:
    v_sad_u32 v20, v31, s76, 0
    v_sad_u32 v20, v35, s76, v20
    v_sad_u32 v20, v39, s76, v20
    v_sad_u32 v20, v43, s76, v20
    v_sad_u32 v20, v47, s76, v20
    v_sad_u32 v20, v51, s76, v20
    v_cmp_ne_u32 vcc, 0, v20
    s_cbranch_vccnz L_Oretry
L_Ook:
    v_mov_b32 v31, v36
    v_mov_b32 v35, v37
    v_mov_b32 v43, v38
    v_mov_b32 v47, v50
    ds_write_b128 v3, v[28:31] offset:0
    ds_write_b128 v3, v[32:35] offset:1024
    ds_write_b128 v3, v[40:43] offset:2048
    ds_write_b128 v3, v[44:47] offset:3072
    ds_write_b64 v4, v[48:49]
    s_waitcnt lgkmcnt(0)
    s_barrier
    ds_read_b128 v[28:31], v5 offset:0
    ds_read_b128 v[32:35], v5 offset:256
    ds_read_b128 v[36:39], v5 offset:2048
    ds_read_b128 v[40:43], v5 offset:2304
    ds_read_b128 v[44:47], v5 offset:4096
    ds_read_b128 v[48:51], v5 offset:4352
    s_waitcnt lgkmcnt(4)
    v_mfma_f32_16x16x32_bf16 v[100:103], v[140:143], v[28:31], 0
    v_mfma_f32_16x16x32_bf16 v[104:107], v[140:143], v[32:35], 0
    ds_read_b128 v[52:55], v5 offset:6144
    v_mfma_f32_16x16x32_bf16 v[108:111], v[144:147], v[28:31], 0
    v_mfma_f32_16x16x32_bf16 v[112:115], v[144:147], v[32:35], 0
    ds_read_b128 v[56:59], v5 offset:6400
    v_mfma_f32_16x16x32_bf16 v[116:119], v[148:151], v[28:31], 0
    v_mfma_f32_16x16x32_bf16 v[120:123], v[148:151], v[32:35], 0
    ds_read_b128 v[60:63], v5 offset:8192
    s_waitcnt lgkmcnt(5)
    v_mfma_f32_16x16x32_bf16 v[100:103], v[152:155], v[36:39], v[100:103]
    v_mfma_f32_16x16x32_bf16 v[104:107], v[152:155], v[40:43], v[104:107]
    ds_read_b128 v[64:67], v5 offset:8448
    v_mfma_f32_16x16x32_bf16 v[108:111], v[156:159], v[36:39], v[108:111]
    v_mfma_f32_16x16x32_bf16 v[112:115], v[156:159], v[40:43], v[112:115]
    ds_read_b128 v[68:71], v5 offset:10240
    v_mfma_f32_16x16x32_bf16 v[116:119], v[160:163], v[36:39], v[116:119]
    v_mfma_f32_16x16x32_bf16 v[120:123], v[160:163], v[40:43], v[120:123]
    ds_read_b128 v[72:75], v5 offset:10496
    s_waitcnt lgkmcnt(6)
    v_mfma_f32_16x16x32_bf16 v[100:103], v[164:167], v[44:47], v[100:103]
    v_mfma_f32_16x16x32_bf16 v[104:107], v[164:167], v[48:51], v[104:107]
    ds_read_b128 v[76:79], v5 offset:12288
    v_mfma_f32_16x16x32_bf16 v[108:111], v[168:171], v[44:47], v[108:111]
    v_mfma_f32_16x16x32_bf16 v[112:115], v[168:171], v[48:51], v[112:115]
    ds_read_b128 v[80:83], v5 offset:12544
    v_mfma_f32_16x16x32_bf16 v[116:119], v[172:175], v[44:47], v[116:119]
    v_mfma_f32_16x16x32_bf16 v[120:123], v[172:175], v[48:51], v[120:123]
    ds_read_b128 v[84:87], v5 offset:14336
    s_waitcnt lgkmcnt(7)
    v_mfma_f32_16x16x32_bf16 v[100:103], v[176:179], v[52:55], v[100:103]
    v_mfma_f32_16x16x32_bf16 v[104:107], v[176:179], v[56:59], v[104:107]
    ds_read_b128 v[88:91], v5 offset:14592
    v_mfma_f32_16x16x32_bf16 v[108:111], v[180:183], v[52:55], v[108:111]
    v_mfma_f32_16x16x32_bf16 v[112:115], v[180:183], v[56:59], v[112:115]
    ds_read_b128 v[92:95], v6 offset:0
    v_mfma_f32_16x16x32_bf16 v[116:119], v[184:187], v[52:55], v[116:119]
    v_mfma_f32_16x16x32_bf16 v[120:123], v[184:187], v[56:59], v[120:123]
    ds_read_b128 v[96:99], v6 offset:256
    s_waitcnt lgkmcnt(8)
    v_mfma_f32_16x16x32_bf16 v[100:103], v[188:191], v[60:63], v[100:103]
    v_mfma_f32_16x16x32_bf16 v[104:107], v[188:191], v[64:67], v[104:107]
    v_mfma_f32_16x16x32_bf16 v[108:111], v[192:195], v[60:63], v[108:111]
    v_mfma_f32_16x16x32_bf16 v[112:115], v[192:195], v[64:67], v[112:115]
    v_mfma_f32_16x16x32_bf16 v[116:119], v[196:199], v[60:63], v[116:119]
    v_mfma_f32_16x16x32_bf16 v[120:123], v[196:199], v[64:67], v[120:123]
    s_waitcnt lgkmcnt(6)
    v_mfma_f32_16x16x32_bf16 v[100:103], v[200:203], v[68:71], v[100:103]
    v_mfma_f32_16x16x32_bf16 v[104:107], v[200:203], v[72:75], v[104:107]
    v_mfma_f32_16x16x32_bf16 v[108:111], v[204:207], v[68:71], v[108:111]
    v_mfma_f32_16x16x32_bf16 v[112:115], v[204:207], v[72:75], v[112:115]
    v_mfma_f32_16x16x32_bf16 v[116:119], v[208:211], v[68:71], v[116:119]
    v_mfma_f32_16x16x32_bf16 v[120:123], v[208:211], v[72:75], v[120:123]
    s_waitcnt lgkmcnt(4)
    v_mfma_f32_16x16x32_bf16 v[100:103], v[212:215], v[76:79], v[100:103]
    v_mfma_f32_16x16x32_bf16 v[104:107], v[212:215], v[80:83], v[104:107]
    v_mfma_f32_16x16x32_bf16 v[108:111], v[216:219], v[76:79], v[108:111]
    v_mfma_f32_16x16x32_bf16 v[112:115], v[216:219], v[80:83], v[112:115]
    v_mfma_f32_16x16x32_bf16 v[116:119], v[220:223], v[76:79], v[116:119]
    v_mfma_f32_16x16x32_bf16 v[120:123], v[220:223], v[80:83], v[120:123]
    s_waitcnt lgkmcnt(2)
    v_mfma_f32_16x16x32_bf16 v[100:103], v[224:227], v[84:87], v[100:103]
    v_mfma_f32_16x16x32_bf16 v[104:107], v[224:227], v[88:91], v[104:107]
    v_mfma_f32_16x16x32_bf16 v[108:111], v[228:231], v[84:87], v[108:111]
    v_mfma_f32_16x16x32_bf16 v[112:115], v[228:231], v[88:91], v[112:115]
    v_mfma_f32_16x16x32_bf16 v[116:119], v[232:235], v[84:87], v[116:119]
    v_mfma_f32_16x16x32_bf16 v[120:123], v[232:235], v[88:91], v[120:123]
    s_waitcnt lgkmcnt(0)
    v_mfma_f32_16x16x32_bf16 v[100:103], v[236:239], v[92:95], v[100:103]
    v_mfma_f32_16x16x32_bf16 v[104:107], v[236:239], v[96:99], v[104:107]
    v_mfma_f32_16x16x32_bf16 v[108:111], v[240:243], v[92:95], v[108:111]
    v_mfma_f32_16x16x32_bf16 v[112:115], v[240:243], v[96:99], v[112:115]
    v_mfma_f32_16x16x32_bf16 v[116:119], v[244:247], v[92:95], v[116:119]
    v_mfma_f32_16x16x32_bf16 v[120:123], v[244:247], v[96:99], v[120:123]
    s_nop 2
    ds_write_b128 v7, v[100:103] offset:0
    ds_write_b128 v7, v[104:107] offset:12544
    ds_write_b128 v7, v[108:111] offset:256
    ds_write_b128 v7, v[112:115] offset:12800
    ds_write_b128 v7, v[116:119] offset:512
    ds_write_b128 v7, v[120:123] offset:13056
    s_waitcnt lgkmcnt(0)
    s_barrier
    ds_read_b128 v[28:31], v13 offset:0
    ds_read_b128 v[32:35], v13 offset:16
    ds_read_b128 v[36:39], v13 offset:25088
    ds_read_b128 v[40:43], v13 offset:25104
    ds_read_b128 v[44:47], v14 offset:0
    ds_read_b128 v[48:51], v14 offset:16
    ds_read_b128 v[52:55], v14 offset:25088
    ds_read_b128 v[56:59], v14 offset:25104
    s_waitcnt lgkmcnt(4)
    v_pk_add_f32 v[28:29], v[28:29], v[36:37]
    s_nop 0
    v_pk_add_f32 v[30:31], v[30:31], v[38:39]
    v_pk_add_f32 v[32:33], v[32:33], v[40:41]
    v_pk_add_f32 v[34:35], v[34:35], v[42:43]
    v_cvt_pk_bf16_f32 v60, v28, v29
    v_cvt_pk_bf16_f32 v61, v30, v31
    v_cvt_pk_bf16_f32 v62, v32, v33
    v_cvt_pk_bf16_f32 v63, v34, v35
    buffer_store_dwordx4 v[60:63], v15, s[56:59], s15 offen
    s_waitcnt lgkmcnt(0)
    v_pk_add_f32 v[44:45], v[44:45], v[52:53]
    v_pk_add_f32 v[46:47], v[46:47], v[54:55]
    v_pk_add_f32 v[48:49], v[48:49], v[56:57]
    s_nop 0
    v_pk_add_f32 v[50:51], v[50:51], v[58:59]
    v_cvt_pk_bf16_f32 v64, v44, v45
    v_cvt_pk_bf16_f32 v65, v46, v47
    v_cvt_pk_bf16_f32 v66, v48, v49
    v_cvt_pk_bf16_f32 v67, v50, v51
    s_mov_b32 exec_hi, 0
    buffer_store_dwordx4 v[64:67], v16, s[56:59], s15 offen
    s_branch L_fin
L_Wretry1:
    s_add_u32 s77, s77, 1
    s_cmp_ge_u32 s77, 32768
    s_cbranch_scc1 L_Wok1
    s_sleep 2
    buffer_load_dword v126, v125, s[48:51], s33 offen sc1
    s_waitcnt vmcnt(0)
    s_branch L_Wchk1
L_Wretry2:
    s_add_u32 s77, s77, 1
    s_cmp_ge_u32 s77, 32768
    s_cbranch_scc1 L_Wok2
    s_sleep 2
    buffer_load_dword v126, v125, s[48:51], s33 offen sc1
    s_waitcnt vmcnt(0)
    s_branch L_Wchk2
L_QretryK:
    s_add_u32 s77, s77, 1
    s_cmp_ge_u32 s77, 32768
    s_cbranch_scc1 L_QokK
    s_sleep 2
    buffer_load_dwordx4 v[28:31], v128, s[48:51], s16 offen sc1
    buffer_load_dwordx4 v[32:35], v128, s[48:51], s17 offen sc1
    buffer_load_dwordx4 v[36:39], v128, s[48:51], s18 offen sc1
    s_waitcnt vmcnt(0)
    s_branch L_QchkK
L_QretryV:
    s_add_u32 s77, s77, 1
    s_cmp_ge_u32 s77, 32768
    s_cbranch_scc1 L_QokV
    s_sleep 2
    buffer_load_dwordx4 v[28:31], v128, s[48:51], s16 offen sc1
    buffer_load_dwordx4 v[32:35], v128, s[48:51], s17 offen sc1
    buffer_load_dwordx4 v[36:39], v128, s[48:51], s18 offen sc1
    s_waitcnt vmcnt(0)
    s_branch L_QchkV
L_QretryW:
    s_add_u32 s77, s77, 1
    s_cmp_ge_u32 s77, 32768
    s_cbranch_scc1 L_QokW
    s_sleep 2
    buffer_load_dwordx4 v[40:43], v129, s[48:51], s16 offen sc1
    buffer_load_dwordx4 v[44:47], v129, s[48:51], s17 offen sc1
    buffer_load_dwordx4 v[48:51], v129, s[48:51], s18 offen sc1
    s_waitcnt vmcnt(0)
    s_branch L_QchkW
L_Rretry:
    s_add_u32 s77, s77, 1
    s_cmp_ge_u32 s77, 32768
    s_cbranch_scc1 L_Rok
    s_sleep 2
    buffer_load_dwordx4 v[52:55], v130, s[48:51], s20 offen sc1
    buffer_load_dwordx4 v[56:59], v130, s[48:51], s21 offen sc1
    buffer_load_dwordx4 v[60:63], v130, s[48:51], s22 offen sc1
    buffer_load_dwordx4 v[64:67], v130, s[48:51], s23 offen sc1
    s_waitcnt vmcnt(0)
    s_branch L_Rchk
L_Oretry:
    s_add_u32 s77, s77, 1
    s_cmp_ge_u32 s77, 32768
    s_cbranch_scc1 L_Ook
    s_sleep 2
    buffer_load_dwordx4 v[28:31], v2, s[48:51], s14 offen offset:0 sc1
    buffer_load_dwordx4 v[32:35], v2, s[48:51], s14 offen offset:512 sc1
    buffer_load_dwordx4 v[36:39], v2, s[48:51], s14 offen offset:1024 sc1
    buffer_load_dwordx4 v[40:43], v2, s[48:51], s14 offen offset:1536 sc1
    buffer_load_dwordx4 v[44:47], v2, s[48:51], s14 offen offset:2048 sc1
    buffer_load_dwordx4 v[48:51], v2, s[48:51], s14 offen offset:2560 sc1
    s_waitcnt vmcnt(0)
    s_branch L_Ochk
L_B:
    s_sub_u32 s12, s5, 24
    s_lshl_b32 s8, s4, 3
    s_add_u32 s8, s8, s12
    v_add_u32_e64 v10, 0, v1
    v_mul_u32_u24 v10, 911, v10
    v_lshrrev_b32_e64 v20, 16, v10
    v_mul_u32_u24 v10, 72576, v20
    v_lshl_add_u32 v2, v1, 4, v10
    v_add_u32_e64 v10, 64, v1
    v_mul_u32_u24 v10, 911, v10
    v_lshrrev_b32_e64 v21, 16, v10
    v_mul_u32_u24 v10, 72576, v21
    v_lshl_add_u32 v3, v1, 4, v10
    v_add_u32 v10, 128, v1
    v_mul_u32_u24 v10, 911, v10
    v_lshrrev_b32_e64 v22, 16, v10
    v_mul_u32_u24 v10, 72576, v22
    v_lshl_add_u32 v4, v1, 4, v10
    v_add_u32 v10, 192, v1
    v_mul_u32_u24 v10, 911, v10
    v_lshrrev_b32_e64 v23, 16, v10
    v_mul_u32_u24 v10, 72576, v23
    v_lshl_add_u32 v5, v1, 4, v10
    v_add_u32 v10, 256, v1
    v_mul_u32_u24 v10, 911, v10
    v_lshrrev_b32_e64 v24, 16, v10
    v_mul_u32_u24 v10, 72576, v24
    v_lshl_add_u32 v6, v1, 4, v10
    s_lshl_b32 s13, s3, 8
    s_add_u32 s13, s13, s8
    s_mul_i32 s13, s13, 1152
    s_mul_i32 s14, s3, 4608
    v_and_b32 v7, 15, v1
    v_lshrrev_b32 v8, 4, v1
    s_waitcnt lgkmcnt(0)
    s_mov_b32 s40, s24
    s_and_b32 s41, s25, 0xffff
    s_mov_b32 s42, 2359296
    s_mov_b32 s43, 0x20000
    s_mov_b32 m0, s14
    s_nop 0
    buffer_load_dwordx4 v2, s[40:43], s13 offen offset:0 lds
    buffer_load_dwordx4 v3, s[40:43], s13 offen offset:1024 lds
    buffer_load_dwordx4 v4, s[40:43], s13 offen offset:2048 lds
    buffer_load_dwordx4 v5, s[40:43], s13 offen offset:3072 lds
    s_add_u32 m0, s14, 4096
    s_add_u32 s15, s13, 4096
    s_mov_b32 exec_hi, 0
    buffer_load_dwordx4 v6, s[40:43], s15 offen lds
    s_mov_b32 exec_hi, -1
    s_load_dword s76, s[38:39], 0
    s_mov_b32 s48, s38
    s_and_b32 s49, s39, 0xffff
    s_mov_b32 s50, 10428416
    s_mov_b32 s51, 0x20000
    s_mov_b32 s56, s34
    s_and_b32 s57, s35, 0xffff
    s_mov_b32 s58, 4718592
    s_mov_b32 s59, 0x20000
    s_mov_b32 s52, s22
    s_and_b32 s53, s23, 0xffff
    s_mov_b32 s54, 663552
    s_mov_b32 s55, 0x20000
    s_cmp_eq_u32 s3, 7
    s_cselect_b32 s11, s8, 64
    s_cmp_lt_u32 s11, 54
    s_cbranch_scc0 L_B_nw
    s_mul_i32 s60, s11, 86
    s_lshr_b32 s60, s60, 8
    s_mul_i32 s61, s60, 3
    s_sub_u32 s61, s11, s61
    s_cmp_ge_u32 s60, 9
    s_cselect_b32 s62, 1, 0
    s_cselect_b32 s63, 9, 0
    s_sub_u32 s63, s60, s63
    v_add_u32_e64 v10, 0, v1
    v_mul_u32_u24 v11, 2731, v10
    v_lshrrev_b32 v11, 16, v11
    v_mul_u32_u24 v12, 24, v11
    v_sub_u32 v10, v10, v12
    v_and_b32 v12, 6, v11
    v_xor_b32 v10, v10, v12
    v_and_b32 v12, 4, v11
    v_lshl_add_u32 v12, v12, 3, v11
    v_mul_u32_u24 v12, 1152, v12
    v_lshl_add_u32 v36, v10, 4, v12
    v_and_b32 v11, 2, v11
    v_xor_b32 v11, 2, v11
    v_mul_u32_u24 v11, 4608, v11
    v_add_u32 v39, v11, v36
    v_add_u32 v10, 64, v1
    v_mul_u32_u24 v11, 2731, v10
    v_lshrrev_b32 v11, 16, v11
    v_mul_u32_u24 v12, 24, v11
    v_sub_u32 v10, v10, v12
    v_and_b32 v12, 6, v11
    v_xor_b32 v10, v10, v12
    v_and_b32 v12, 4, v11
    v_lshl_add_u32 v12, v12, 3, v11
    v_mul_u32_u24 v12, 1152, v12
    v_lshl_add_u32 v37, v10, 4, v12
    v_and_b32 v11, 2, v11
    v_xor_b32 v11, 2, v11
    v_mul_u32_u24 v11, 4608, v11
    v_add_u32_e64 v40, v11, v37
    v_add_u32 v10, 128, v1
    v_mul_u32_u24 v11, 2731, v10
    v_lshrrev_b32 v11, 16, v11
    v_mul_u32_u24 v12, 24, v11
    v_sub_u32 v10, v10, v12
    v_and_b32 v12, 6, v11
    v_xor_b32 v10, v10, v12
    v_and_b32 v12, 4, v11
    v_lshl_add_u32 v12, v12, 3, v11
    v_mul_u32_u24 v12, 1152, v12
    v_lshl_add_u32 v38, v10, 4, v12
    v_and_b32 v11, 2, v11
    v_xor_b32 v11, 2, v11
    v_mul_u32_u24 v11, 4608, v11
    v_add_u32 v41, v11, v38
    s_lshr_b32 s78, s63, 1
    s_mul_i32 s64, s78, 72
    s_and_b32 s78, s63, 1
    s_lshl_b32 s79, s78, 4
    s_add_u32 s64, s64, s79
    s_add_u32 s66, s64, 8
    s_add_u32 s67, s64, 12
    s_lshl_b32 s79, s78, 1
    s_add_u32 s64, s64, s79
    s_mul_i32 s79, s78, -8
    s_add_u32 s65, s64, 4
    s_add_u32 s65, s65, s79
    s_cmp_eq_u32 s63, 8
    s_cselect_b32 s64, 32, s64
    s_cselect_b32 s65, 176, s65
    s_cselect_b32 s66, 104, s66
    s_cselect_b32 s67, 248, s67
    s_mul_i32 s79, s62, 331776
    s_mul_i32 s68, s61, 384
    s_add_u32 s79, s79, s68
    s_cmp_eq_u32 s78, 1
    s_cselect_b64 vcc, -1, 0
    v_cndmask_b32 v39, v36, v39, vcc
    v_cndmask_b32 v40, v37, v40, vcc
    v_cndmask_b32 v41, v38, v41, vcc
    s_mul_i32 s64, s64, 1152
    s_add_u32 s64, s64, s79
    s_mov_b32 m0, 74240
    s_nop 0
    buffer_load_dwordx4 v36, s[52:55], s64 offen lds
    s_mov_b32 m0, 75264
    s_nop 0
    buffer_load_dwordx4 v37, s[52:55], s64 offen lds
    s_mov_b32 m0, 76288
    s_nop 0
    buffer_load_dwordx4 v38, s[52:55], s64 offen lds
    s_mul_i32 s65, s65, 1152
    s_add_u32 s65, s65, s79
    s_mov_b32 m0, 77312
    s_nop 0
    buffer_load_dwordx4 v39, s[52:55], s65 offen lds
    s_mov_b32 m0, 78336
    s_nop 0
    buffer_load_dwordx4 v40, s[52:55], s65 offen lds
    s_mov_b32 m0, 79360
    s_nop 0
    buffer_load_dwordx4 v41, s[52:55], s65 offen lds
    s_mul_i32 s66, s66, 1152
    s_add_u32 s66, s66, s79
    s_mov_b32 m0, 80384
    s_nop 0
    buffer_load_dwordx4 v36, s[52:55], s66 offen lds
    s_mov_b32 m0, 81408
    s_nop 0
    buffer_load_dwordx4 v37, s[52:55], s66 offen lds
    s_mov_b32 m0, 82432
    s_nop 0
    buffer_load_dwordx4 v38, s[52:55], s66 offen lds
    s_mul_i32 s67, s67, 1152
    s_add_u32 s67, s67, s79
    s_mov_b32 m0, 83456
    s_nop 0
    buffer_load_dwordx4 v36, s[52:55], s67 offen lds
    s_mov_b32 m0, 84480
    s_nop 0
    buffer_load_dwordx4 v37, s[52:55], s67 offen lds
    s_mov_b32 m0, 85504
    s_nop 0
    buffer_load_dwordx4 v38, s[52:55], s67 offen lds
L_B_nw:
    s_cmp_ge_u32 s12, 3
    s_cselect_b32 s78, 1, 0
    s_cselect_b32 s79, 3, 0
    s_lshl_b32 s9, s4, 1
    s_add_u32 s9, s9, s78
    s_sub_u32 s10, s12, s79
    s_cmp_ge_u32 s12, 6
    s_cselect_b32 s9, 16, s9
    s_cselect_b32 s10, s4, s10
    s_cmp_eq_u32 s12, 7
    s_cselect_b32 s10, 7, s10
    s_and_b32 s78, s3, 3
    s_lshl_b32 s78, s78, 9
    s_add_u32 s78, s78, s9
    s_sub_u32 s79, 2048, s78
    s_mov_b32 s16, 73728
    s_mov_b32 s17, -73728
    s_cmp_ge_u32 s3, 4
    s_cselect_b32 s78, s79, s78
    s_cselect_b32 s16, s17, s16
    s_mul_i32 s78, s78, 2304
    s_mul_i32 s79, s10, 192
    s_add_u32 s17, s78, s79
    s_add_u32 s17, s17, 1152
    s_sub_u32 s18, s78, s79
    s_add_u32 s18, s18, 1920
    s_mul_i32 s19, s3, 6912
    s_lshl_b32 s79, s16, 3
    v_mov_b32 v14, s17
    v_mov_b32 v15, s18
    v_add_u32_e64 v10, 0, v1
    v_mul_u32_u24 v11, 2731, v10
    v_lshrrev_b32 v11, 16, v11
    v_mul_u32_u24 v12, 24, v11
    v_sub_u32 v10, v10, v12
    v_cmp_lt_u32 vcc, 11, v10
    s_nop 1
    v_cndmask_b32 v12, v14, v15, vcc
    v_cndmask_b32 v13, 0, 32, vcc
    v_lshl_add_u32 v12, v10, 4, v12
    v_mad_i32_i24 v240, v11, s16, v12
    v_add_u32_e64 v243, s79, v240
    v_mul_u32_u24 v11, 432, v11
    v_lshl_add_u32 v11, v10, 4, v11
    v_add3_u32 v246, v11, v13, s19
    v_add_u32_e64 v10, 64, v1
    v_mul_u32_u24 v11, 2731, v10
    v_lshrrev_b32 v11, 16, v11
    v_mul_u32_u24 v12, 24, v11
    v_sub_u32 v10, v10, v12
    v_cmp_lt_u32 vcc, 11, v10
    s_nop 1
    v_cndmask_b32 v12, v14, v15, vcc
    v_cndmask_b32 v13, 0, 32, vcc
    v_lshl_add_u32 v12, v10, 4, v12
    v_mad_i32_i24 v241, v11, s16, v12
    v_add_u32_e64 v244, s79, v241
    v_mul_u32_u24 v11, 432, v11
    v_lshl_add_u32 v11, v10, 4, v11
    v_add3_u32 v247, v11, v13, s19
    v_add_u32 v10, 128, v1
    v_mul_u32_u24 v11, 2731, v10
    v_lshrrev_b32 v11, 16, v11
    v_mul_u32_u24 v12, 24, v11
    v_sub_u32 v10, v10, v12
    v_cmp_lt_u32 vcc, 11, v10
    s_nop 1
    v_cndmask_b32 v12, v14, v15, vcc
    v_cndmask_b32 v13, 0, 32, vcc
    v_lshl_add_u32 v12, v10, 4, v12
    v_mad_i32_i24 v242, v11, s16, v12
    v_add_u32_e64 v245, s79, v242
    v_mul_u32_u24 v11, 432, v11
    v_lshl_add_u32 v11, v10, 4, v11
    v_add3_u32 v248, v11, v13, s19
    s_lshl_b32 s78, s3, 5
    v_lshl_add_u32 v10, v8, 3, s78
    v_mul_u32_u24 v11, 432, v7
    v_add_u32 v249, v11, v10
    v_sub_u32_e64 v250, v11, v10
    v_add_u32 v250, 410, v250
    v_lshrrev_b32 v10, 1, v7
    v_xor_b32 v10, v10, v8
    v_lshlrev_b32_e64 v10, 4, v10
    v_lshl_add_u32 v251, v7, 7, v10
    v_xor_b32 v252, 64, v251
    v_and_b32 v10, 7, v1
    v_xor_b32 v10, v10, v8
    v_lshlrev_b32 v45, 4, v10
    v_lshrrev_b32 v10, 3, v1
    v_and_b32 v11, 3, v10
    v_lshrrev_b32_e64 v10, 2, v10
    v_lshl_add_u32 v10, v10, 3, v11
    v_mul_u32_u24 v10, 1152, v10
    v_add_u32 v18, v10, v45
    v_xor_b32 v19, 64, v18
    v_add_u32 v19, 17408, v19
    v_lshlrev_b32 v10, 3, v8
    v_cvt_f32_u32 v9, v10
    v_cvt_f32_u32 v10, v7
    v_mul_f32 v10, 0x3d000000, v10
    v_mul_f32 v11, v10, v9
    v_fmamk_f32 v48, v10, 0x00000000, v11
    v_fmamk_f32 v49, v10, 0x3f800000, v11
    v_fmamk_f32 v50, v10, 0x40000000, v11
    v_fmamk_f32 v51, v10, 0x40400000, v11
    v_fmamk_f32 v52, v10, 0x40800000, v11
    v_fmamk_f32 v53, v10, 0x40a00000, v11
    v_fmamk_f32 v54, v10, 0x40c00000, v11
    v_fmamk_f32 v55, v10, 0x40e00000, v11
    v_cos_f32 v56, v48
    v_sin_f32 v48, v48
    v_cos_f32 v57, v49
    v_sin_f32 v49, v49
    v_cos_f32 v58, v50
    v_sin_f32 v50, v50
    v_cos_f32 v59, v51
    v_sin_f32 v51, v51
    v_cos_f32 v60, v52
    v_sin_f32 v52, v52
    v_cos_f32 v61, v53
    v_sin_f32 v53, v53
    v_cos_f32 v62, v54
    v_sin_f32 v54, v54
    v_cos_f32 v63, v55
    v_sin_f32 v55, v55
    v_cvt_pk_bf16_f32 v28, v56, v57
    v_cvt_pk_bf16_f32 v32, -v48, -v49
    v_cvt_pk_bf16_f32 v29, v58, v59
    v_cvt_pk_bf16_f32 v33, -v50, -v51
    v_cvt_pk_bf16_f32 v30, v60, v61
    v_cvt_pk_bf16_f32 v34, -v52, -v53
    v_cvt_pk_bf16_f32 v31, v62, v63
    v_cvt_pk_bf16_f32 v35, -v54, -v55
    v_cmp_eq_u32 vcc, 0, v7
    v_mov_b32 v10, 0xbf803f80
    s_nop 0
    v_cndmask_b32 v32, v32, v10, vcc
    v_cndmask_b32 v33, v33, v10, vcc
    v_cndmask_b32 v34, v34, v10, vcc
    v_cndmask_b32 v35, v35, v10, vcc
    s_lshr_b32 s78, s3, 1
    s_lshl_b32 s78, s78, 9
    s_add_u32 s78, s78, s9
    v_lshl_add_u32 v10, v7, 5, s78
    v_cvt_f32_u32 v10, v10
    v_mul_f32 v10, 0x3a000000, v10
    s_and_b32 s78, s3, 1
    s_lshl_b32 s78, s78, 5
    v_cvt_f32_u32 v11, s78
    v_add_f32 v11, v11, v9
    v_mul_f32_e64 v11, v11, v10
    v_fmamk_f32 v48, v10, 0x00000000, v11
    v_fmamk_f32 v49, v10, 0x3f800000, v11
    v_fmamk_f32 v50, v10, 0x40000000, v11
    v_fmamk_f32 v51, v10, 0x40400000, v11
    v_fmamk_f32 v52, v10, 0x40800000, v11
    v_fmamk_f32 v53, v10, 0x40a00000, v11
    v_fmamk_f32 v54, v10, 0x40c00000, v11
    v_fmamk_f32 v55, v10, 0x40e00000, v11
    v_cos_f32 v56, v48
    v_sin_f32 v48, v48
    v_cos_f32 v57, v49
    v_sin_f32 v49, v49
    v_cos_f32 v58, v50
    v_sin_f32 v50, v50
    v_cos_f32 v59, v51
    v_sin_f32 v51, v51
    v_cos_f32 v60, v52
    v_sin_f32 v52, v52
    v_cos_f32 v61, v53
    v_sin_f32 v53, v53
    v_cos_f32 v62, v54
    v_sin_f32 v54, v54
    v_cos_f32 v63, v55
    v_sin_f32 v55, v55
    v_cvt_pk_bf16_f32 v64, v56, v57
    v_cvt_pk_bf16_f32 v68, -v48, -v49
    v_cvt_pk_bf16_f32 v65, v58, v59
    v_cvt_pk_bf16_f32 v69, -v50, -v51
    v_cvt_pk_bf16_f32 v66, v60, v61
    v_cvt_pk_bf16_f32 v70, -v52, -v53
    v_cvt_pk_bf16_f32 v67, v62, v63
    v_cvt_pk_bf16_f32 v71, -v54, -v55
    s_lshl_b32 s78, s3, 10
    s_add_u32 s78, s78, 147456
    v_lshl_add_u32 v10, v1, 4, s78
    ds_write_b128 v10, v[64:67]
    ds_write_b128 v10, v[68:71] offset:8192
    v_lshlrev_b32 v253, 4, v1
    v_add_u32 v253, 147456, v253
    s_mul_i32 s78, s10, 96
    s_lshl_b32 s79, s3, 4
    s_add_u32 s78, s78, s79
    v_add_u32 v10, s78, v7
    v_cvt_f32_u32 v10, v10
    v_mul_f32 v46, 0x3ae38e39, v10
    v_mul_f32 v47, v46, v9
    s_cmp_ge_u32 s10, 3
    s_cbranch_scc1 L_B_nt
    s_cmp_eq_u32 s3, 7
    s_cbranch_scc1 L_B_nt
    v_fmamk_f32 v48, v46, 0x00000000, v47
    s_nop 0
    v_fmamk_f32 v49, v46, 0x3f800000, v47
    v_fmamk_f32 v50, v46, 0x40000000, v47
    v_fmamk_f32 v51, v46, 0x40400000, v47
    v_fmamk_f32 v52, v46, 0x40800000, v47
    v_fmamk_f32 v53, v46, 0x40a00000, v47
    v_fmamk_f32 v54, v46, 0x40c00000, v47
    v_fmamk_f32 v55, v46, 0x40e00000, v47
    v_cos_f32 v56, v48
    v_sin_f32 v48, v48
    v_cos_f32 v57, v49
    v_sin_f32 v49, v49
    v_cos_f32 v58, v50
    v_sin_f32 v50, v50
    v_cos_f32 v59, v51
    v_sin_f32 v51, v51
    v_cos_f32 v60, v52
    v_sin_f32 v52, v52
    v_cos_f32 v61, v53
    v_sin_f32 v53, v53
    v_cos_f32 v62, v54
    v_sin_f32 v54, v54
    v_cos_f32 v63, v55
    v_sin_f32 v55, v55
    v_cvt_pk_bf16_f32 v72, v56, v57
    v_cvt_pk_bf16_f32 v108, -v48, -v49
    v_cvt_pk_bf16_f32 v73, v58, v59
    v_cvt_pk_bf16_f32 v109, -v50, -v51
    v_cvt_pk_bf16_f32 v74, v60, v61
    v_cvt_pk_bf16_f32 v110, -v52, -v53
    v_cvt_pk_bf16_f32 v75, v62, v63
    v_cvt_pk_bf16_f32 v111, -v54, -v55
    v_fmamk_f32 v48, v46, 0x42000000, v47
    v_fmamk_f32 v49, v46, 0x42040000, v47
    v_fmamk_f32 v50, v46, 0x42080000, v47
    v_fmamk_f32 v51, v46, 0x420c0000, v47
    v_fmamk_f32 v52, v46, 0x42100000, v47
    v_fmamk_f32 v53, v46, 0x42140000, v47
    v_fmamk_f32 v54, v46, 0x42180000, v47
    v_fmamk_f32 v55, v46, 0x421c0000, v47
    v_cos_f32 v56, v48
    v_sin_f32 v48, v48
    v_cos_f32 v57, v49
    v_sin_f32 v49, v49
    v_cos_f32 v58, v50
    v_sin_f32 v50, v50
    v_cos_f32 v59, v51
    v_sin_f32 v51, v51
    v_cos_f32 v60, v52
    v_sin_f32 v52, v52
    v_cos_f32 v61, v53
    v_sin_f32 v53, v53
    v_cos_f32 v62, v54
    v_sin_f32 v54, v54
    v_cos_f32 v63, v55
    v_sin_f32 v55, v55
    v_cvt_pk_bf16_f32 v76, v56, v57
    v_cvt_pk_bf16_f32 v112, -v48, -v49
    v_cvt_pk_bf16_f32 v77, v58, v59
    v_cvt_pk_bf16_f32 v113, -v50, -v51
    v_cvt_pk_bf16_f32 v78, v60, v61
    v_cvt_pk_bf16_f32 v114, -v52, -v53
    v_cvt_pk_bf16_f32 v79, v62, v63
    v_cvt_pk_bf16_f32 v115, -v54, -v55
    v_fmamk_f32 v48, v46, 0x42800000, v47
    v_fmamk_f32 v49, v46, 0x42820000, v47
    v_fmamk_f32 v50, v46, 0x42840000, v47
    v_fmamk_f32 v51, v46, 0x42860000, v47
    v_fmamk_f32 v52, v46, 0x42880000, v47
    v_fmamk_f32 v53, v46, 0x428a0000, v47
    v_fmamk_f32 v54, v46, 0x428c0000, v47
    v_fmamk_f32 v55, v46, 0x428e0000, v47
    v_cos_f32 v56, v48
    v_sin_f32 v48, v48
    v_cos_f32 v57, v49
    v_sin_f32 v49, v49
    v_cos_f32 v58, v50
    v_sin_f32 v50, v50
    v_cos_f32 v59, v51
    v_sin_f32 v51, v51
    v_cos_f32 v60, v52
    v_sin_f32 v52, v52
    v_cos_f32 v61, v53
    v_sin_f32 v53, v53
    v_cos_f32 v62, v54
    v_sin_f32 v54, v54
    v_cos_f32 v63, v55
    v_sin_f32 v55, v55
    v_cvt_pk_bf16_f32 v80, v56, v57
    v_cvt_pk_bf16_f32 v116, -v48, -v49
    v_cvt_pk_bf16_f32 v81, v58, v59
    v_cvt_pk_bf16_f32 v117, -v50, -v51
    v_cvt_pk_bf16_f32 v82, v60, v61
    v_cvt_pk_bf16_f32 v118, -v52, -v53
    v_cvt_pk_bf16_f32 v83, v62, v63
    v_cvt_pk_bf16_f32 v119, -v54, -v55
    v_fmamk_f32 v48, v46, 0x42c00000, v47
    v_fmamk_f32 v49, v46, 0x42c20000, v47
    v_fmamk_f32 v50, v46, 0x42c40000, v47
    v_fmamk_f32 v51, v46, 0x42c60000, v47
    v_fmamk_f32 v52, v46, 0x42c80000, v47
    v_fmamk_f32 v53, v46, 0x42ca0000, v47
    v_fmamk_f32 v54, v46, 0x42cc0000, v47
    v_fmamk_f32 v55, v46, 0x42ce0000, v47
    v_cos_f32 v56, v48
    v_sin_f32 v48, v48
    v_cos_f32 v57, v49
    v_sin_f32 v49, v49
    v_cos_f32 v58, v50
    v_sin_f32 v50, v50
    v_cos_f32 v59, v51
    v_sin_f32 v51, v51
    v_cos_f32 v60, v52
    v_sin_f32 v52, v52
    v_cos_f32 v61, v53
    v_sin_f32 v53, v53
    v_cos_f32 v62, v54
    v_sin_f32 v54, v54
    v_cos_f32 v63, v55
    v_sin_f32 v55, v55
    v_cvt_pk_bf16_f32 v84, v56, v57
    v_cvt_pk_bf16_f32 v120, -v48, -v49
    v_cvt_pk_bf16_f32 v85, v58, v59
    v_cvt_pk_bf16_f32 v121, -v50, -v51
    v_cvt_pk_bf16_f32 v86, v60, v61
    v_cvt_pk_bf16_f32 v122, -v52, -v53
    v_cvt_pk_bf16_f32 v87, v62, v63
    v_cvt_pk_bf16_f32 v123, -v54, -v55
L_B_nt:
    s_cmp_ge_u32 s3, 6
    s_cbranch_scc1 L_B_ld
    v_bfe_u32 v10, v1, 2, 2
    v_lshl_add_u32 v10, v8, 3, v10
    v_mul_u32_u24 v10, 1152, v10
    v_and_b32 v11, 3, v1
    s_lshl_b32 s78, s3, 2
    v_add_u32 v11, s78, v11
    v_mul_u32_u24 v15, 24, v11
    v_add_u32 v12, v10, v15
    v_sub_u32 v13, v10, v15
    v_add_u32 v13, 1128, v13
    v_add_u32_e64 v14, 24, v13
    v_add_u32 v10, 576, v10
    v_cmp_eq_u32 vcc, 0, v11
    s_nop 1
    v_cndmask_b32 v14, v14, v10, vcc
    v_add_u32 v11, s78, v8
    v_mul_u32_u24_e64 v10, 24, v11
    v_mul_u32_u24 v16, 1168, v7
    v_add_u32_e64 v16, v16, v10
    v_cmp_eq_u32 s[78:79], 0, v11
    s_waitcnt vmcnt(0) lgkmcnt(0)
    s_barrier
    ds_read_b64_tr_b16 v[200:201], v12 offset:0
    ds_read_b64_tr_b16 v[202:203], v12 offset:4608
    ds_read_b64_tr_b16 v[204:205], v12 offset:8
    ds_read_b64_tr_b16 v[206:207], v12 offset:4616
    ds_read_b64_tr_b16 v[208:209], v12 offset:16
    ds_read_b64_tr_b16 v[210:211], v12 offset:4624
    ds_read_b64_tr_b16 v[212:213], v13 offset:0
    ds_read_b64_tr_b16 v[214:215], v13 offset:4608
    ds_read_b64_tr_b16 v[216:217], v13 offset:8
    ds_read_b64_tr_b16 v[218:219], v13 offset:4616
    ds_read_b64_tr_b16 v[220:221], v13 offset:16
    ds_read_b64_tr_b16 v[222:223], v13 offset:4624
    ds_read_b64_tr_b16 v[224:225], v14 offset:0
    ds_read_b64_tr_b16 v[226:227], v14 offset:4608
    s_waitcnt lgkmcnt(12)
    v_mfma_f32_16x16x32_bf16 v[144:147], v[200:203], v[28:31], 0
    s_waitcnt lgkmcnt(10)
    v_mfma_f32_16x16x32_bf16 v[148:151], v[204:207], v[28:31], 0
    s_waitcnt lgkmcnt(8)
    v_mfma_f32_16x16x32_bf16 v[152:155], v[208:211], v[28:31], 0
    s_waitcnt lgkmcnt(6)
    v_mfma_f32_16x16x32_bf16 v[156:159], v[212:215], v[28:31], 0
    s_waitcnt lgkmcnt(4)
    v_mfma_f32_16x16x32_bf16 v[160:163], v[216:219], v[28:31], 0
    s_waitcnt lgkmcnt(2)
    v_mfma_f32_16x16x32_bf16 v[164:167], v[220:223], v[28:31], 0
    s_waitcnt lgkmcnt(0)
    v_mfma_f32_16x16x32_bf16 v[168:171], v[224:227], v[28:31], 0
    v_mfma_f32_16x16x32_bf16 v[172:175], v[200:203], v[32:35], 0
    v_mfma_f32_16x16x32_bf16 v[176:179], v[204:207], v[32:35], 0
    v_mfma_f32_16x16x32_bf16 v[180:183], v[208:211], v[32:35], 0
    v_mfma_f32_16x16x32_bf16 v[184:187], v[212:215], v[32:35], 0
    v_mfma_f32_16x16x32_bf16 v[188:191], v[216:219], v[32:35], 0
    v_mfma_f32_16x16x32_bf16 v[192:195], v[220:223], v[32:35], 0
    v_mfma_f32_16x16x32_bf16 v[196:199], v[224:227], v[32:35], 0
    v_add_f32 v59, v155, v157
    v_sub_f32 v71, v155, v157
    v_add_f32 v58, v154, v158
    v_sub_f32 v70, v154, v158
    v_add_f32 v57, v153, v159
    v_sub_f32 v69, v153, v159
    v_add_f32 v56, v152, v160
    v_sub_f32 v68, v152, v160
    v_add_f32 v55, v151, v161
    v_sub_f32 v67, v151, v161
    v_add_f32 v54, v150, v162
    v_sub_f32 v66, v150, v162
    v_add_f32 v53, v149, v163
    v_sub_f32 v65, v149, v163
    v_add_f32 v52, v148, v164
    v_sub_f32 v64, v148, v164
    v_add_f32 v51, v147, v165
    v_sub_f32 v63, v147, v165
    v_add_f32 v50, v146, v166
    v_sub_f32 v62, v146, v166
    v_add_f32 v49, v145, v167
    v_sub_f32 v61, v145, v167
    v_add_f32 v48, v144, v168
    v_sub_f32_e64 v60, v144, v168
    v_cndmask_b32 v48, v48, v144, s[78:79]
    v_cndmask_b32 v60, v60, v168, s[78:79]
    v_cvt_pk_bf16_f32 v210, v68, v69
    v_cvt_pk_bf16_f32 v211, v70, v71
    ds_write_b64 v16, v[210:211] offset:37456
    v_cvt_pk_bf16_f32 v208, v64, v65
    v_cvt_pk_bf16_f32 v209, v66, v67
    ds_write_b64 v16, v[208:209] offset:37448
    v_cvt_pk_bf16_f32 v204, v56, v57
    v_cvt_pk_bf16_f32 v205, v58, v59
    ds_write_b64 v16, v[204:205] offset:36880
    v_cvt_pk_bf16_f32 v202, v52, v53
    v_cvt_pk_bf16_f32 v203, v54, v55
    ds_write_b64 v16, v[202:203] offset:36872
    v_cvt_pk_bf16_f32 v206, v60, v61
    v_cvt_pk_bf16_f32 v207, v62, v63
    ds_write_b64 v16, v[206:207] offset:37440
    v_cvt_pk_bf16_f32 v200, v48, v49
    v_cvt_pk_bf16_f32 v201, v50, v51
    ds_write_b64 v16, v[200:201] offset:36864
    v_add_f32 v59, v183, v185
    v_sub_f32 v71, v183, v185
    v_add_f32 v58, v182, v186
    v_sub_f32 v70, v182, v186
    v_add_f32 v57, v181, v187
    v_sub_f32 v69, v181, v187
    v_add_f32 v56, v180, v188
    v_sub_f32 v68, v180, v188
    v_add_f32 v55, v179, v189
    v_sub_f32 v67, v179, v189
    v_add_f32 v54, v178, v190
    v_sub_f32 v66, v178, v190
    v_add_f32 v53, v177, v191
    v_sub_f32 v65, v177, v191
    v_add_f32 v52, v176, v192
    v_sub_f32 v64, v176, v192
    v_add_f32 v51, v175, v193
    v_sub_f32 v63, v175, v193
    v_add_f32 v50, v174, v194
    v_sub_f32 v62, v174, v194
    v_add_f32 v49, v173, v195
    v_sub_f32 v61, v173, v195
    v_add_f32 v48, v172, v196
    v_sub_f32 v60, v172, v196
    v_cndmask_b32 v48, v48, v172, s[78:79]
    v_cndmask_b32 v60, v60, v196, s[78:79]
    v_cvt_pk_bf16_f32 v222, v68, v69
    v_cvt_pk_bf16_f32 v223, v70, v71
    ds_write_b64 v16, v[222:223] offset:56144
    v_cvt_pk_bf16_f32 v220, v64, v65
    v_cvt_pk_bf16_f32 v221, v66, v67
    ds_write_b64 v16, v[220:221] offset:56136
    v_cvt_pk_bf16_f32 v216, v56, v57
    v_cvt_pk_bf16_f32 v217, v58, v59
    ds_write_b64 v16, v[216:217] offset:55568
    v_cvt_pk_bf16_f32 v214, v52, v53
    v_cvt_pk_bf16_f32 v215, v54, v55
    ds_write_b64 v16, v[214:215] offset:55560
    v_cvt_pk_bf16_f32 v218, v60, v61
    v_cvt_pk_bf16_f32 v219, v62, v63
    ds_write_b64 v16, v[218:219] offset:56128
    v_cvt_pk_bf16_f32 v212, v48, v49
    v_cvt_pk_bf16_f32 v213, v50, v51
    ds_write_b64 v16, v[212:213] offset:55552
    s_branch L_B_co
L_B_ld:
    s_cmp_lt_u32 s11, 54
    s_cbranch_scc1 L_B_tr
    s_waitcnt vmcnt(0) lgkmcnt(0)
    s_barrier
    s_branch L_B_co
L_B_tr:
    v_bfe_u32 v10, v1, 2, 3
    v_lshrrev_b32_e64 v11, 5, v1
    v_lshl_add_u32 v11, v11, 4, v10
    v_mul_u32_u24 v11, 384, v11
    v_and_b32_e64 v12, 3, v1
    v_lshl_add_u32 v11, v12, 3, v11
    v_add_u32 v11, 74240, v11
    v_lshrrev_b32 v10, 1, v10
    v_xor_b32 v12, 0, v10
    v_lshl_add_u32 v40, v12, 5, v11
    v_xor_b32_e64 v12, 1, v10
    v_lshl_add_u32 v41, v12, 5, v11
    v_xor_b32_e64 v12, 2, v10
    v_lshl_add_u32 v42, v12, 5, v11
    v_xor_b32_e64 v12, 3, v10
    v_lshl_add_u32 v43, v12, 5, v11
    s_lshl_b32 s64, s61, 1
    s_add_u32 s64, s64, s62
    s_mul_i32 s64, s64, 110592
    s_mul_i32 s78, s63, 3072
    s_add_u32 s64, s64, s78
    s_add_u32 s64, s64, 9764864
    v_lshlrev_b32 v10, 4, v1
    s_waitcnt vmcnt(12) lgkmcnt(0)
    s_barrier
    s_waitcnt vmcnt(0)
    ds_read_b64_tr_b16 v[80:81], v40 offset:0
    ds_read_b64_tr_b16 v[82:83], v40 offset:3072
    ds_read_b64_tr_b16 v[84:85], v40 offset:128
    s_nop 0
    ds_read_b64_tr_b16 v[86:87], v40 offset:3200
    ds_read_b64_tr_b16 v[88:89], v40 offset:256
    ds_read_b64_tr_b16 v[90:91], v40 offset:3328
    ds_read_b64_tr_b16 v[92:93], v41 offset:0
    ds_read_b64_tr_b16 v[94:95], v41 offset:3072
    ds_read_b64_tr_b16 v[96:97], v41 offset:128
    ds_read_b64_tr_b16 v[98:99], v41 offset:3200
    ds_read_b64_tr_b16 v[100:101], v41 offset:256
    ds_read_b64_tr_b16 v[102:103], v41 offset:3328
    ds_read_b64_tr_b16 v[104:105], v42 offset:0
    ds_read_b64_tr_b16 v[106:107], v42 offset:3072
    ds_read_b64_tr_b16 v[108:109], v42 offset:128
    ds_read_b64_tr_b16 v[110:111], v42 offset:3200
    ds_read_b64_tr_b16 v[112:113], v42 offset:256
    ds_read_b64_tr_b16 v[114:115], v42 offset:3328
    ds_read_b64_tr_b16 v[116:117], v43 offset:0
    ds_read_b64_tr_b16 v[118:119], v43 offset:3072
    ds_read_b64_tr_b16 v[120:121], v43 offset:128
    ds_read_b64_tr_b16 v[122:123], v43 offset:3200
    ds_read_b64_tr_b16 v[124:125], v43 offset:256
    ds_read_b64_tr_b16 v[126:127], v43 offset:3328
    s_waitcnt lgkmcnt(15)
    buffer_store_dwordx4 v[80:83], v10, s[48:51], s64 offen offset:0 sc1
    buffer_store_dwordx4 v[84:87], v10, s[48:51], s64 offen offset:1024 sc1
    buffer_store_dwordx4 v[88:91], v10, s[48:51], s64 offen offset:2048 sc1
    s_add_u32 s64, s64, 27648
    s_waitcnt lgkmcnt(12)
    buffer_store_dwordx4 v[92:95], v10, s[48:51], s64 offen offset:0 sc1
    buffer_store_dwordx4 v[96:99], v10, s[48:51], s64 offen offset:1024 sc1
    buffer_store_dwordx4 v[100:103], v10, s[48:51], s64 offen offset:2048 sc1
    s_add_u32 s64, s64, 27648
    s_waitcnt lgkmcnt(6)
    buffer_store_dwordx4 v[104:107], v10, s[48:51], s64 offen offset:0 sc1
    buffer_store_dwordx4 v[108:111], v10, s[48:51], s64 offen offset:1024 sc1
    buffer_store_dwordx4 v[112:115], v10, s[48:51], s64 offen offset:2048 sc1
    s_add_u32 s64, s64, 27648
    s_waitcnt lgkmcnt(0)
    buffer_store_dwordx4 v[116:119], v10, s[48:51], s64 offen offset:0 sc1
    buffer_store_dwordx4 v[120:123], v10, s[48:51], s64 offen offset:1024 sc1
    buffer_store_dwordx4 v[124:127], v10, s[48:51], s64 offen offset:2048 sc1
L_B_co:
    s_mul_i32 s76, s76, 0x9e3779b1
    s_add_u32 s76, s76, 0x7f4a7c15
    s_mul_i32 s78, s3, 4672
    s_add_u32 s78, s78, 36864
    v_add_u32_e64 v10, v1, v20
    v_lshl_add_u32 v20, v10, 4, s78
    v_add_u32_e64 v10, v1, v21
    v_lshl_add_u32 v21, v10, 4, s78
    v_add_u32_e64 v10, v1, v22
    v_lshl_add_u32 v22, v10, 4, s78
    v_add_u32_e64 v10, v1, v23
    v_lshl_add_u32 v23, v10, 4, s78
    v_add_u32_e64 v10, v1, v24
    v_lshl_add_u32 v24, v10, 4, s78
    s_add_u32 s13, s13, 7405568
    s_add_u32 s14, s13, 4096
    s_waitcnt lgkmcnt(0)
    s_barrier
    ds_read_b128 v[48:51], v20 offset:0
    ds_read_b128 v[52:55], v21 offset:1024
    ds_read_b128 v[56:59], v22 offset:2048
    ds_read_b128 v[60:63], v23 offset:3072
    ds_read_b128 v[64:67], v24 offset:4096
    s_waitcnt lgkmcnt(4)
    buffer_store_dwordx4 v[48:51], v2, s[48:51], s13 offen offset:0 sc1
    s_waitcnt lgkmcnt(3)
    buffer_store_dwordx4 v[52:55], v3, s[48:51], s13 offen offset:1024 sc1
    s_waitcnt lgkmcnt(2)
    buffer_store_dwordx4 v[56:59], v4, s[48:51], s13 offen offset:2048 sc1
    s_waitcnt lgkmcnt(1)
    buffer_store_dwordx4 v[60:63], v5, s[48:51], s13 offen offset:3072 sc1
    s_waitcnt lgkmcnt(0)
    s_mov_b32 exec_hi, 0
    buffer_store_dwordx4 v[64:67], v6, s[48:51], s14 offen sc1
    s_mov_b32 exec_hi, -1
    s_cmp_ge_u32 s10, 3
    s_cbranch_scc1 L_B_idle
    s_waitcnt vmcnt(0)
    s_barrier
    s_cmp_eq_u32 s3, 7
    s_cbranch_scc1 L_B_w7
    s_nop 0
    v_fmamk_f32 v48, v46, 0x43000000, v47
    v_fmamk_f32 v49, v46, 0x43010000, v47
    v_fmamk_f32 v50, v46, 0x43020000, v47
    v_fmamk_f32 v51, v46, 0x43030000, v47
    v_fmamk_f32 v52, v46, 0x43040000, v47
    v_fmamk_f32 v53, v46, 0x43050000, v47
    v_fmamk_f32 v54, v46, 0x43060000, v47
    v_fmamk_f32 v55, v46, 0x43070000, v47
    v_cos_f32 v56, v48
    v_sin_f32 v48, v48
    v_cos_f32 v57, v49
    v_sin_f32 v49, v49
    v_cos_f32 v58, v50
    v_sin_f32 v50, v50
    v_cos_f32 v59, v51
    v_sin_f32 v51, v51
    v_cos_f32 v60, v52
    v_sin_f32 v52, v52
    v_cos_f32 v61, v53
    v_sin_f32 v53, v53
    v_cos_f32 v62, v54
    v_sin_f32 v54, v54
    v_cos_f32 v63, v55
    v_sin_f32 v55, v55
    v_cvt_pk_bf16_f32 v88, v56, v57
    v_cvt_pk_bf16_f32 v124, -v48, -v49
    v_cvt_pk_bf16_f32 v89, v58, v59
    v_cvt_pk_bf16_f32 v125, -v50, -v51
    v_cvt_pk_bf16_f32 v90, v60, v61
    v_cvt_pk_bf16_f32 v126, -v52, -v53
    v_cvt_pk_bf16_f32 v91, v62, v63
    v_cvt_pk_bf16_f32 v127, -v54, -v55
    v_fmamk_f32 v48, v46, 0x43200000, v47
    v_fmamk_f32 v49, v46, 0x43210000, v47
    v_fmamk_f32 v50, v46, 0x43220000, v47
    v_fmamk_f32 v51, v46, 0x43230000, v47
    v_fmamk_f32 v52, v46, 0x43240000, v47
    v_fmamk_f32 v53, v46, 0x43250000, v47
    v_fmamk_f32 v54, v46, 0x43260000, v47
    v_fmamk_f32 v55, v46, 0x43270000, v47
    v_cos_f32 v56, v48
    v_sin_f32 v48, v48
    v_cos_f32 v57, v49
    v_sin_f32 v49, v49
    v_cos_f32 v58, v50
    v_sin_f32 v50, v50
    v_cos_f32 v59, v51
    v_sin_f32 v51, v51
    v_cos_f32 v60, v52
    v_sin_f32 v52, v52
    v_cos_f32 v61, v53
    v_sin_f32 v53, v53
    v_cos_f32 v62, v54
    v_sin_f32 v54, v54
    v_cos_f32 v63, v55
    v_sin_f32 v55, v55
    v_cvt_pk_bf16_f32 v92, v56, v57
    v_cvt_pk_bf16_f32 v128, -v48, -v49
    v_cvt_pk_bf16_f32 v93, v58, v59
    v_cvt_pk_bf16_f32 v129, -v50, -v51
    v_cvt_pk_bf16_f32 v94, v60, v61
    v_cvt_pk_bf16_f32 v130, -v52, -v53
    v_cvt_pk_bf16_f32 v95, v62, v63
    v_cvt_pk_bf16_f32 v131, -v54, -v55
    v_fmamk_f32 v48, v46, 0x43400000, v47
    v_fmamk_f32 v49, v46, 0x43410000, v47
    v_fmamk_f32 v50, v46, 0x43420000, v47
    v_fmamk_f32 v51, v46, 0x43430000, v47
    v_fmamk_f32 v52, v46, 0x43440000, v47
    v_fmamk_f32 v53, v46, 0x43450000, v47
    v_fmamk_f32 v54, v46, 0x43460000, v47
    v_fmamk_f32 v55, v46, 0x43470000, v47
    v_cos_f32 v56, v48
    v_sin_f32 v48, v48
    v_cos_f32 v57, v49
    v_sin_f32 v49, v49
    v_cos_f32 v58, v50
    v_sin_f32 v50, v50
    v_cos_f32 v59, v51
    v_sin_f32 v51, v51
    v_cos_f32 v60, v52
    v_sin_f32 v52, v52
    v_cos_f32 v61, v53
    v_sin_f32 v53, v53
    v_cos_f32 v62, v54
    v_sin_f32 v54, v54
    v_cos_f32 v63, v55
    v_sin_f32 v55, v55
    v_cvt_pk_bf16_f32 v96, v56, v57
    v_cvt_pk_bf16_f32 v132, -v48, -v49
    v_cvt_pk_bf16_f32 v97, v58, v59
    v_cvt_pk_bf16_f32 v133, -v50, -v51
    v_cvt_pk_bf16_f32 v98, v60, v61
    v_cvt_pk_bf16_f32 v134, -v52, -v53
    v_cvt_pk_bf16_f32 v99, v62, v63
    v_cvt_pk_bf16_f32 v135, -v54, -v55
    v_fmamk_f32 v48, v46, 0x43600000, v47
    v_fmamk_f32 v49, v46, 0x43610000, v47
    v_fmamk_f32 v50, v46, 0x43620000, v47
    v_fmamk_f32 v51, v46, 0x43630000, v47
    v_fmamk_f32 v52, v46, 0x43640000, v47
    v_fmamk_f32 v53, v46, 0x43650000, v47
    v_fmamk_f32 v54, v46, 0x43660000, v47
    v_fmamk_f32 v55, v46, 0x43670000, v47
    v_cos_f32 v56, v48
    v_sin_f32 v48, v48
    v_cos_f32 v57, v49
    v_sin_f32 v49, v49
    v_cos_f32 v58, v50
    v_sin_f32 v50, v50
    v_cos_f32 v59, v51
    v_sin_f32 v51, v51
    v_cos_f32 v60, v52
    v_sin_f32 v52, v52
    v_cos_f32 v61, v53
    v_sin_f32 v53, v53
    v_cos_f32 v62, v54
    v_sin_f32 v54, v54
    v_cos_f32 v63, v55
    v_sin_f32 v55, v55
    v_cvt_pk_bf16_f32 v100, v56, v57
    v_cvt_pk_bf16_f32 v136, -v48, -v49
    v_cvt_pk_bf16_f32 v101, v58, v59
    v_cvt_pk_bf16_f32 v137, -v50, -v51
    v_cvt_pk_bf16_f32 v102, v60, v61
    v_cvt_pk_bf16_f32 v138, -v52, -v53
    v_cvt_pk_bf16_f32 v103, v62, v63
    v_cvt_pk_bf16_f32 v139, -v54, -v55
    v_fmamk_f32 v48, v46, 0x43800000, v47
    v_fmamk_f32 v49, v46, 0x43808000, v47
    v_fmamk_f32 v50, v46, 0x43810000, v47
    v_fmamk_f32 v51, v46, 0x43818000, v47
    v_fmamk_f32 v52, v46, 0x43820000, v47
    v_fmamk_f32 v53, v46, 0x43828000, v47
    v_fmamk_f32 v54, v46, 0x43830000, v47
    v_fmamk_f32 v55, v46, 0x43838000, v47
    v_cos_f32 v56, v48
    v_sin_f32 v48, v48
    v_cos_f32 v57, v49
    v_sin_f32 v49, v49
    v_cos_f32 v58, v50
    v_sin_f32 v50, v50
    v_cos_f32 v59, v51
    v_sin_f32 v51, v51
    v_cos_f32 v60, v52
    v_sin_f32 v52, v52
    v_cos_f32 v61, v53
    v_sin_f32 v53, v53
    v_cos_f32 v62, v54
    v_sin_f32 v54, v54
    v_cos_f32 v63, v55
    v_sin_f32 v55, v55
    v_cvt_pk_bf16_f32 v104, v56, v57
    v_cvt_pk_bf16_f32 v140, -v48, -v49
    v_cvt_pk_bf16_f32 v105, v58, v59
    v_cvt_pk_bf16_f32 v141, -v50, -v51
    v_cvt_pk_bf16_f32 v106, v60, v61
    v_cvt_pk_bf16_f32 v142, -v52, -v53
    v_cvt_pk_bf16_f32 v107, v62, v63
    v_cvt_pk_bf16_f32 v143, -v54, -v55
    v_and_b32 v10, 1, v1
    v_lshlrev_b32 v10, 15, v10
    v_or_b32 v10, 0x3f80, v10
    v_cmp_gt_u32 vcc, 16, v1
    s_nop 1
    v_cndmask_b32 v28, 0, v10, vcc
    v_mov_b32 v29, 0
    v_mov_b32 v30, 0
    v_mov_b32 v31, 0
L_B2:
    s_waitcnt lgkmcnt(0)
    s_barrier
    ds_read_b128 v[32:35], v251 offset:0
    ds_read_b128 v[36:39], v251 offset:2048
    ds_read_b128 v[40:43], v251 offset:4096
    ds_read_b128 v[44:47], v251 offset:6144
    ds_read_b128 v[48:51], v251 offset:8192
    ds_read_b128 v[52:55], v251 offset:10240
    ds_read_b128 v[56:59], v251 offset:12288
    ds_read_b128 v[60:63], v251 offset:14336
    s_waitcnt lgkmcnt(7)
    v_mfma_f32_16x16x32_bf16 v[144:147], v[32:35], v[72:75], 0
    ds_read_b128 v[208:211], v252 offset:0
    s_waitcnt lgkmcnt(7)
    v_mfma_f32_16x16x32_bf16 v[148:151], v[36:39], v[72:75], 0
    ds_read_b128 v[212:215], v252 offset:2048
    s_waitcnt lgkmcnt(7)
    v_mfma_f32_16x16x32_bf16 v[152:155], v[40:43], v[72:75], 0
    ds_read_b128 v[216:219], v252 offset:4096
    s_waitcnt lgkmcnt(7)
    v_mfma_f32_16x16x32_bf16 v[156:159], v[44:47], v[72:75], 0
    ds_read_b128 v[220:223], v252 offset:6144
    s_waitcnt lgkmcnt(7)
    v_mfma_f32_16x16x32_bf16 v[160:163], v[48:51], v[72:75], 0
    ds_read_b128 v[224:227], v252 offset:8192
    s_waitcnt lgkmcnt(7)
    v_mfma_f32_16x16x32_bf16 v[164:167], v[52:55], v[72:75], 0
    ds_read_b128 v[228:231], v252 offset:10240
    s_waitcnt lgkmcnt(7)
    v_mfma_f32_16x16x32_bf16 v[168:171], v[56:59], v[72:75], 0
    ds_read_b128 v[232:235], v252 offset:12288
    s_waitcnt lgkmcnt(7)
    v_mfma_f32_16x16x32_bf16 v[172:175], v[60:63], v[72:75], 0
    ds_read_b128 v[236:239], v252 offset:14336
    s_waitcnt lgkmcnt(0)
    s_barrier
    v_mfma_f32_16x16x32_bf16 v[144:147], v[208:211], v[76:79], v[144:147]
    ds_read_b128 v[32:35], v251 offset:16384
    v_mfma_f32_16x16x32_bf16 v[148:151], v[212:215], v[76:79], v[148:151]
    ds_read_b128 v[36:39], v251 offset:18432
    v_mfma_f32_16x16x32_bf16 v[152:155], v[216:219], v[76:79], v[152:155]
    ds_read_b128 v[40:43], v251 offset:20480
    v_mfma_f32_16x16x32_bf16 v[156:159], v[220:223], v[76:79], v[156:159]
    ds_read_b128 v[44:47], v251 offset:22528
    v_mfma_f32_16x16x32_bf16 v[160:163], v[224:227], v[76:79], v[160:163]
    ds_read_b128 v[48:51], v251 offset:24576
    v_mfma_f32_16x16x32_bf16 v[164:167], v[228:231], v[76:79], v[164:167]
    ds_read_b128 v[52:55], v251 offset:26624
    v_mfma_f32_16x16x32_bf16 v[168:171], v[232:235], v[76:79], v[168:171]
    ds_read_b128 v[56:59], v251 offset:28672
    v_mfma_f32_16x16x32_bf16 v[172:175], v[236:239], v[76:79], v[172:175]
    ds_read_b128 v[60:63], v251 offset:30720
    s_waitcnt lgkmcnt(7)
    v_mfma_f32_16x16x32_bf16 v[144:147], v[32:35], v[80:83], v[144:147]
    ds_read_b128 v[208:211], v252 offset:16384
    s_waitcnt lgkmcnt(7)
    v_mfma_f32_16x16x32_bf16 v[148:151], v[36:39], v[80:83], v[148:151]
    ds_read_b128 v[212:215], v252 offset:18432
    s_waitcnt lgkmcnt(7)
    v_mfma_f32_16x16x32_bf16 v[152:155], v[40:43], v[80:83], v[152:155]
    ds_read_b128 v[216:219], v252 offset:20480
    s_waitcnt lgkmcnt(7)
    v_mfma_f32_16x16x32_bf16 v[156:159], v[44:47], v[80:83], v[156:159]
    ds_read_b128 v[220:223], v252 offset:22528
    s_waitcnt lgkmcnt(7)
    v_mfma_f32_16x16x32_bf16 v[160:163], v[48:51], v[80:83], v[160:163]
    ds_read_b128 v[224:227], v252 offset:24576
    s_waitcnt lgkmcnt(7)
    v_mfma_f32_16x16x32_bf16 v[164:167], v[52:55], v[80:83], v[164:167]
    ds_read_b128 v[228:231], v252 offset:26624
    s_waitcnt lgkmcnt(7)
    v_mfma_f32_16x16x32_bf16 v[168:171], v[56:59], v[80:83], v[168:171]
    ds_read_b128 v[232:235], v252 offset:28672
    s_waitcnt lgkmcnt(7)
    v_mfma_f32_16x16x32_bf16 v[172:175], v[60:63], v[80:83], v[172:175]
    ds_read_b128 v[236:239], v252 offset:30720
    s_waitcnt lgkmcnt(0)
    s_barrier
    v_mfma_f32_16x16x32_bf16 v[144:147], v[208:211], v[84:87], v[144:147]
    ds_read_b128 v[32:35], v251 offset:32768
    v_mfma_f32_16x16x32_bf16 v[148:151], v[212:215], v[84:87], v[148:151]
    ds_read_b128 v[36:39], v251 offset:34816
    v_mfma_f32_16x16x32_bf16 v[152:155], v[216:219], v[84:87], v[152:155]
    ds_read_b128 v[40:43], v251 offset:36864
    v_mfma_f32_16x16x32_bf16 v[156:159], v[220:223], v[84:87], v[156:159]
    ds_read_b128 v[44:47], v251 offset:38912
    v_mfma_f32_16x16x32_bf16 v[160:163], v[224:227], v[84:87], v[160:163]
    ds_read_b128 v[48:51], v251 offset:40960
    v_mfma_f32_16x16x32_bf16 v[164:167], v[228:231], v[84:87], v[164:167]
    ds_read_b128 v[52:55], v251 offset:43008
    v_mfma_f32_16x16x32_bf16 v[168:171], v[232:235], v[84:87], v[168:171]
    ds_read_b128 v[56:59], v251 offset:45056
    v_mfma_f32_16x16x32_bf16 v[172:175], v[236:239], v[84:87], v[172:175]
    ds_read_b128 v[60:63], v251 offset:47104
    s_waitcnt lgkmcnt(7)
    v_mfma_f32_16x16x32_bf16 v[144:147], v[32:35], v[88:91], v[144:147]
    ds_read_b128 v[208:211], v252 offset:32768
    s_waitcnt lgkmcnt(7)
    v_mfma_f32_16x16x32_bf16 v[148:151], v[36:39], v[88:91], v[148:151]
    ds_read_b128 v[212:215], v252 offset:34816
    s_waitcnt lgkmcnt(7)
    v_mfma_f32_16x16x32_bf16 v[152:155], v[40:43], v[88:91], v[152:155]
    ds_read_b128 v[216:219], v252 offset:36864
    s_waitcnt lgkmcnt(7)
    v_mfma_f32_16x16x32_bf16 v[156:159], v[44:47], v[88:91], v[156:159]
    ds_read_b128 v[220:223], v252 offset:38912
    s_waitcnt lgkmcnt(7)
    v_mfma_f32_16x16x32_bf16 v[160:163], v[48:51], v[88:91], v[160:163]
    ds_read_b128 v[224:227], v252 offset:40960
    s_waitcnt lgkmcnt(7)
    v_mfma_f32_16x16x32_bf16 v[164:167], v[52:55], v[88:91], v[164:167]
    ds_read_b128 v[228:231], v252 offset:43008
    s_waitcnt lgkmcnt(7)
    v_mfma_f32_16x16x32_bf16 v[168:171], v[56:59], v[88:91], v[168:171]
    ds_read_b128 v[232:235], v252 offset:45056
    s_waitcnt lgkmcnt(7)
    v_mfma_f32_16x16x32_bf16 v[172:175], v[60:63], v[88:91], v[172:175]
    ds_read_b128 v[236:239], v252 offset:47104
    s_waitcnt lgkmcnt(0)
    s_barrier
    v_mfma_f32_16x16x32_bf16 v[144:147], v[208:211], v[92:95], v[144:147]
    ds_read_b128 v[32:35], v251 offset:49152
    v_mfma_f32_16x16x32_bf16 v[148:151], v[212:215], v[92:95], v[148:151]
    ds_read_b128 v[36:39], v251 offset:51200
    v_mfma_f32_16x16x32_bf16 v[152:155], v[216:219], v[92:95], v[152:155]
    ds_read_b128 v[40:43], v251 offset:53248
    v_mfma_f32_16x16x32_bf16 v[156:159], v[220:223], v[92:95], v[156:159]
    ds_read_b128 v[44:47], v251 offset:55296
    v_mfma_f32_16x16x32_bf16 v[160:163], v[224:227], v[92:95], v[160:163]
    ds_read_b128 v[48:51], v251 offset:57344
    v_mfma_f32_16x16x32_bf16 v[164:167], v[228:231], v[92:95], v[164:167]
    ds_read_b128 v[52:55], v251 offset:59392
    v_mfma_f32_16x16x32_bf16 v[168:171], v[232:235], v[92:95], v[168:171]
    ds_read_b128 v[56:59], v251 offset:61440
    v_mfma_f32_16x16x32_bf16 v[172:175], v[236:239], v[92:95], v[172:175]
    ds_read_b128 v[60:63], v251 offset:63488
    s_waitcnt lgkmcnt(7)
    v_mfma_f32_16x16x32_bf16 v[144:147], v[32:35], v[96:99], v[144:147]
    ds_read_b128 v[208:211], v252 offset:49152
    s_waitcnt lgkmcnt(7)
    v_mfma_f32_16x16x32_bf16 v[148:151], v[36:39], v[96:99], v[148:151]
    ds_read_b128 v[212:215], v252 offset:51200
    s_waitcnt lgkmcnt(7)
    v_mfma_f32_16x16x32_bf16 v[152:155], v[40:43], v[96:99], v[152:155]
    ds_read_b128 v[216:219], v252 offset:53248
    s_waitcnt lgkmcnt(7)
    v_mfma_f32_16x16x32_bf16 v[156:159], v[44:47], v[96:99], v[156:159]
    ds_read_b128 v[220:223], v252 offset:55296
    s_waitcnt lgkmcnt(7)
    v_mfma_f32_16x16x32_bf16 v[160:163], v[48:51], v[96:99], v[160:163]
    ds_read_b128 v[224:227], v252 offset:57344
    s_waitcnt lgkmcnt(7)
    v_mfma_f32_16x16x32_bf16 v[164:167], v[52:55], v[96:99], v[164:167]
    ds_read_b128 v[228:231], v252 offset:59392
    s_waitcnt lgkmcnt(7)
    v_mfma_f32_16x16x32_bf16 v[168:171], v[56:59], v[96:99], v[168:171]
    ds_read_b128 v[232:235], v252 offset:61440
    s_waitcnt lgkmcnt(7)
    v_mfma_f32_16x16x32_bf16 v[172:175], v[60:63], v[96:99], v[172:175]
    ds_read_b128 v[236:239], v252 offset:63488
    s_waitcnt lgkmcnt(0)
    s_barrier
    v_mfma_f32_16x16x32_bf16 v[144:147], v[208:211], v[100:103], v[144:147]
    ds_read_b128 v[32:35], v251 offset:0
    v_mfma_f32_16x16x32_bf16 v[148:151], v[212:215], v[100:103], v[148:151]
    ds_read_b128 v[36:39], v251 offset:2048
    v_mfma_f32_16x16x32_bf16 v[152:155], v[216:219], v[100:103], v[152:155]
    ds_read_b128 v[40:43], v251 offset:4096
    v_mfma_f32_16x16x32_bf16 v[156:159], v[220:223], v[100:103], v[156:159]
    ds_read_b128 v[44:47], v251 offset:6144
    v_mfma_f32_16x16x32_bf16 v[160:163], v[224:227], v[100:103], v[160:163]
    ds_read_b128 v[48:51], v251 offset:8192
    v_mfma_f32_16x16x32_bf16 v[164:167], v[228:231], v[100:103], v[164:167]
    ds_read_b128 v[52:55], v251 offset:10240
    v_mfma_f32_16x16x32_bf16 v[168:171], v[232:235], v[100:103], v[168:171]
    ds_read_b128 v[56:59], v251 offset:12288
    v_mfma_f32_16x16x32_bf16 v[172:175], v[236:239], v[100:103], v[172:175]
    ds_read_b128 v[60:63], v251 offset:14336
    s_waitcnt lgkmcnt(7)
    v_mfma_f32_16x16x32_bf16 v[144:147], v[32:35], v[104:107], v[144:147]
    ds_read_b128 v[208:211], v252 offset:0
    s_waitcnt lgkmcnt(7)
    v_mfma_f32_16x16x32_bf16 v[148:151], v[36:39], v[104:107], v[148:151]
    ds_read_b128 v[212:215], v252 offset:2048
    s_waitcnt lgkmcnt(7)
    v_mfma_f32_16x16x32_bf16 v[152:155], v[40:43], v[104:107], v[152:155]
    ds_read_b128 v[216:219], v252 offset:4096
    s_waitcnt lgkmcnt(7)
    v_mfma_f32_16x16x32_bf16 v[156:159], v[44:47], v[104:107], v[156:159]
    ds_read_b128 v[220:223], v252 offset:6144
    s_waitcnt lgkmcnt(7)
    v_mfma_f32_16x16x32_bf16 v[160:163], v[48:51], v[104:107], v[160:163]
    ds_read_b128 v[224:227], v252 offset:8192
    s_waitcnt lgkmcnt(7)
    v_mfma_f32_16x16x32_bf16 v[164:167], v[52:55], v[104:107], v[164:167]
    ds_read_b128 v[228:231], v252 offset:10240
    s_waitcnt lgkmcnt(7)
    v_mfma_f32_16x16x32_bf16 v[168:171], v[56:59], v[104:107], v[168:171]
    ds_read_b128 v[232:235], v252 offset:12288
    s_waitcnt lgkmcnt(7)
    v_mfma_f32_16x16x32_bf16 v[172:175], v[60:63], v[104:107], v[172:175]
    ds_read_b128 v[236:239], v252 offset:14336
    s_waitcnt lgkmcnt(0)
    s_barrier
    v_mfma_f32_16x16x32_bf16 v[176:179], v[208:211], v[108:111], 0
    v_mfma_f32_16x16x32_bf16 v[144:147], v[208:211], v[28:31], v[144:147]
    ds_read_b128 v[32:35], v251 offset:16384
    v_mfma_f32_16x16x32_bf16 v[180:183], v[212:215], v[108:111], 0
    v_mfma_f32_16x16x32_bf16 v[148:151], v[212:215], v[28:31], v[148:151]
    ds_read_b128 v[36:39], v251 offset:18432
    v_mfma_f32_16x16x32_bf16 v[184:187], v[216:219], v[108:111], 0
    v_mfma_f32_16x16x32_bf16 v[152:155], v[216:219], v[28:31], v[152:155]
    ds_read_b128 v[40:43], v251 offset:20480
    v_mfma_f32_16x16x32_bf16 v[188:191], v[220:223], v[108:111], 0
    v_mfma_f32_16x16x32_bf16 v[156:159], v[220:223], v[28:31], v[156:159]
    ds_read_b128 v[44:47], v251 offset:22528
    v_mfma_f32_16x16x32_bf16 v[192:195], v[224:227], v[108:111], 0
    v_mfma_f32_16x16x32_bf16 v[160:163], v[224:227], v[28:31], v[160:163]
    ds_read_b128 v[48:51], v251 offset:24576
    v_mfma_f32_16x16x32_bf16 v[196:199], v[228:231], v[108:111], 0
    v_mfma_f32_16x16x32_bf16 v[164:167], v[228:231], v[28:31], v[164:167]
    ds_read_b128 v[52:55], v251 offset:26624
    v_mfma_f32_16x16x32_bf16 v[200:203], v[232:235], v[108:111], 0
    v_mfma_f32_16x16x32_bf16 v[168:171], v[232:235], v[28:31], v[168:171]
    ds_read_b128 v[56:59], v251 offset:28672
    v_mfma_f32_16x16x32_bf16 v[204:207], v[236:239], v[108:111], 0
    v_mfma_f32_16x16x32_bf16 v[172:175], v[236:239], v[28:31], v[172:175]
    ds_read_b128 v[60:63], v251 offset:30720
    s_waitcnt lgkmcnt(7)
    v_mfma_f32_16x16x32_bf16 v[176:179], v[32:35], v[112:115], v[176:179]
    ds_read_b128 v[208:211], v252 offset:16384
    s_waitcnt lgkmcnt(7)
    v_mfma_f32_16x16x32_bf16 v[180:183], v[36:39], v[112:115], v[180:183]
    ds_read_b128 v[212:215], v252 offset:18432
    s_waitcnt lgkmcnt(7)
    v_mfma_f32_16x16x32_bf16 v[184:187], v[40:43], v[112:115], v[184:187]
    ds_read_b128 v[216:219], v252 offset:20480
    s_waitcnt lgkmcnt(7)
    v_mfma_f32_16x16x32_bf16 v[188:191], v[44:47], v[112:115], v[188:191]
    ds_read_b128 v[220:223], v252 offset:22528
    s_waitcnt lgkmcnt(7)
    v_mfma_f32_16x16x32_bf16 v[192:195], v[48:51], v[112:115], v[192:195]
    ds_read_b128 v[224:227], v252 offset:24576
    s_waitcnt lgkmcnt(7)
    v_mfma_f32_16x16x32_bf16 v[196:199], v[52:55], v[112:115], v[196:199]
    ds_read_b128 v[228:231], v252 offset:26624
    s_waitcnt lgkmcnt(7)
    v_mfma_f32_16x16x32_bf16 v[200:203], v[56:59], v[112:115], v[200:203]
    ds_read_b128 v[232:235], v252 offset:28672
    s_waitcnt lgkmcnt(7)
    v_mfma_f32_16x16x32_bf16 v[204:207], v[60:63], v[112:115], v[204:207]
    ds_read_b128 v[236:239], v252 offset:30720
    s_waitcnt lgkmcnt(0)
    s_barrier
    v_mfma_f32_16x16x32_bf16 v[176:179], v[208:211], v[116:119], v[176:179]
    ds_read_b128 v[32:35], v251 offset:32768
    v_mfma_f32_16x16x32_bf16 v[180:183], v[212:215], v[116:119], v[180:183]
    ds_read_b128 v[36:39], v251 offset:34816
    v_mfma_f32_16x16x32_bf16 v[184:187], v[216:219], v[116:119], v[184:187]
    ds_read_b128 v[40:43], v251 offset:36864
    v_mfma_f32_16x16x32_bf16 v[188:191], v[220:223], v[116:119], v[188:191]
    ds_read_b128 v[44:47], v251 offset:38912
    v_mfma_f32_16x16x32_bf16 v[192:195], v[224:227], v[116:119], v[192:195]
    ds_read_b128 v[48:51], v251 offset:40960
    v_mfma_f32_16x16x32_bf16 v[196:199], v[228:231], v[116:119], v[196:199]
    ds_read_b128 v[52:55], v251 offset:43008
    v_mfma_f32_16x16x32_bf16 v[200:203], v[232:235], v[116:119], v[200:203]
    ds_read_b128 v[56:59], v251 offset:45056
    v_mfma_f32_16x16x32_bf16 v[204:207], v[236:239], v[116:119], v[204:207]
    ds_read_b128 v[60:63], v251 offset:47104
    s_waitcnt lgkmcnt(7)
    v_mfma_f32_16x16x32_bf16 v[176:179], v[32:35], v[120:123], v[176:179]
    ds_read_b128 v[208:211], v252 offset:32768
    s_waitcnt lgkmcnt(7)
    v_mfma_f32_16x16x32_bf16 v[180:183], v[36:39], v[120:123], v[180:183]
    ds_read_b128 v[212:215], v252 offset:34816
    s_waitcnt lgkmcnt(7)
    v_mfma_f32_16x16x32_bf16 v[184:187], v[40:43], v[120:123], v[184:187]
    ds_read_b128 v[216:219], v252 offset:36864
    s_waitcnt lgkmcnt(7)
    v_mfma_f32_16x16x32_bf16 v[188:191], v[44:47], v[120:123], v[188:191]
    ds_read_b128 v[220:223], v252 offset:38912
    s_waitcnt lgkmcnt(7)
    v_mfma_f32_16x16x32_bf16 v[192:195], v[48:51], v[120:123], v[192:195]
    ds_read_b128 v[224:227], v252 offset:40960
    s_waitcnt lgkmcnt(7)
    v_mfma_f32_16x16x32_bf16 v[196:199], v[52:55], v[120:123], v[196:199]
    ds_read_b128 v[228:231], v252 offset:43008
    s_waitcnt lgkmcnt(7)
    v_mfma_f32_16x16x32_bf16 v[200:203], v[56:59], v[120:123], v[200:203]
    ds_read_b128 v[232:235], v252 offset:45056
    s_waitcnt lgkmcnt(7)
    v_mfma_f32_16x16x32_bf16 v[204:207], v[60:63], v[120:123], v[204:207]
    ds_read_b128 v[236:239], v252 offset:47104
    s_waitcnt lgkmcnt(0)
    s_barrier
    v_mfma_f32_16x16x32_bf16 v[176:179], v[208:211], v[124:127], v[176:179]
    ds_read_b128 v[32:35], v251 offset:49152
    v_mfma_f32_16x16x32_bf16 v[180:183], v[212:215], v[124:127], v[180:183]
    ds_read_b128 v[36:39], v251 offset:51200
    v_mfma_f32_16x16x32_bf16 v[184:187], v[216:219], v[124:127], v[184:187]
    ds_read_b128 v[40:43], v251 offset:53248
    v_mfma_f32_16x16x32_bf16 v[188:191], v[220:223], v[124:127], v[188:191]
    ds_read_b128 v[44:47], v251 offset:55296
    v_mfma_f32_16x16x32_bf16 v[192:195], v[224:227], v[124:127], v[192:195]
    ds_read_b128 v[48:51], v251 offset:57344
    v_mfma_f32_16x16x32_bf16 v[196:199], v[228:231], v[124:127], v[196:199]
    ds_read_b128 v[52:55], v251 offset:59392
    v_mfma_f32_16x16x32_bf16 v[200:203], v[232:235], v[124:127], v[200:203]
    ds_read_b128 v[56:59], v251 offset:61440
    v_mfma_f32_16x16x32_bf16 v[204:207], v[236:239], v[124:127], v[204:207]
    ds_read_b128 v[60:63], v251 offset:63488
    s_waitcnt lgkmcnt(7)
    v_mfma_f32_16x16x32_bf16 v[176:179], v[32:35], v[128:131], v[176:179]
    ds_read_b128 v[208:211], v252 offset:49152
    s_waitcnt lgkmcnt(7)
    v_mfma_f32_16x16x32_bf16 v[180:183], v[36:39], v[128:131], v[180:183]
    ds_read_b128 v[212:215], v252 offset:51200
    s_waitcnt lgkmcnt(7)
    v_mfma_f32_16x16x32_bf16 v[184:187], v[40:43], v[128:131], v[184:187]
    ds_read_b128 v[216:219], v252 offset:53248
    s_waitcnt lgkmcnt(7)
    v_mfma_f32_16x16x32_bf16 v[188:191], v[44:47], v[128:131], v[188:191]
    ds_read_b128 v[220:223], v252 offset:55296
    s_waitcnt lgkmcnt(7)
    v_mfma_f32_16x16x32_bf16 v[192:195], v[48:51], v[128:131], v[192:195]
    ds_read_b128 v[224:227], v252 offset:57344
    s_waitcnt lgkmcnt(7)
    v_mfma_f32_16x16x32_bf16 v[196:199], v[52:55], v[128:131], v[196:199]
    ds_read_b128 v[228:231], v252 offset:59392
    s_waitcnt lgkmcnt(7)
    v_mfma_f32_16x16x32_bf16 v[200:203], v[56:59], v[128:131], v[200:203]
    ds_read_b128 v[232:235], v252 offset:61440
    s_waitcnt lgkmcnt(7)
    v_mfma_f32_16x16x32_bf16 v[204:207], v[60:63], v[128:131], v[204:207]
    ds_read_b128 v[236:239], v252 offset:63488
    s_waitcnt lgkmcnt(0)
    s_barrier
    v_mfma_f32_16x16x32_bf16 v[176:179], v[208:211], v[132:135], v[176:179]
    ds_read_b128 v[32:35], v251 offset:0
    v_mfma_f32_16x16x32_bf16 v[180:183], v[212:215], v[132:135], v[180:183]
    ds_read_b128 v[36:39], v251 offset:2048
    v_mfma_f32_16x16x32_bf16 v[184:187], v[216:219], v[132:135], v[184:187]
    ds_read_b128 v[40:43], v251 offset:4096
    v_mfma_f32_16x16x32_bf16 v[188:191], v[220:223], v[132:135], v[188:191]
    ds_read_b128 v[44:47], v251 offset:6144
    v_mfma_f32_16x16x32_bf16 v[192:195], v[224:227], v[132:135], v[192:195]
    ds_read_b128 v[48:51], v251 offset:8192
    v_mfma_f32_16x16x32_bf16 v[196:199], v[228:231], v[132:135], v[196:199]
    ds_read_b128 v[52:55], v251 offset:10240
    v_mfma_f32_16x16x32_bf16 v[200:203], v[232:235], v[132:135], v[200:203]
    ds_read_b128 v[56:59], v251 offset:12288
    v_mfma_f32_16x16x32_bf16 v[204:207], v[236:239], v[132:135], v[204:207]
    ds_read_b128 v[60:63], v251 offset:14336
    s_waitcnt lgkmcnt(7)
    v_mfma_f32_16x16x32_bf16 v[176:179], v[32:35], v[136:139], v[176:179]
    ds_read_b128 v[208:211], v252 offset:0
    s_waitcnt lgkmcnt(7)
    v_mfma_f32_16x16x32_bf16 v[180:183], v[36:39], v[136:139], v[180:183]
    ds_read_b128 v[212:215], v252 offset:2048
    s_waitcnt lgkmcnt(7)
    v_mfma_f32_16x16x32_bf16 v[184:187], v[40:43], v[136:139], v[184:187]
    ds_read_b128 v[216:219], v252 offset:4096
    s_waitcnt lgkmcnt(7)
    v_mfma_f32_16x16x32_bf16 v[188:191], v[44:47], v[136:139], v[188:191]
    ds_read_b128 v[220:223], v252 offset:6144
    s_waitcnt lgkmcnt(7)
    v_mfma_f32_16x16x32_bf16 v[192:195], v[48:51], v[136:139], v[192:195]
    ds_read_b128 v[224:227], v252 offset:8192
    s_waitcnt lgkmcnt(7)
    v_mfma_f32_16x16x32_bf16 v[196:199], v[52:55], v[136:139], v[196:199]
    ds_read_b128 v[228:231], v252 offset:10240
    s_waitcnt lgkmcnt(7)
    v_mfma_f32_16x16x32_bf16 v[200:203], v[56:59], v[136:139], v[200:203]
    ds_read_b128 v[232:235], v252 offset:12288
    s_waitcnt lgkmcnt(7)
    v_mfma_f32_16x16x32_bf16 v[204:207], v[60:63], v[136:139], v[204:207]
    ds_read_b128 v[236:239], v252 offset:14336
    s_waitcnt lgkmcnt(7)
    v_mfma_f32_16x16x32_bf16 v[176:179], v[208:211], v[140:143], v[176:179]
    ds_read_b128 v[72:75], v253 offset:0
    ds_read_b128 v[76:79], v253 offset:1024
    s_waitcnt lgkmcnt(8)
    v_mfma_f32_16x16x32_bf16 v[180:183], v[212:215], v[140:143], v[180:183]
    ds_read_b128 v[80:83], v253 offset:2048
    ds_read_b128 v[84:87], v253 offset:3072
    s_waitcnt lgkmcnt(9)
    v_mfma_f32_16x16x32_bf16 v[184:187], v[216:219], v[140:143], v[184:187]
    ds_read_b128 v[88:91], v253 offset:4096
    ds_read_b128 v[92:95], v253 offset:5120
    s_waitcnt lgkmcnt(10)
    v_mfma_f32_16x16x32_bf16 v[188:191], v[220:223], v[140:143], v[188:191]
    ds_read_b128 v[96:99], v253 offset:6144
    ds_read_b128 v[100:103], v253 offset:7168
    s_waitcnt lgkmcnt(11)
    v_mfma_f32_16x16x32_bf16 v[192:195], v[224:227], v[140:143], v[192:195]
    ds_read_b128 v[104:107], v253 offset:8192
    ds_read_b128 v[108:111], v253 offset:9216
    s_waitcnt lgkmcnt(12)
    v_mfma_f32_16x16x32_bf16 v[196:199], v[228:231], v[140:143], v[196:199]
    ds_read_b128 v[112:115], v253 offset:10240
    ds_read_b128 v[116:119], v253 offset:11264
    s_waitcnt lgkmcnt(13)
    v_mfma_f32_16x16x32_bf16 v[200:203], v[232:235], v[140:143], v[200:203]
    ds_read_b128 v[120:123], v253 offset:12288
    ds_read_b128 v[124:127], v253 offset:13312
    s_waitcnt lgkmcnt(14)
    v_mfma_f32_16x16x32_bf16 v[204:207], v[236:239], v[140:143], v[204:207]
    ds_read_b128 v[128:131], v253 offset:14336
    ds_read_b128 v[132:135], v253 offset:15360
    v_cvt_pk_bf16_f32 v32, v144, v145
    v_cvt_pk_bf16_f32 v33, v146, v147
    v_cvt_pk_bf16_f32 v34, v148, v149
    v_cvt_pk_bf16_f32 v35, v150, v151
    v_cvt_pk_bf16_f32 v36, v152, v153
    v_cvt_pk_bf16_f32 v37, v154, v155
    v_cvt_pk_bf16_f32 v38, v156, v157
    v_cvt_pk_bf16_f32 v39, v158, v159
    v_cvt_pk_bf16_f32 v40, -v160, -v161
    v_cvt_pk_bf16_f32 v41, -v162, -v163
    v_cvt_pk_bf16_f32 v42, -v164, -v165
    v_cvt_pk_bf16_f32 v43, -v166, -v167
    v_cvt_pk_bf16_f32 v44, -v168, -v169
    v_cvt_pk_bf16_f32 v45, -v170, -v171
    v_cvt_pk_bf16_f32 v46, -v172, -v173
    v_cvt_pk_bf16_f32 v47, -v174, -v175
    s_waitcnt lgkmcnt(0)
    v_mfma_f32_16x16x32_bf16 v[208:211], v[32:35], v[72:75], 0
    v_mfma_f32_16x16x32_bf16 v[212:215], v[32:35], v[80:83], 0
    v_mfma_f32_16x16x32_bf16 v[216:219], v[32:35], v[88:91], 0
    v_mfma_f32_16x16x32_bf16 v[220:223], v[32:35], v[96:99], 0
    v_mfma_f32_16x16x32_bf16 v[208:211], v[36:39], v[76:79], v[208:211]
    v_mfma_f32_16x16x32_bf16 v[212:215], v[36:39], v[84:87], v[212:215]
    v_mfma_f32_16x16x32_bf16 v[216:219], v[36:39], v[92:95], v[216:219]
    v_mfma_f32_16x16x32_bf16 v[220:223], v[36:39], v[100:103], v[220:223]
    v_mfma_f32_16x16x32_bf16 v[208:211], v[40:43], v[104:107], v[208:211]
    v_mfma_f32_16x16x32_bf16 v[212:215], v[40:43], v[112:115], v[212:215]
    v_mfma_f32_16x16x32_bf16 v[216:219], v[40:43], v[120:123], v[216:219]
    v_mfma_f32_16x16x32_bf16 v[220:223], v[40:43], v[128:131], v[220:223]
    v_mfma_f32_16x16x32_bf16 v[208:211], v[44:47], v[108:111], v[208:211]
    v_mfma_f32_16x16x32_bf16 v[212:215], v[44:47], v[116:119], v[212:215]
    v_mfma_f32_16x16x32_bf16 v[216:219], v[44:47], v[124:127], v[216:219]
    v_mfma_f32_16x16x32_bf16 v[220:223], v[44:47], v[132:135], v[220:223]
    v_cvt_pk_bf16_f32 v48, v176, v177
    s_nop 0
    v_cvt_pk_bf16_f32 v49, v178, v179
    v_cvt_pk_bf16_f32 v50, v180, v181
    v_cvt_pk_bf16_f32 v51, v182, v183
    v_cvt_pk_bf16_f32 v52, v184, v185
    v_cvt_pk_bf16_f32 v53, v186, v187
    v_cvt_pk_bf16_f32 v54, v188, v189
    v_cvt_pk_bf16_f32 v55, v190, v191
    v_cvt_pk_bf16_f32 v56, v192, v193
    v_cvt_pk_bf16_f32 v57, v194, v195
    v_cvt_pk_bf16_f32 v58, v196, v197
    v_cvt_pk_bf16_f32 v59, v198, v199
    v_cvt_pk_bf16_f32 v60, v200, v201
    v_cvt_pk_bf16_f32 v61, v202, v203
    v_cvt_pk_bf16_f32 v62, v204, v205
    v_cvt_pk_bf16_f32 v63, v206, v207
    v_mfma_f32_16x16x32_bf16 v[224:227], v[48:51], v[104:107], 0
    v_mfma_f32_16x16x32_bf16 v[228:231], v[48:51], v[112:115], 0
    v_mfma_f32_16x16x32_bf16 v[232:235], v[48:51], v[120:123], 0
    v_mfma_f32_16x16x32_bf16 v[236:239], v[48:51], v[128:131], 0
    v_mfma_f32_16x16x32_bf16 v[224:227], v[52:55], v[108:111], v[224:227]
    v_mfma_f32_16x16x32_bf16 v[228:231], v[52:55], v[116:119], v[228:231]
    v_mfma_f32_16x16x32_bf16 v[232:235], v[52:55], v[124:127], v[232:235]
    v_mfma_f32_16x16x32_bf16 v[236:239], v[52:55], v[132:135], v[236:239]
    v_mfma_f32_16x16x32_bf16 v[224:227], v[56:59], v[72:75], v[224:227]
    v_mfma_f32_16x16x32_bf16 v[228:231], v[56:59], v[80:83], v[228:231]
    v_mfma_f32_16x16x32_bf16 v[232:235], v[56:59], v[88:91], v[232:235]
    v_mfma_f32_16x16x32_bf16 v[236:239], v[56:59], v[96:99], v[236:239]
    v_mfma_f32_16x16x32_bf16 v[224:227], v[60:63], v[76:79], v[224:227]
    v_mfma_f32_16x16x32_bf16 v[228:231], v[60:63], v[84:87], v[228:231]
    v_mfma_f32_16x16x32_bf16 v[232:235], v[60:63], v[92:95], v[232:235]
    v_mfma_f32_16x16x32_bf16 v[236:239], v[60:63], v[100:103], v[236:239]
    v_add_u32 v249, 74240, v249
    v_add_u32 v250, 74240, v250
    s_nop 2
    v_sub_f32 v144, v208, v224
    v_add_f32 v148, v208, v224
    v_sub_f32 v145, v209, v225
    v_add_f32 v149, v209, v225
    v_sub_f32 v146, v210, v226
    v_add_f32 v150, v210, v226
    v_sub_f32 v147, v211, v227
    v_add_f32_e64 v151, v211, v227
    v_cvt_pk_bf16_f32 v152, v144, v145
    v_cvt_pk_bf16_f32 v153, v146, v147
    v_cvt_pk_bf16_f32 v154, v146, v145
    ds_write_b64 v249, v[152:153] offset:0
    ds_write_b16_d16_hi v250, v153 offset:27648
    ds_write_b32 v250, v154 offset:27650
    ds_write_b16 v250, v152 offset:27654
    v_cvt_pk_bf16_f32 v156, v148, v149
    v_cvt_pk_bf16_f32 v157, v150, v151
    v_cvt_pk_bf16_f32 v158, v150, v149
    ds_write_b64 v249, v[156:157] offset:27648
    ds_write_b16_d16_hi v250, v157 offset:0
    ds_write_b32 v250, v158 offset:2
    ds_write_b16 v250, v156 offset:6
    v_sub_f32 v160, v212, v228
    v_add_f32 v164, v212, v228
    v_sub_f32 v161, v213, v229
    v_add_f32 v165, v213, v229
    v_sub_f32 v162, v214, v230
    v_add_f32 v166, v214, v230
    v_sub_f32 v163, v215, v231
    v_add_f32 v167, v215, v231
    v_cvt_pk_bf16_f32 v168, v160, v161
    v_cvt_pk_bf16_f32 v169, v162, v163
    v_cvt_pk_bf16_f32 v170, v162, v161
    ds_write_b64 v249, v[168:169] offset:6912
    ds_write_b16_d16_hi v250, v169 offset:34560
    ds_write_b32 v250, v170 offset:34562
    ds_write_b16 v250, v168 offset:34566
    v_cvt_pk_bf16_f32 v172, v164, v165
    v_cvt_pk_bf16_f32 v173, v166, v167
    v_cvt_pk_bf16_f32 v174, v166, v165
    ds_write_b64 v249, v[172:173] offset:34560
    ds_write_b16_d16_hi v250, v173 offset:6912
    ds_write_b32 v250, v174 offset:6914
    ds_write_b16 v250, v172 offset:6918
    v_sub_f32 v176, v216, v232
    v_add_f32 v180, v216, v232
    v_sub_f32 v177, v217, v233
    v_add_f32 v181, v217, v233
    v_sub_f32 v178, v218, v234
    v_add_f32 v182, v218, v234
    v_sub_f32 v179, v219, v235
    v_add_f32 v183, v219, v235
    v_cvt_pk_bf16_f32 v184, v176, v177
    v_cvt_pk_bf16_f32 v185, v178, v179
    v_cvt_pk_bf16_f32 v186, v178, v177
    ds_write_b64 v249, v[184:185] offset:13824
    ds_write_b16_d16_hi v250, v185 offset:41472
    ds_write_b32 v250, v186 offset:41474
    ds_write_b16 v250, v184 offset:41478
    v_cvt_pk_bf16_f32 v188, v180, v181
    v_cvt_pk_bf16_f32 v189, v182, v183
    v_cvt_pk_bf16_f32 v190, v182, v181
    ds_write_b64 v249, v[188:189] offset:41472
    ds_write_b16_d16_hi v250, v189 offset:13824
    ds_write_b32 v250, v190 offset:13826
    ds_write_b16 v250, v188 offset:13830
    v_sub_f32 v192, v220, v236
    v_add_f32 v196, v220, v236
    v_sub_f32 v193, v221, v237
    v_add_f32 v197, v221, v237
    v_sub_f32 v194, v222, v238
    v_add_f32 v198, v222, v238
    v_sub_f32 v195, v223, v239
    v_add_f32 v199, v223, v239
    v_cvt_pk_bf16_f32 v200, v192, v193
    v_cvt_pk_bf16_f32 v201, v194, v195
    v_cvt_pk_bf16_f32 v202, v194, v193
    ds_write_b64 v249, v[200:201] offset:20736
    ds_write_b16_d16_hi v250, v201 offset:48384
    ds_write_b32 v250, v202 offset:48386
    ds_write_b16 v250, v200 offset:48390
    v_cvt_pk_bf16_f32 v204, v196, v197
    v_cvt_pk_bf16_f32 v205, v198, v199
    v_cvt_pk_bf16_f32 v206, v198, v197
    ds_write_b64 v249, v[204:205] offset:48384
    ds_write_b16_d16_hi v250, v205 offset:20736
    ds_write_b32 v250, v206 offset:20738
    ds_write_b16 v250, v204 offset:20742
L_B2_out:
    v_add_u32 v246, 74240, v246
    v_add_u32 v247, 74240, v247
    v_add_u32 v248, 74240, v248
    s_and_b32 s78, s9, 15
    s_lshr_b32 s79, s3, 2
    s_cmp_eq_u32 s78, 0
    s_cselect_b32 s79, s79, 0
    s_waitcnt lgkmcnt(0)
    s_barrier
    s_cmp_eq_u32 s79, 1
    s_cbranch_scc1 L_fin
    ds_read_b128 v[32:35], v246 offset:0
    ds_read_b128 v[36:39], v247 offset:0
    ds_read_b128 v[40:43], v248 offset:0
    ds_read_b128 v[44:47], v246 offset:3456
    ds_read_b128 v[48:51], v247 offset:3456
    ds_read_b128 v[52:55], v248 offset:3456
    s_waitcnt lgkmcnt(5)
    buffer_store_dwordx4 v[32:35], v240, s[56:59], 0 offen
    s_waitcnt lgkmcnt(4)
    buffer_store_dwordx4 v[36:39], v241, s[56:59], 0 offen
    s_waitcnt lgkmcnt(3)
    buffer_store_dwordx4 v[40:43], v242, s[56:59], 0 offen
    s_waitcnt lgkmcnt(2)
    buffer_store_dwordx4 v[44:47], v243, s[56:59], 0 offen
    s_waitcnt lgkmcnt(1)
    buffer_store_dwordx4 v[48:51], v244, s[56:59], 0 offen
    s_waitcnt lgkmcnt(0)
    buffer_store_dwordx4 v[52:55], v245, s[56:59], 0 offen
    s_branch L_fin
L_B_w7:
    s_lshl_b32 s78, s8, 7
    s_add_u32 s78, s78, 4096
    v_mov_b32 v12, s76
    v_mov_b32 v11, 0
    s_mov_b64 exec, 1
    buffer_store_dword v12, v11, s[48:51], s78 offen sc1
    s_mov_b64 exec, -1
    s_mul_i32 s20, s9, 73728
    s_add_u32 s20, s20, 7405568
    s_add_u32 s24, s20, 1179648
    s_and_b32 s78, s9, 15
    s_cmp_eq_u32 s78, 0
    s_cselect_b32 s24, 10428416, s24
    s_add_u32 s21, s20, 4608
    s_add_u32 s22, s20, 36864
    s_add_u32 s23, s20, 41472
    s_add_u32 s25, s24, 4608
    s_add_u32 s26, s24, 36864
    s_add_u32 s27, s24, 41472
    v_lshlrev_b32_e64 v11, 7, v1
    s_mov_b32 s78, 4096
    s_mov_b32 s77, 0
    s_waitcnt vmcnt(0)
L_B_poll:
    buffer_load_dword v10, v11, s[48:51], s78 offen sc1
    s_add_u32 s77, s77, 1
    s_waitcnt vmcnt(0)
    v_cmp_ne_u32 vcc, s76, v10
    s_cbranch_vccz L_B_go
    s_mov_b64 exec, vcc
    s_cmp_lt_u32 s77, 32768
    s_sleep 4
    s_cbranch_scc1 L_B_poll
L_B_go:
    s_mov_b64 exec, -1
    s_mov_b32 m0, 0
    s_nop 0
    buffer_load_dwordx4 v18, s[48:51], s20 offen sc1 lds
    buffer_load_dwordx4 v19, s[48:51], s20 offen offset:1024 sc1 lds
    s_mov_b32 m0, 2048
    s_nop 0
    buffer_load_dwordx4 v18, s[48:51], s21 offen sc1 lds
    buffer_load_dwordx4 v19, s[48:51], s21 offen offset:1024 sc1 lds
    s_mov_b32 m0, 4096
    s_nop 0
    buffer_load_dwordx4 v18, s[48:51], s22 offen sc1 lds
    buffer_load_dwordx4 v19, s[48:51], s22 offen offset:1024 sc1 lds
    s_mov_b32 m0, 6144
    s_nop 0
    buffer_load_dwordx4 v18, s[48:51], s23 offen sc1 lds
    buffer_load_dwordx4 v19, s[48:51], s23 offen offset:1024 sc1 lds
    s_mov_b32 m0, 8192
    s_nop 0
    buffer_load_dwordx4 v18, s[48:51], s24 offen sc1 lds
    buffer_load_dwordx4 v19, s[48:51], s24 offen offset:1024 sc1 lds
    s_mov_b32 m0, 10240
    s_nop 0
    buffer_load_dwordx4 v18, s[48:51], s25 offen sc1 lds
    buffer_load_dwordx4 v19, s[48:51], s25 offen offset:1024 sc1 lds
    s_mov_b32 m0, 12288
    s_nop 0
    buffer_load_dwordx4 v18, s[48:51], s26 offen sc1 lds
    buffer_load_dwordx4 v19, s[48:51], s26 offen offset:1024 sc1 lds
    s_mov_b32 m0, 14336
    s_nop 0
    buffer_load_dwordx4 v18, s[48:51], s27 offen sc1 lds
    buffer_load_dwordx4 v19, s[48:51], s27 offen offset:1024 sc1 lds
    v_add_u32 v18, 128, v18
    v_add_u32 v19, 128, v19
    s_mov_b32 m0, 16384
    s_nop 0
    buffer_load_dwordx4 v18, s[48:51], s20 offen sc1 lds
    buffer_load_dwordx4 v19, s[48:51], s20 offen offset:1024 sc1 lds
    s_mov_b32 m0, 18432
    s_nop 0
    buffer_load_dwordx4 v18, s[48:51], s21 offen sc1 lds
    buffer_load_dwordx4 v19, s[48:51], s21 offen offset:1024 sc1 lds
    s_mov_b32 m0, 20480
    s_nop 0
    buffer_load_dwordx4 v18, s[48:51], s22 offen sc1 lds
    buffer_load_dwordx4 v19, s[48:51], s22 offen offset:1024 sc1 lds
    s_mov_b32 m0, 22528
    s_nop 0
    buffer_load_dwordx4 v18, s[48:51], s23 offen sc1 lds
    buffer_load_dwordx4 v19, s[48:51], s23 offen offset:1024 sc1 lds
    s_mov_b32 m0, 24576
    s_nop 0
    buffer_load_dwordx4 v18, s[48:51], s24 offen sc1 lds
    buffer_load_dwordx4 v19, s[48:51], s24 offen offset:1024 sc1 lds
    s_mov_b32 m0, 26624
    s_nop 0
    buffer_load_dwordx4 v18, s[48:51], s25 offen sc1 lds
    buffer_load_dwordx4 v19, s[48:51], s25 offen offset:1024 sc1 lds
    s_mov_b32 m0, 28672
    s_nop 0
    buffer_load_dwordx4 v18, s[48:51], s26 offen sc1 lds
    buffer_load_dwordx4 v19, s[48:51], s26 offen offset:1024 sc1 lds
    s_mov_b32 m0, 30720
    s_nop 0
    buffer_load_dwordx4 v18, s[48:51], s27 offen sc1 lds
    buffer_load_dwordx4 v19, s[48:51], s27 offen offset:1024 sc1 lds
    v_add_u32 v18, 128, v18
    v_add_u32 v19, 128, v19
    s_mov_b32 m0, 32768
    s_nop 0
    buffer_load_dwordx4 v18, s[48:51], s20 offen sc1 lds
    buffer_load_dwordx4 v19, s[48:51], s20 offen offset:1024 sc1 lds
    s_mov_b32 m0, 34816
    s_nop 0
    buffer_load_dwordx4 v18, s[48:51], s21 offen sc1 lds
    buffer_load_dwordx4 v19, s[48:51], s21 offen offset:1024 sc1 lds
    s_mov_b32 m0, 36864
    s_nop 0
    buffer_load_dwordx4 v18, s[48:51], s22 offen sc1 lds
    buffer_load_dwordx4 v19, s[48:51], s22 offen offset:1024 sc1 lds
    s_mov_b32 m0, 38912
    s_nop 0
    buffer_load_dwordx4 v18, s[48:51], s23 offen sc1 lds
    buffer_load_dwordx4 v19, s[48:51], s23 offen offset:1024 sc1 lds
    s_mov_b32 m0, 40960
    s_nop 0
    buffer_load_dwordx4 v18, s[48:51], s24 offen sc1 lds
    buffer_load_dwordx4 v19, s[48:51], s24 offen offset:1024 sc1 lds
    s_mov_b32 m0, 43008
    s_nop 0
    buffer_load_dwordx4 v18, s[48:51], s25 offen sc1 lds
    buffer_load_dwordx4 v19, s[48:51], s25 offen offset:1024 sc1 lds
    s_mov_b32 m0, 45056
    s_nop 0
    buffer_load_dwordx4 v18, s[48:51], s26 offen sc1 lds
    buffer_load_dwordx4 v19, s[48:51], s26 offen offset:1024 sc1 lds
    s_mov_b32 m0, 47104
    s_nop 0
    buffer_load_dwordx4 v18, s[48:51], s27 offen sc1 lds
    buffer_load_dwordx4 v19, s[48:51], s27 offen offset:1024 sc1 lds
    v_add_u32 v18, 128, v18
    v_add_u32 v19, 128, v19
    s_waitcnt vmcnt(32)
    s_barrier
    s_mov_b32 m0, 49152
    s_nop 0
    buffer_load_dwordx4 v18, s[48:51], s20 offen sc1 lds
    buffer_load_dwordx4 v19, s[48:51], s20 offen offset:1024 sc1 lds
    s_mov_b32 m0, 51200
    s_nop 0
    buffer_load_dwordx4 v18, s[48:51], s21 offen sc1 lds
    buffer_load_dwordx4 v19, s[48:51], s21 offen offset:1024 sc1 lds
    s_mov_b32 m0, 53248
    s_nop 0
    buffer_load_dwordx4 v18, s[48:51], s22 offen sc1 lds
    buffer_load_dwordx4 v19, s[48:51], s22 offen offset:1024 sc1 lds
    s_mov_b32 m0, 55296
    s_nop 0
    buffer_load_dwordx4 v18, s[48:51], s23 offen sc1 lds
    buffer_load_dwordx4 v19, s[48:51], s23 offen offset:1024 sc1 lds
    s_mov_b32 m0, 57344
    s_nop 0
    buffer_load_dwordx4 v18, s[48:51], s24 offen sc1 lds
    buffer_load_dwordx4 v19, s[48:51], s24 offen offset:1024 sc1 lds
    s_mov_b32 m0, 59392
    s_nop 0
    buffer_load_dwordx4 v18, s[48:51], s25 offen sc1 lds
    buffer_load_dwordx4 v19, s[48:51], s25 offen offset:1024 sc1 lds
    s_mov_b32 m0, 61440
    s_nop 0
    buffer_load_dwordx4 v18, s[48:51], s26 offen sc1 lds
    buffer_load_dwordx4 v19, s[48:51], s26 offen offset:1024 sc1 lds
    s_mov_b32 m0, 63488
    s_nop 0
    buffer_load_dwordx4 v18, s[48:51], s27 offen sc1 lds
    buffer_load_dwordx4 v19, s[48:51], s27 offen offset:1024 sc1 lds
    v_add_u32 v18, 128, v18
    v_add_u32 v19, 128, v19
    s_waitcnt vmcnt(32)
    s_barrier
    s_mov_b32 m0, 0
    s_nop 0
    buffer_load_dwordx4 v18, s[48:51], s20 offen sc1 lds
    buffer_load_dwordx4 v19, s[48:51], s20 offen offset:1024 sc1 lds
    s_mov_b32 m0, 2048
    s_nop 0
    buffer_load_dwordx4 v18, s[48:51], s21 offen sc1 lds
    buffer_load_dwordx4 v19, s[48:51], s21 offen offset:1024 sc1 lds
    s_mov_b32 m0, 4096
    s_nop 0
    buffer_load_dwordx4 v18, s[48:51], s22 offen sc1 lds
    buffer_load_dwordx4 v19, s[48:51], s22 offen offset:1024 sc1 lds
    s_mov_b32 m0, 6144
    s_nop 0
    buffer_load_dwordx4 v18, s[48:51], s23 offen sc1 lds
    buffer_load_dwordx4 v19, s[48:51], s23 offen offset:1024 sc1 lds
    s_mov_b32 m0, 8192
    s_nop 0
    buffer_load_dwordx4 v18, s[48:51], s24 offen sc1 lds
    buffer_load_dwordx4 v19, s[48:51], s24 offen offset:1024 sc1 lds
    s_mov_b32 m0, 10240
    s_nop 0
    buffer_load_dwordx4 v18, s[48:51], s25 offen sc1 lds
    buffer_load_dwordx4 v19, s[48:51], s25 offen offset:1024 sc1 lds
    s_mov_b32 m0, 12288
    s_nop 0
    buffer_load_dwordx4 v18, s[48:51], s26 offen sc1 lds
    buffer_load_dwordx4 v19, s[48:51], s26 offen offset:1024 sc1 lds
    s_mov_b32 m0, 14336
    s_nop 0
    buffer_load_dwordx4 v18, s[48:51], s27 offen sc1 lds
    buffer_load_dwordx4 v19, s[48:51], s27 offen offset:1024 sc1 lds
    v_add_u32 v18, 128, v18
    v_add_u32 v19, 128, v19
    s_waitcnt vmcnt(32)
    s_barrier
    s_mov_b32 m0, 16384
    s_nop 0
    buffer_load_dwordx4 v18, s[48:51], s20 offen sc1 lds
    buffer_load_dwordx4 v19, s[48:51], s20 offen offset:1024 sc1 lds
    s_mov_b32 m0, 18432
    s_nop 0
    buffer_load_dwordx4 v18, s[48:51], s21 offen sc1 lds
    buffer_load_dwordx4 v19, s[48:51], s21 offen offset:1024 sc1 lds
    s_mov_b32 m0, 20480
    s_nop 0
    buffer_load_dwordx4 v18, s[48:51], s22 offen sc1 lds
    buffer_load_dwordx4 v19, s[48:51], s22 offen offset:1024 sc1 lds
    s_mov_b32 m0, 22528
    s_nop 0
    buffer_load_dwordx4 v18, s[48:51], s23 offen sc1 lds
    buffer_load_dwordx4 v19, s[48:51], s23 offen offset:1024 sc1 lds
    s_mov_b32 m0, 24576
    s_nop 0
    buffer_load_dwordx4 v18, s[48:51], s24 offen sc1 lds
    buffer_load_dwordx4 v19, s[48:51], s24 offen offset:1024 sc1 lds
    s_mov_b32 m0, 26624
    s_nop 0
    buffer_load_dwordx4 v18, s[48:51], s25 offen sc1 lds
    buffer_load_dwordx4 v19, s[48:51], s25 offen offset:1024 sc1 lds
    s_mov_b32 m0, 28672
    s_nop 0
    buffer_load_dwordx4 v18, s[48:51], s26 offen sc1 lds
    buffer_load_dwordx4 v19, s[48:51], s26 offen offset:1024 sc1 lds
    s_mov_b32 m0, 30720
    s_nop 0
    buffer_load_dwordx4 v18, s[48:51], s27 offen sc1 lds
    buffer_load_dwordx4 v19, s[48:51], s27 offen offset:1024 sc1 lds
    v_add_u32 v18, 128, v18
    v_add_u32 v19, 128, v19
    s_waitcnt vmcnt(32)
    s_barrier
    s_mov_b32 m0, 32768
    s_nop 0
    buffer_load_dwordx4 v18, s[48:51], s20 offen sc1 lds
    buffer_load_dwordx4 v19, s[48:51], s20 offen offset:1024 sc1 lds
    s_mov_b32 m0, 34816
    s_nop 0
    buffer_load_dwordx4 v18, s[48:51], s21 offen sc1 lds
    buffer_load_dwordx4 v19, s[48:51], s21 offen offset:1024 sc1 lds
    s_mov_b32 m0, 36864
    s_nop 0
    buffer_load_dwordx4 v18, s[48:51], s22 offen sc1 lds
    buffer_load_dwordx4 v19, s[48:51], s22 offen offset:1024 sc1 lds
    s_mov_b32 m0, 38912
    s_nop 0
    buffer_load_dwordx4 v18, s[48:51], s23 offen sc1 lds
    buffer_load_dwordx4 v19, s[48:51], s23 offen offset:1024 sc1 lds
    s_mov_b32 m0, 40960
    s_nop 0
    buffer_load_dwordx4 v18, s[48:51], s24 offen sc1 lds
    buffer_load_dwordx4 v19, s[48:51], s24 offen offset:1024 sc1 lds
    s_mov_b32 m0, 43008
    s_nop 0
    buffer_load_dwordx4 v18, s[48:51], s25 offen sc1 lds
    buffer_load_dwordx4 v19, s[48:51], s25 offen offset:1024 sc1 lds
    s_mov_b32 m0, 45056
    s_nop 0
    buffer_load_dwordx4 v18, s[48:51], s26 offen sc1 lds
    buffer_load_dwordx4 v19, s[48:51], s26 offen offset:1024 sc1 lds
    s_mov_b32 m0, 47104
    s_nop 0
    buffer_load_dwordx4 v18, s[48:51], s27 offen sc1 lds
    buffer_load_dwordx4 v19, s[48:51], s27 offen offset:1024 sc1 lds
    v_add_u32 v18, 128, v18
    v_add_u32 v19, 128, v19
    s_waitcnt vmcnt(32)
    s_barrier
    s_mov_b32 m0, 49152
    s_nop 0
    buffer_load_dwordx4 v18, s[48:51], s20 offen sc1 lds
    buffer_load_dwordx4 v19, s[48:51], s20 offen offset:1024 sc1 lds
    s_mov_b32 m0, 51200
    s_nop 0
    buffer_load_dwordx4 v18, s[48:51], s21 offen sc1 lds
    buffer_load_dwordx4 v19, s[48:51], s21 offen offset:1024 sc1 lds
    s_mov_b32 m0, 53248
    s_nop 0
    buffer_load_dwordx4 v18, s[48:51], s22 offen sc1 lds
    buffer_load_dwordx4 v19, s[48:51], s22 offen offset:1024 sc1 lds
    s_mov_b32 m0, 55296
    s_nop 0
    buffer_load_dwordx4 v18, s[48:51], s23 offen sc1 lds
    buffer_load_dwordx4 v19, s[48:51], s23 offen offset:1024 sc1 lds
    s_mov_b32 m0, 57344
    s_nop 0
    buffer_load_dwordx4 v18, s[48:51], s24 offen sc1 lds
    buffer_load_dwordx4 v19, s[48:51], s24 offen offset:1024 sc1 lds
    s_mov_b32 m0, 59392
    s_nop 0
    buffer_load_dwordx4 v18, s[48:51], s25 offen sc1 lds
    buffer_load_dwordx4 v19, s[48:51], s25 offen offset:1024 sc1 lds
    s_mov_b32 m0, 61440
    s_nop 0
    buffer_load_dwordx4 v18, s[48:51], s26 offen sc1 lds
    buffer_load_dwordx4 v19, s[48:51], s26 offen offset:1024 sc1 lds
    s_mov_b32 m0, 63488
    s_nop 0
    buffer_load_dwordx4 v18, s[48:51], s27 offen sc1 lds
    buffer_load_dwordx4 v19, s[48:51], s27 offen offset:1024 sc1 lds
    v_add_u32 v18, 128, v18
    v_add_u32 v19, 128, v19
    s_waitcnt vmcnt(32)
    s_barrier
    s_mov_b32 m0, 0
    s_nop 0
    buffer_load_dwordx4 v18, s[48:51], s20 offen sc1 lds
    buffer_load_dwordx4 v19, s[48:51], s20 offen offset:1024 sc1 lds
    s_mov_b32 m0, 2048
    s_nop 0
    buffer_load_dwordx4 v18, s[48:51], s21 offen sc1 lds
    buffer_load_dwordx4 v19, s[48:51], s21 offen offset:1024 sc1 lds
    s_mov_b32 m0, 4096
    s_nop 0
    buffer_load_dwordx4 v18, s[48:51], s22 offen sc1 lds
    buffer_load_dwordx4 v19, s[48:51], s22 offen offset:1024 sc1 lds
    s_mov_b32 m0, 6144
    s_nop 0
    buffer_load_dwordx4 v18, s[48:51], s23 offen sc1 lds
    buffer_load_dwordx4 v19, s[48:51], s23 offen offset:1024 sc1 lds
    s_mov_b32 m0, 8192
    s_nop 0
    buffer_load_dwordx4 v18, s[48:51], s24 offen sc1 lds
    buffer_load_dwordx4 v19, s[48:51], s24 offen offset:1024 sc1 lds
    s_mov_b32 m0, 10240
    s_nop 0
    buffer_load_dwordx4 v18, s[48:51], s25 offen sc1 lds
    buffer_load_dwordx4 v19, s[48:51], s25 offen offset:1024 sc1 lds
    s_mov_b32 m0, 12288
    s_nop 0
    buffer_load_dwordx4 v18, s[48:51], s26 offen sc1 lds
    buffer_load_dwordx4 v19, s[48:51], s26 offen offset:1024 sc1 lds
    s_mov_b32 m0, 14336
    s_nop 0
    buffer_load_dwordx4 v18, s[48:51], s27 offen sc1 lds
    buffer_load_dwordx4 v19, s[48:51], s27 offen offset:1024 sc1 lds
    v_add_u32 v18, 128, v18
    v_add_u32 v19, 128, v19
    s_waitcnt vmcnt(32)
    s_barrier
    s_waitcnt vmcnt(16)
    s_barrier
    s_waitcnt vmcnt(0)
    s_barrier
    s_branch L_B2_out
L_B_idle:
    s_waitcnt vmcnt(0)
    s_barrier
    s_cmp_eq_u32 s3, 7
    s_cbranch_scc0 L_fin
    s_lshl_b32 s78, s8, 7
    s_add_u32 s78, s78, 4096
    v_mov_b32 v12, s76
    v_mov_b32 v11, 0
    s_mov_b64 exec, 1
    buffer_store_dword v12, v11, s[48:51], s78 offen sc1
    s_mov_b64 exec, -1
    s_cmp_eq_u32 s2, 255
    s_cbranch_scc0 L_fin
    s_sleep 64
    v_lshlrev_b32 v10, 7, v1
    v_add_u32 v10, 4096, v10
    v_lshrrev_b32 v14, 4, v1
    v_and_b32 v15, 15, v1
    v_lshl_add_u32 v11, v14, 6, v15
    v_mul_u32_u24 v11, 1920, v11
    v_add_u32 v11, 65548, v11
    v_add_u32 v12, 491520, v11
    v_mul_u32_u24 v13, 786432, v14
    v_lshl_add_u32 v13, v15, 11, v13
    v_add_u32 v13, 1114124, v13
    s_mov_b32 s77, 0
L_jan_poll:
    s_sleep 32
    buffer_load_dword v16, v10, s[48:51], 0 offen sc1
    buffer_load_dword v17, v11, s[48:51], 0 offen sc1
    buffer_load_dword v18, v12, s[48:51], 0 offen sc1
    buffer_load_dword v19, v13, s[48:51], 0 offen sc1
    s_add_u32 s77, s77, 1
    s_waitcnt vmcnt(0)
    v_xor_b32 v16, s76, v16
    v_xor_b32 v17, s76, v17
    v_xor_b32 v18, s76, v18
    v_xor_b32 v19, s76, v19
    v_or_b32 v16, v16, v17
    v_or_b32 v16, v16, v18
    v_or_b32 v16, v16, v19
    v_cmp_ne_u32 vcc, 0, v16
    s_cmp_ge_u32 s77, 4096
    s_cbranch_scc1 L_jan_go
    s_cbranch_vccnz L_jan_poll
L_jan_go:
    v_mov_b32 v10, s76
    v_mov_b32 v11, 0
    s_mov_b64 exec, 1
    buffer_store_dword v10, v11, s[48:51], 0 offen sc1
L_fin:
L_end:
    s_endpgm
.section .rodata,"a"
.p2align 6
.amdhsa_kernel concat_heads__linear_kernel_hedgehog__spectral_fnet__prompt_kernel
  .amdhsa_next_free_vgpr 256
  .amdhsa_next_free_sgpr 102
  .amdhsa_accum_offset 256
  .amdhsa_group_segment_fixed_size 0
  .amdhsa_kernarg_size 96
  .amdhsa_user_sgpr_count 2
  .amdhsa_user_sgpr_kernarg_segment_ptr 1
  .amdhsa_system_sgpr_workgroup_id_x 1
.end_amdhsa_kernel
```
